```python
import torch

def _softmax(x, axis=-1):
    return torch.softmax(x, dim=axis)
def _gelu(x):
    return torch.nn.functional.gelu(x, approximate="tanh")
def _silu(x):
    return torch.nn.functional.silu(x)
def _sigmoid(x):
    return torch.sigmoid(x)
def _layernorm(x, axis=-1, eps=1e-5):
    m = x.mean(dim=axis, keepdim=True)
    v = x.var(dim=axis, keepdim=True, unbiased=False)
    return (x - m) / torch.sqrt(v + eps)
def _scatter_add(tgt, idx, src, axis=0):
    return tgt.clone().index_add_(axis, idx, src)
def _segment_sum(src, seg, n):
    out = torch.zeros((n,) + src.shape[1:], dtype=src.dtype)
    return out.index_add_(0, seg, src)
def _pad(x, pw):
    flat = tuple(v for pair in reversed(pw) for v in pair)
    return torch.nn.functional.pad(x, flat)

kernel_name = 'sequential_preLN__ssm_conv_h3__mixer_channel_mlp__prompt'

def setup_inputs():

    _w = (lambda a: (lambda t: t.to(torch.bfloat16) if t.is_floating_point() else t)(torch.as_tensor(a)))
    def _A_setup():
        B, S, D = 1, 2048, 640
        ks = 4
        return {
            "q": _w((lambda *s: torch.randn(*s, dtype=torch.bfloat16) * 0.05)(B, S, D)),
            "k": _w((lambda *s: torch.randn(*s, dtype=torch.bfloat16) * 0.2)(B, S, D)),
            "v": _w((lambda *s: torch.randn(*s, dtype=torch.bfloat16) * 0.2)(B, S, D)),
            "shift_k": _w((lambda *s: torch.randn(*s, dtype=torch.bfloat16) * 0.2)(D, ks) * 0.5),
            "ssm_k": _w((lambda *s: torch.randn(*s, dtype=torch.bfloat16) * 0.8)(D, S) * (1.0 / S ** 0.5)),
            "ssm_D": _w((lambda *s: torch.randn(*s, dtype=torch.bfloat16) * 0.2)(D)),
        }
    _A_in = _A_setup()

    def _B_setup():
        B, S, D, F = 1, 2048, 640, 1728
        return {
            "x": _w((lambda *s: torch.randn(*s, dtype=torch.bfloat16) * 0.05)(B, S, D)),
            "w1": _w((lambda *s: torch.randn(*s, dtype=torch.bfloat16) * 0.8)(D, F) * (D ** -0.5)),
            "b1": _w((lambda *s: torch.randn(*s, dtype=torch.bfloat16) * 0.4)(F)),
            "w2": _w((lambda *s: torch.randn(*s, dtype=torch.bfloat16) * 0.05)(F, D) * (F ** -0.5)),
            "b2": _w((lambda *s: torch.randn(*s, dtype=torch.bfloat16) * 0.05)(D)),
        }
    _B_in = _B_setup()

    return {
        "A_q": _A_in["q"],
        "A_k": _A_in["k"],
        "A_v": _A_in["v"],
        "A_shift_k": _A_in["shift_k"],
        "A_ssm_k": _A_in["ssm_k"],
        "A_ssm_D": _A_in["ssm_D"],
        "B_x": _B_in["x"],
        "B_w1": _B_in["w1"],
        "B_b1": _B_in["b1"],
        "B_w2": _B_in["w2"],
        "B_b2": _B_in["b2"],
    }

def reference(A_q, A_k, A_v, A_shift_k, A_ssm_k, A_ssm_D, B_x, B_w1, B_b1, B_w2, B_b2):
    def _A_ref(q, k, v, shift_k, ssm_k, ssm_D):
        B, S, D = q.shape
        ks = shift_k.shape[-1]
        k_pad = _pad(k, ((0, 0), (ks - 1, 0), (0, 0)))
        k_shift = torch.zeros_like(k)
        for t in range(ks):
            k_shift = k_shift + k_pad[:, t:t + S, :] * shift_k[:, ks - 1 - t][None, None, :]
        kv = k_shift * v
        L = 2 * S
        kv_pad = _pad(kv, ((0, 0), (0, S), (0, 0)))
        kf_pad = _pad(ssm_k, ((0, 0), (0, S)))
        kv_f = (lambda x, axes=(-2,-1): torch.fft.rfft2(x.float(), dim=axes))(kv_pad[:, None, :, :], axes=(1, 2))
        kf_f = (lambda x, axes=(-2,-1): torch.fft.rfft2(x.float(), dim=axes))(kf_pad[:, None, :], axes=(1, 2))
        kf_f = (lambda x, *d: x.permute(*d))(kf_f, 1, 2, 0)
        y_f = kv_f * kf_f[None, :, :, :]
        y = (lambda x, s, axes=(-2,-1): torch.fft.irfft2(x, s=s, dim=axes).to(torch.bfloat16))(y_f, (1, L), axes=(1, 2))[:, 0, :S, :]
        y = y + kv * ssm_D[None, None, :]
        return q * y

    def _B_ref(x, w1, b1, w2, b2):
        y = _layernorm(x, axis=-1)
        h = _gelu(torch.einsum("bsd,df->bsf", y, w1) + b1)
        return torch.einsum("bsf,fd->bsd", h, w2) + b2

    x = A_q
    h = x + _A_ref(_layernorm(x, axis=-1), A_k, A_v, A_shift_k, A_ssm_k, A_ssm_D)
    h2 = h + _B_ref(_layernorm(h, axis=-1), B_w1, B_b1, B_w2, B_b2)
    return h2
```

```asm
; @launch grid=(256,1,1) block=(256,1,1) lds=163840
.amdgcn_target "amdgcn-amd-amdhsa--gfx950"
.text
.globl sequential_preLN__ssm_conv_h3__mixer_channel_mlp__prompt_kernel
.p2align 12
.p2align 8
.type sequential_preLN__ssm_conv_h3__mixer_channel_mlp__prompt_kernel,@function
sequential_preLN__ssm_conv_h3__mixer_channel_mlp__prompt_kernel:
    s_cmp_ge_u32 s2, 256
    s_cbranch_scc1 L_end
    s_load_dwordx2 s[12:13], s[0:1], 8
    s_load_dwordx2 s[16:17], s[0:1], 16
    s_load_dwordx2 s[52:53], s[0:1], 104
    s_load_dwordx2 s[20:21], s[0:1], 24
    s_load_dwordx2 s[8:9], s[0:1], 0
    s_getpc_b64 s[60:61]
L_pc:
    s_lshr_b32 s4, s2, 3
    v_lshrrev_b32 v2, 4, v0
    s_lshl_b32 s62, s4, 11
    v_lshl_add_u32 v2, v2, 7, s62
    v_min_u32 v2, L_last-L_pc-4, v2
    v_mov_b32 v3, 0
    v_lshl_add_u64 v[2:3], v[2:3], 0, s[60:61]
    v_lshrrev_b32 v1, 6, v0
    global_load_dword v255, v[2:3], off
    v_readfirstlane_b32 s5, v1
    s_and_b32 s3, s2, 7
    s_mov_b32 s14, 0x280000
    s_mov_b32 s15, 0x20000
    s_mov_b32 s18, 0x280000
    s_mov_b32 s19, 0x20000
    s_lshl_b32 s60, s5, 10
    s_lshl_b32 s65, s3, 5
    s_add_u32 s65, s65, s4
    s_lshr_b32 s61, s65, 1
    s_and_b32 s68, s4, 1
    s_mul_i32 s62, s61, 20480
    s_mul_i32 s63, s68, 640
    s_add_u32 s62, s62, s63
    s_sub_u32 s63, s62, 3840
    v_mul_u32_u24 v2, 1639, v0
    v_lshrrev_b32 v2, 16, v2
    v_bitop3_b32 v3, v0, v2, 6 bitop3:0x78
    v_mul_u32_u24 v2, 640, v2
    v_lshl_add_u32 v7, v3, 4, v2
    s_add_u32 m0, s60, 106496
    v_add_u32 v4, s63, v7
    s_waitcnt lgkmcnt(0)
    buffer_load_dwordx4 v4, s[12:15], 0 offen lds
    s_add_u32 m0, s60, 118784
    s_nop 0
    buffer_load_dwordx4 v7, s[16:19], s62 offen lds
    v_add_u32 v1, 256, v0
    v_mul_u32_u24 v2, 1639, v1
    v_lshrrev_b32 v2, 16, v2
    v_bitop3_b32 v3, v1, v2, 6 bitop3:0x78
    v_mul_u32_u24 v2, 640, v2
    v_lshl_add_u32 v8, v3, 4, v2
    s_add_u32 m0, s60, 110592
    v_add_u32 v5, s63, v8
    buffer_load_dwordx4 v5, s[12:15], 0 offen lds
    s_add_u32 m0, s60, 122880
    s_nop 0
    buffer_load_dwordx4 v8, s[16:19], s62 offen lds
    v_add_u32 v1, 512, v0
    v_mul_u32_u24 v2, 1639, v1
    v_lshrrev_b32_e64 v2, 16, v2
    v_bitop3_b32 v3, v1, v2, 6 bitop3:0x78
    v_mul_u32_u24 v2, 640, v2
    v_lshl_add_u32 v9, v3, 4, v2
    s_add_u32 m0, s60, 114688
    v_add_u32 v6, s63, v9
    buffer_load_dwordx4 v6, s[12:15], 0 offen lds
    s_add_u32 m0, s60, 126976
    s_cmp_lt_u32 s5, 2
    s_cselect_b32 s62, s62, 0x7ff00000
    buffer_load_dwordx4 v9, s[16:19], s62 offen lds
    v_mov_b32 v38, v0
    v_and_b32 v0, 63, v0
    v_mov_b32 v231, 0x7ff00000
    s_lshl_b32 s68, s68, 2
    s_add_u32 s68, s68, s5
    s_load_dwordx2 s[24:25], s[0:1], 32
    s_load_dwordx2 s[28:29], s[0:1], 40
    s_load_dwordx2 s[32:33], s[0:1], 56
    s_load_dwordx2 s[40:41], s[0:1], 72
    s_load_dwordx2 s[36:37], s[0:1], 64
    s_load_dwordx2 s[44:45], s[0:1], 80
    s_load_dwordx2 s[48:49], s[0:1], 88
    s_mov_b32 s22, 0x1400
    s_mov_b32 s23, 0x20000
    s_mov_b32 s54, 0x1900000
    s_mov_b32 s55, 0x20000
    v_and_b32 v1, 15, v0
    v_lshrrev_b32 v39, 5, v0
    v_lshl_add_u32 v3, v39, 4, v1
    s_mul_i32 s64, s68, 640
    v_lshlrev_b32_e64 v10, 3, v3
    buffer_load_dwordx2 v[12:13], v10, s[20:23], s64 offen offset:0
    buffer_load_dwordx2 v[14:15], v10, s[20:23], s64 offen offset:256
    buffer_load_dwordx2 v[16:17], v10, s[20:23], s64 offen offset:512
    s_waitcnt lgkmcnt(0)
    s_nop 0
    s_load_dword s7, s[52:53], 0
    s_mov_b32 s10, 0x280000
    s_mov_b32 s11, 0x20000
    s_mov_b32 s26, 0x280000
    s_mov_b32 s27, 0x20000
    s_mov_b32 s30, 0x500
    s_mov_b32 s31, 0x20000
    s_mov_b32 s34, 0x21c000
    s_mov_b32 s35, 0x20000
    s_mov_b32 s42, 0x21c000
    s_mov_b32 s43, 0x20000
    s_mov_b32 s38, 0xd80
    s_mov_b32 s39, 0x20000
    s_mov_b32 s46, 0x500
    s_mov_b32 s47, 0x20000
    s_mov_b32 s50, 0x280000
    s_mov_b32 s51, 0x20000
    v_bfe_u32 v30, v0, 4, 1
    v_bfe_u32 v31, v0, 2, 2
    v_and_b32 v32, 3, v0
    v_lshlrev_b32 v33, 3, v32
    v_add_u32 v33, 106496, v33
    v_xor_b32 v34, 1, v31
    v_add_u32 v34, v34, v30
    v_lshrrev_b32 v4, 1, v34
    v_mul_u32_u24 v34, 640, v34
    v_add_u32 v34, v34, v33
    v_lshl_add_u32 v35, v31, 1, v30
    v_mul_u32_u24 v35, 640, v35
    v_add_u32 v35, v35, v33
    s_mul_i32 s67, s5, 5
    v_add_u32 v5, s67, v39
    v_xor_b32 v6, v5, v4
    v_lshl_add_u32 v200, v6, 5, v34
    v_xor_b32 v6, 2, v6
    v_lshl_add_u32 v201, v6, 5, v34
    v_xor_b32 v6, v5, v31
    v_lshl_add_u32 v202, v6, 5, v35
    v_add_u32 v5, 2, v5
    v_xor_b32 v6, v5, v4
    v_lshl_add_u32 v203, v6, 5, v34
    v_xor_b32 v6, 2, v6
    v_lshl_add_u32 v204, v6, 5, v34
    v_xor_b32 v6, v5, v31
    v_lshl_add_u32 v205, v6, 5, v35
    v_add_u32 v5, 2, v5
    v_xor_b32 v6, v5, v4
    v_lshl_add_u32 v206, v6, 5, v34
    v_xor_b32 v6, 2, v6
    v_lshl_add_u32 v207, v6, 5, v34
    v_xor_b32 v6, v5, v31
    v_lshl_add_u32 v208, v6, 5, v35
    s_lshr_b32 s67, s61, 1
    s_and_b32 s67, s67, 3
    v_xor_b32 v36, s67, v32
    v_lshlrev_b32 v36, 4, v36
    v_lshl_add_u32 v36, v30, 6, v36
    v_lshl_add_u32 v37, v39, 2, v31
    v_lshl_add_u32 v36, v37, 14, v36
    s_mul_i32 s67, s68, 327680
    s_lshl_b32 s68, s61, 7
    s_add_u32 s67, s67, s68
    s_add_u32 s67, s67, 0x100000
    v_cmp_gt_u32 vcc, 32, v0
    s_mov_b32 s69, 0xffff0000
    s_nop 0
    v_cndmask_b32 v37, v231, v36, vcc
    s_mul_i32 s62, s65, 10240
    s_mul_i32 s63, s5, 2560
    s_add_u32 s66, s62, s63
    v_and_b32_e64 v11, 31, v0
    v_mul_u32_u24 v18, 1280, v39
    v_lshl_add_u32 v19, v11, 3, v18
    v_lshl_add_u32 v18, v11, 4, v18
    s_mul_i32 s70, s4, 21846
    s_lshr_b32 s70, s70, 16
    s_mul_i32 s71, s70, 3
    s_sub_u32 s71, s4, s71
    s_mul_i32 s72, s3, 10
    s_add_u32 s70, s70, s72
    s_cmp_ge_u32 s4, 30
    s_cselect_b32 s71, 3, s71
    s_mul_i32 s78, s4, 21846
    s_lshr_b32 s78, s78, 16
    s_cmp_eq_u32 s4, 31
    s_cselect_b32 s78, 12, s78
    s_lshl_b32 s78, s78, 2
    s_add_u32 s78, s78, s5
    s_and_b32 s56, s71, 1
    s_lshl_b32 s56, s56, 1
    s_cmp_eq_u32 s71, 2
    s_cselect_b32 s56, 1, s56
    s_lshl_b32 s77, s5, 10
    s_add_u32 s77, s77, 132096
    s_lshl_b32 s74, s70, 3
    s_add_u32 s74, s74, s5
    s_lshl_b32 s72, s74, 12
    s_mul_i32 s73, s5, 8448
    s_cmp_eq_u32 s71, 3
    s_cselect_b32 s75, 0x7ff00000, 0
    v_lshl_add_u32 v112, v0, 4, s75
    s_cmp_eq_u32 s71, 0
    s_cselect_b32 s75, 0x7ff00000, s75
    s_add_u32 s76, s72, 16384
    v_lshl_add_u32 v113, v0, 4, s75
    v_and_b32 v114, 1, v0
    v_lshlrev_b32 v117, 3, v114
    s_lshl_b32 s95, s74, 1
    v_mov_b32 v227, v231
    v_writelane_b32 v227, 0, 0
    s_lshl_b32 s94, s65, 7
    s_add_u32 s0, s94, 0x20000
    s_add_u32 s99, s94, 0x20008
    s_add_u32 s1, s94, 0x20004
    v_lshlrev_b32 v1, 4, v0
    v_lshrrev_b32 v2, 1, v0
    v_lshrrev_b32 v214, 3, v0
    v_lshlrev_b32 v2, 7, v2
    v_lshlrev_b32 v214, 8, v214
    v_and_b32 v225, 7, v0
    v_lshlrev_b32 v225, 8, v225
    s_sub_u32 s93, s5, 1
    s_lshl_b32 s93, s93, 14
    s_lshl_b32 s94, s3, 8
    s_add_u32 s93, s93, s94
    s_add_u32 s93, s93, 0x10000
    s_cmp_eq_u32 s5, 3
    s_cselect_b32 s94, 30, 31
    s_cmp_eq_u32 s4, s94
    s_cselect_b32 s93, s93, 0x7ff00000
    s_cmp_eq_u32 s5, 0
    s_cselect_b32 s57, s0, s93
    s_cselect_b32 s58, s0, 0x7ff00000
    s_cselect_b32 s94, 28, 11
    v_lshrrev_b32 v3, 3, v0
    v_lshlrev_b32 v3, s94, v3
    v_lshrrev_b32 v220, 4, v225
    v_add_u32 v3, v3, v220
    v_mov_b32 v220, 0
    v_mov_b32 v221, 0
    v_mov_b32 v222, 0
    v_mov_b32 v223, 0
    v_mov_b32 v238, v231
    v_mov_b32 v239, v231
    v_mov_b32 v240, v231
    v_mov_b32 v241, v231
    v_mov_b32 v242, v231
    v_mov_b32 v243, v231
    v_mov_b32 v244, v231
    v_mov_b32 v245, v231
    v_mov_b32 v246, v231
    s_cmp_lg_u32 s56, 2
    s_cbranch_scc1 L_nw1
    v_mul_u32_u24 v136, 1639, v38
    v_lshrrev_b32 v136, 16, v136
    v_mul_u32_u24 v136, 640, v136
    v_lshl_add_u32 v240, v38, 4, v136
    v_add_u32 v135, 256, v38
    v_mul_u32_u24 v136, 1639, v135
    v_lshrrev_b32_e64 v136, 16, v136
    v_mul_u32_u24 v136, 640, v136
    v_lshl_add_u32 v241, v135, 4, v136
    v_add_u32 v135, 512, v38
    v_mul_u32_u24 v136, 1639, v135
    v_lshrrev_b32_e64 v136, 16, v136
    v_mul_u32_u24 v136, 640, v136
    v_lshl_add_u32 v242, v135, 4, v136
    v_add_u32 v135, 768, v38
    v_mul_u32_u24 v136, 1639, v135
    v_lshrrev_b32_e64 v136, 16, v136
    v_mul_u32_u24 v136, 640, v136
    v_lshl_add_u32 v243, v135, 4, v136
    v_add_u32 v135, 1024, v38
    v_mul_u32_u24 v136, 1639, v135
    v_lshrrev_b32 v136, 16, v136
    v_mul_u32_u24 v136, 640, v136
    v_lshl_add_u32 v244, v135, 4, v136
    v_lshrrev_b32 v136, 2, v0
    v_mul_u32_u24 v136, 640, v136
    s_mul_i32 s74, s5, 160
    s_add_u32 s74, s74, 132096
    v_and_b32 v137, 3, v0
    v_add_u32 v136, s74, v136
    v_lshl_add_u32 v245, v137, 4, v136
    v_lshl_add_u32 v246, v137, 3, v136
    s_mul_i32 s84, s3, 56
    s_add_u32 s84, s84, s78
    s_and_b32 s80, s84, 7
    s_lshr_b32 s84, s84, 3
    s_cmp_ge_u32 s84, 28
    s_cselect_b32 s85, 1, 0
    s_mul_i32 s86, s85, 28
    s_sub_u32 s86, s84, s86
    s_lshl_b32 s81, s85, 3
    s_add_u32 s81, s81, s80
    s_mul_i32 s81, s81, 28
    s_add_u32 s81, s81, s86
    s_lshr_b32 s87, s86, 1
    s_sub_u32 s88, s86, 16
    s_cmp_lt_u32 s86, 16
    s_cselect_b32 s87, s87, s88
    s_cselect_b32 s89, 2, 1
    s_sub_u32 s90, 0, s87
    s_cmp_lt_u32 s87, s80
    s_cselect_b32 s88, 1, 0
    s_cmp_eq_u32 s87, s80
    s_cselect_b32 s88, s90, s88
    s_mul_i32 s88, s88, s89
    s_add_u32 s81, s81, s88
    s_mul_i32 s81, s81, 5120
    s_add_u32 s81, s81, 0xf40000
    s_mul_i32 s85, s85, 864
    s_lshr_b32 s87, s86, 1
    s_mul_i32 s87, s87, 44
    s_lshl_b32 s88, s86, 5
    s_add_u32 s87, s87, s88
    s_add_u32 s87, s87, 48
    s_mul_i32 s88, s86, 108
    s_sub_u32 s89, s88, 1728
    s_cmp_lt_u32 s86, 16
    s_cselect_b32 s87, s87, s89
    s_lshl_b32 s88, s88, 1
    s_sub_u32 s88, s88, 5152
    s_cmp_lt_u32 s86, 24
    s_cselect_b32 s88, s87, s88
    s_cselect_b32 s87, 0, 117760
    s_add_u32 s85, s85, s88
    s_mul_i32 s85, s85, 1280
    s_lshr_b32 s88, s80, 2
    s_mul_i32 s88, s88, 640
    s_add_u32 s85, s85, s88
    s_add_u32 s86, s85, s87
    s_add_u32 s82, s81, 4096
    s_cmp_lt_u32 s5, 2
    s_cselect_b32 s87, s85, s86
    s_nop 1
L_nw1:
    s_cmp_lg_u32 s56, 1
    s_cbranch_scc1 L_nw2
    v_cmp_gt_u32 vcc, 224, v38
    v_mul_u32_u24 v136, 1192, v38
    v_lshrrev_b32 v136, 16, v136
    v_mul_u32_u24 v136, 2576, v136
    v_lshl_add_u32 v240, v38, 4, v136
    v_add_u32 v135, 256, v38
    v_mul_u32_u24 v136, 1192, v135
    v_lshrrev_b32_e64 v136, 16, v136
    v_mul_u32_u24 v136, 2576, v136
    v_lshl_add_u32 v241, v135, 4, v136
    v_add_u32 v135, 512, v38
    v_mul_u32_u24 v136, 1192, v135
    v_lshrrev_b32_e64 v136, 16, v136
    v_mul_u32_u24 v136, 2576, v136
    v_lshl_add_u32 v242, v135, 4, v136
    v_add_u32 v135, 768, v38
    v_mul_u32_u24 v136, 1192, v135
    v_lshrrev_b32_e64 v136, 16, v136
    v_mul_u32_u24 v136, 2576, v136
    v_lshl_add_u32 v243, v135, 4, v136
    v_add_u32 v135, 1024, v38
    v_mul_u32_u24 v136, 1192, v135
    v_lshrrev_b32_e64 v136, 16, v136
    v_mul_u32_u24 v136, 2576, v136
    v_lshl_add_u32 v244, v135, 4, v136
    v_add_u32 v135, 1280, v38
    v_mul_u32_u24 v136, 1192, v135
    v_lshrrev_b32_e64 v136, 16, v136
    v_mul_u32_u24 v136, 2576, v136
    v_lshl_add_u32 v245, v135, 4, v136
    v_add_u32 v135, 1536, v38
    v_mul_u32_u24 v136, 1192, v135
    v_lshrrev_b32 v136, 16, v136
    v_mul_u32_u24 v136, 2576, v136
    v_lshl_add_u32 v246, v135, 4, v136
    v_cndmask_b32 v246, v231, v246, vcc
    v_lshrrev_b32_e64 v136, 4, v0
    v_bfe_u32 v137, v0, 2, 2
    v_lshl_add_u32 v137, v136, 3, v137
    v_mul_u32_u24 v137, 880, v137
    v_and_b32_e64 v138, 3, v0
    v_lshl_add_u32 v137, v138, 3, v137
    s_mul_i32 s74, s5, 216
    s_add_u32 s74, s74, 132096
    v_add_u32 v247, s74, v137
    v_cmp_gt_u32 vcc, 48, v0
    v_lshlrev_b32_e64 v238, 2, v0
    v_mov_b32 v232, 0x3f803f80
    v_mov_b32 v233, 0x3f803f80
    v_mov_b32 v234, 0x3f803f80
    v_mov_b32 v235, 0x3f803f80
    v_cndmask_b32 v239, v231, v238, vcc
    s_mul_i32 s89, s3, 40
    s_add_u32 s89, s89, s78
    s_lshr_b32 s88, s89, 4
    s_and_b32 s89, s89, 15
    s_mul_i32 s84, s88, 110592
    s_and_b32 s90, s89, 12
    s_mul_i32 s90, s90, 216
    s_add_u32 s84, s84, s90
    s_mul_i32 s90, s89, 20
    s_add_u32 s90, s90, s88
    s_mul_i32 s90, s90, 448
    s_add_u32 s87, s90, 0x1170000
    s_mul_i32 s89, s89, 143360
    s_add_u32 s89, s89, 0xd10000
    s_lshl_b32 s90, s88, 12
    s_add_u32 s86, s90, s89
    s_mul_i32 s88, s88, 3072
    s_add_u32 s89, s89, s88
    s_add_u32 s85, s89, 81920
    s_nop 1
L_nw2:
    s_cmp_lg_u32 s5, 0
    s_cbranch_scc1 L_wk3
    s_mov_b64 exec, 0
    s_branch L_pad_s0_0
L_pad_s0_1:
    s_mov_b64 exec, -1
L_wk3:
    buffer_load_dwordx4 v[20:23], v18, s[8:11], s66 offen
    buffer_load_dwordx4 v[24:27], v18, s[8:11], s66 offen offset:512
    buffer_load_dwordx2 v[28:29], v19, s[8:11], s66 offen offset:1024
    s_waitcnt vmcnt(3)
    s_barrier
    ds_read_b64_tr_b16 v[40:41], v200 offset:0
    ds_read_b64_tr_b16 v[42:43], v201 offset:2560
    ds_read_b64_tr_b16 v[44:45], v200 offset:5120
    ds_read_b64_tr_b16 v[46:47], v201 offset:7680
    ds_read_b64_tr_b16 v[48:49], v200 offset:10240
    ds_read_b64_tr_b16 v[70:71], v202 offset:12288
    ds_read_b64_tr_b16 v[72:73], v202 offset:17408
    ds_read_b64_tr_b16 v[50:51], v203 offset:0
    ds_read_b64_tr_b16 v[52:53], v204 offset:2560
    ds_read_b64_tr_b16 v[54:55], v203 offset:5120
    ds_read_b64_tr_b16 v[56:57], v204 offset:7680
    ds_read_b64_tr_b16 v[58:59], v203 offset:10240
    ds_read_b64_tr_b16 v[74:75], v205 offset:12288
    ds_read_b64_tr_b16 v[76:77], v205 offset:17408
    ds_read_b64_tr_b16 v[60:61], v206 offset:0
    ds_read_b64_tr_b16 v[62:63], v207 offset:2560
    ds_read_b64_tr_b16 v[64:65], v206 offset:5120
    ds_read_b64_tr_b16 v[66:67], v207 offset:7680
    ds_read_b64_tr_b16 v[68:69], v206 offset:10240
    ds_read_b64_tr_b16 v[78:79], v208 offset:12288
    ds_read_b64_tr_b16 v[80:81], v208 offset:17408
    ds_read_b32 v82, v35
    s_waitcnt lgkmcnt(15)
    s_nop 0
    v_dot2_f32_bf16 v84, v40, v13, 0
    v_dot2_f32_bf16 v85, v41, v13, 0
    v_dot2_f32_bf16 v86, v42, v13, 0
    v_dot2_f32_bf16 v87, v43, v13, 0
    v_dot2_f32_bf16 v88, v44, v13, 0
    v_dot2_f32_bf16 v89, v45, v13, 0
    v_dot2_f32_bf16 v90, v46, v13, 0
    v_dot2_f32_bf16 v91, v47, v13, 0
    v_dot2_f32_bf16 v84, v41, v12, v84
    v_dot2_f32_bf16 v85, v42, v12, v85
    v_dot2_f32_bf16 v86, v43, v12, v86
    v_dot2_f32_bf16 v87, v44, v12, v87
    v_dot2_f32_bf16 v88, v45, v12, v88
    v_dot2_f32_bf16 v89, v46, v12, v89
    v_dot2_f32_bf16 v90, v47, v12, v90
    v_dot2_f32_bf16 v91, v48, v12, v91
    v_lshlrev_b32 v92, 16, v70
    v_and_b32 v93, s69, v70
    v_lshlrev_b32 v94, 16, v71
    v_and_b32 v95, s69, v71
    v_lshlrev_b32 v96, 16, v72
    v_and_b32 v97, s69, v72
    v_lshlrev_b32 v98, 16, v73
    v_and_b32 v99, s69, v73
    v_pk_mul_f32 v[92:93], v[92:93], v[84:85]
    v_pk_mul_f32 v[94:95], v[94:95], v[86:87]
    v_pk_mul_f32 v[96:97], v[96:97], v[88:89]
    v_pk_mul_f32 v[98:99], v[98:99], v[90:91]
    v_cvt_pk_bf16_f32 v100, v92, v93
    v_cvt_pk_bf16_f32 v101, v94, v95
    v_cvt_pk_bf16_f32 v102, v96, v97
    v_cvt_pk_bf16_f32 v103, v98, v99
    buffer_store_dwordx4 v[100:103], v36, s[52:55], s67 offen sc1
    s_add_u32 s67, s67, 131072
    s_waitcnt lgkmcnt(8)
    s_nop 0
    v_dot2_f32_bf16 v84, v50, v15, 0
    v_dot2_f32_bf16 v85, v51, v15, 0
    v_dot2_f32_bf16 v86, v52, v15, 0
    v_dot2_f32_bf16 v87, v53, v15, 0
    v_dot2_f32_bf16 v88, v54, v15, 0
    v_dot2_f32_bf16 v89, v55, v15, 0
    v_dot2_f32_bf16 v90, v56, v15, 0
    v_dot2_f32_bf16 v91, v57, v15, 0
    v_dot2_f32_bf16 v84, v51, v14, v84
    v_dot2_f32_bf16 v85, v52, v14, v85
    v_dot2_f32_bf16 v86, v53, v14, v86
    v_dot2_f32_bf16 v87, v54, v14, v87
    v_dot2_f32_bf16 v88, v55, v14, v88
    v_dot2_f32_bf16 v89, v56, v14, v89
    v_dot2_f32_bf16 v90, v57, v14, v90
    v_dot2_f32_bf16 v91, v58, v14, v91
    v_lshlrev_b32 v92, 16, v74
    v_and_b32 v93, s69, v74
    v_lshlrev_b32 v94, 16, v75
    v_and_b32 v95, s69, v75
    v_lshlrev_b32 v96, 16, v76
    v_and_b32 v97, s69, v76
    v_lshlrev_b32 v98, 16, v77
    v_and_b32 v99, s69, v77
    v_pk_mul_f32 v[92:93], v[92:93], v[84:85]
    v_pk_mul_f32 v[94:95], v[94:95], v[86:87]
    v_pk_mul_f32 v[96:97], v[96:97], v[88:89]
    v_pk_mul_f32 v[98:99], v[98:99], v[90:91]
    v_cvt_pk_bf16_f32 v104, v92, v93
    v_cvt_pk_bf16_f32 v105, v94, v95
    v_cvt_pk_bf16_f32 v106, v96, v97
    v_cvt_pk_bf16_f32 v107, v98, v99
    buffer_store_dwordx4 v[104:107], v36, s[52:55], s67 offen sc1
    s_add_u32 s67, s67, 131072
    buffer_store_dwordx4 v[220:223], v3, s[52:55], s57 offen sc1
    buffer_load_dword v224, v227, s[52:55], s58 offen sc1
    s_waitcnt lgkmcnt(1)
    s_nop 0
    v_dot2_f32_bf16 v84, v60, v17, 0
    v_dot2_f32_bf16 v85, v61, v17, 0
    v_dot2_f32_bf16 v86, v62, v17, 0
    v_dot2_f32_bf16 v87, v63, v17, 0
    v_dot2_f32_bf16 v88, v64, v17, 0
    v_dot2_f32_bf16 v89, v65, v17, 0
    v_dot2_f32_bf16 v90, v66, v17, 0
    v_dot2_f32_bf16 v91, v67, v17, 0
    v_dot2_f32_bf16 v84, v61, v16, v84
    v_dot2_f32_bf16 v85, v62, v16, v85
    v_dot2_f32_bf16 v86, v63, v16, v86
    v_dot2_f32_bf16 v87, v64, v16, v87
    v_dot2_f32_bf16 v88, v65, v16, v88
L_pad_s0_0:
    s_cbranch_execz L_pad_s0_1
    v_dot2_f32_bf16 v89, v66, v16, v89
    v_dot2_f32_bf16 v90, v67, v16, v90
    v_dot2_f32_bf16 v91, v68, v16, v91
    v_lshlrev_b32 v92, 16, v78
    v_and_b32 v93, s69, v78
    v_lshlrev_b32 v94, 16, v79
    v_and_b32 v95, s69, v79
    v_lshlrev_b32 v96, 16, v80
    v_and_b32 v97, s69, v80
    v_lshlrev_b32 v98, 16, v81
    v_and_b32_e64 v99, s69, v81
    v_pk_mul_f32 v[92:93], v[92:93], v[84:85]
    v_pk_mul_f32 v[94:95], v[94:95], v[86:87]
    v_pk_mul_f32 v[96:97], v[96:97], v[88:89]
    v_pk_mul_f32 v[98:99], v[98:99], v[90:91]
    v_cvt_pk_bf16_f32 v108, v92, v93
    v_cvt_pk_bf16_f32 v109, v94, v95
    v_cvt_pk_bf16_f32 v110, v96, v97
    v_cvt_pk_bf16_f32 v111, v98, v99
    buffer_store_dwordx4 v[108:111], v37, s[52:55], s67 offen sc1
    s_add_u32 m0, s73, 32
    s_nop 0
    buffer_load_dwordx4 v112, s[24:27], s72 offen lds
    buffer_load_dwordx4 v112, s[24:27], s72 offen offset:1024 lds
    buffer_load_dwordx4 v112, s[24:27], s72 offen offset:2048 lds
    buffer_load_dwordx4 v113, s[24:27], s72 offen offset:3072 lds
    buffer_load_ushort v117, v117, s[28:31], s95 offen
    s_add_u32 m0, s73, 33824
    s_nop 0
    buffer_load_dwordx4 v112, s[24:27], s76 offen lds
    buffer_load_dwordx4 v112, s[24:27], s76 offen offset:1024 lds
    buffer_load_dwordx4 v112, s[24:27], s76 offen offset:2048 lds
    buffer_load_dwordx4 v113, s[24:27], s76 offen offset:3072 lds
    v_mul_u32_u24 v115, 33792, v114
    v_add_u32 v115, s73, v115
    v_lshl_add_u32 v118, v0, 3, s73
    v_add_u32 v119, 4252, v118
    v_bfe_u32 v120, v0, 1, 1
    v_mul_u32_u24 v120, 4224, v120
    v_and_b32 v121, 28, v0
    v_add3_u32 v120, v120, v121, v115
    v_mov_b32 v124, 0
    v_mov_b32 v125, 0
    v_mov_b32 v126, 0
    v_mov_b32 v127, 0
    ds_write_b32 v120, v124 offset:0
    s_and_b32 s74, s5, 1
    s_mul_i32 s74, s74, 17664
    s_lshr_b32 s75, s5, 1
    s_lshl_b32 s75, s75, 8
    s_add_u32 s74, s74, s75
    s_add_u32 s74, s74, 67584
    v_lshl_add_u32 v116, v0, 4, s74
    ds_write_b128 v116, v[124:127]
    s_lshl_b32 s76, s70, 15
    s_lshl_b32 s72, s5, 10
    s_add_u32 s76, s76, s72
    s_add_u32 s76, s76, 0x100000
    s_lshl_b32 s67, s3, 11
    s_add_u32 s67, s67, 0x14000
    s_and_b32 s74, s3, 6
    s_lshl_b32 s74, s74, 2
    s_lshr_b32 s75, s4, 3
    s_lshl_b32 s75, s75, 1
    s_add_u32 s74, s74, s75
    s_and_b32 s75, s3, 1
    s_add_u32 s74, s74, s75
    s_lshl_b32 s74, s74, 2
    s_add_u32 s74, s74, s5
    s_lshl_b32 s74, s74, 7
    s_add_u32 s57, s74, 0x30000
    s_and_b32 s75, s4, 7
    s_cselect_b32 s66, 0x7ff00000, s57
    v_bfe_u32 v210, v0, 3, 1
    v_lshrrev_b32 v211, 4, v225
    v_lshl_add_u32 v210, v210, 15, v211
    v_cmp_gt_u32 vcc, 16, v0
    s_xor_b32 s58, s2, 1
    s_lshl_b32 s58, s58, 2
    s_add_u32 s58, s58, s5
    s_mul_i32 s58, s58, 2560
    s_add_u32 s58, s58, 0x1198000
    v_cndmask_b32 v210, v231, v210, vcc
    v_cmp_gt_u32 vcc, 32, v0
    v_mov_b32 v252, 0
    v_mov_b32 v248, -1
    v_mov_b32 v253, 0
    v_mov_b32 v249, -1
    v_mov_b32 v254, 0
    v_mov_b32 v250, -1
    v_mov_b32 v255, 0
    v_mov_b32 v251, -1
    v_cndmask_b32 v212, v231, v1, vcc
    s_waitcnt lgkmcnt(0)
    s_mul_i32 s6, s7, 0x9E3779B1
    s_add_u32 s6, s6, 0x7F4A7C15
    s_or_b32 s6, s6, 1
    v_mov_b32 v226, s6
    s_mov_b32 s64, 0x3f803f80
    s_waitcnt vmcnt(16)
    v_dot2_f32_bf16 v40, v20, s64, 0
    v_dot2_f32_bf16 v41, v20, v20, 0
    v_dot2_f32_bf16 v40, v21, s64, v40
    v_dot2_f32_bf16 v41, v21, v21, v41
    v_dot2_f32_bf16 v40, v22, s64, v40
    v_dot2_f32_bf16 v41, v22, v22, v41
    v_dot2_f32_bf16 v40, v23, s64, v40
    v_dot2_f32_bf16 v41, v23, v23, v41
    s_waitcnt vmcnt(15)
    s_nop 0
    v_dot2_f32_bf16 v40, v24, s64, v40
    v_dot2_f32_bf16 v41, v24, v24, v41
    v_dot2_f32_bf16 v40, v25, s64, v40
    v_dot2_f32_bf16 v41, v25, v25, v41
    v_dot2_f32_bf16 v40, v26, s64, v40
    v_dot2_f32_bf16 v41, v26, v26, v41
    v_dot2_f32_bf16 v40, v27, s64, v40
    v_dot2_f32_bf16 v41, v27, v27, v41
    s_waitcnt vmcnt(14)
    v_dot2_f32_bf16 v40, v28, s64, v40
    v_dot2_f32_bf16 v41, v28, v28, v41
    v_dot2_f32_bf16 v40, v29, s64, v40
    v_dot2_f32_bf16 v41, v29, v29, v41
    s_nop 1
    v_add_f32_dpp v40, v40, v40 quad_perm:[1,0,3,2] row_mask:0xf bank_mask:0xf
    v_add_f32_dpp v41, v41, v41 quad_perm:[1,0,3,2] row_mask:0xf bank_mask:0xf
    s_nop 0
    v_add_f32_dpp v40, v40, v40 quad_perm:[2,3,0,1] row_mask:0xf bank_mask:0xf
    v_add_f32_dpp v41, v41, v41 quad_perm:[2,3,0,1] row_mask:0xf bank_mask:0xf
    s_nop 0
    v_add_f32_dpp v40, v40, v40 row_half_mirror row_mask:0xf bank_mask:0xf
    v_add_f32_dpp v41, v41, v41 row_half_mirror row_mask:0xf bank_mask:0xf
    s_nop 0
    v_add_f32_dpp v40, v40, v40 row_mirror row_mask:0xf bank_mask:0xf
    v_add_f32_dpp v41, v41, v41 row_mirror row_mask:0xf bank_mask:0xf
    v_mov_b32 v42, v40
    v_mov_b32 v43, v41
    s_nop 0
    v_permlane16_swap_b32 v40, v42
    v_permlane16_swap_b32 v41, v43
    v_add_f32 v40, v40, v42
    v_add_f32 v41, v41, v43
    v_mul_f32 v40, 0x3acccccd, v40
    v_mul_f32 v41, 0x3acccccd, v41
    v_fma_f32 v41, -v40, v40, v41
    v_max_f32 v41, 0, v41
    v_add_f32 v41, 0x3727c5ac, v41
    v_rsq_f32 v44, v41
    v_cmp_gt_u32 vcc, 2, v11
    v_lshlrev_b32 v48, 5, v39
    v_lshl_add_u32 v48, v11, 4, v48
    v_mov_b32 v46, v226
    v_mov_b32 v47, v226
    v_mul_f32 v45, -v40, v44
    s_lshl_b32 s64, s65, 2
    s_add_u32 s64, s64, s5
    v_cndmask_b32 v48, v231, v48, vcc
    s_lshl_b32 s64, s64, 6
    s_add_u32 s64, s64, 0x40000
    s_waitcnt vmcnt(9)
    s_barrier
    s_cmp_lg_u32 s5, 0
    s_cbranch_scc1 L_post4
    buffer_store_dword v226, v227, s[52:55], s0 offen
L_post4:
    buffer_store_dwordx4 v[44:47], v48, s[52:55], s64 offen sc1
    s_cmp_eq_u32 s71, 3
    s_cbranch_scc1 L_idle
    s_cmp_lg_u32 s56, 2
    s_cbranch_scc1 L_nw5
    s_add_u32 m0, s77, 0
    s_nop 0
    buffer_load_dwordx4 v240, s[40:43], s85 offen lds
    s_add_u32 m0, s77, 4096
    s_nop 0
    buffer_load_dwordx4 v241, s[40:43], s85 offen lds
    s_add_u32 m0, s77, 8192
    s_nop 0
    buffer_load_dwordx4 v242, s[40:43], s87 offen lds
    s_add_u32 m0, s77, 12288
    s_nop 0
    buffer_load_dwordx4 v243, s[40:43], s86 offen lds
    s_add_u32 m0, s77, 16384
    s_nop 0
    buffer_load_dwordx4 v244, s[40:43], s86 offen lds
    s_nop 1
L_nw5:
    s_cmp_lg_u32 s56, 1
    s_cbranch_scc1 L_nw6
    s_add_u32 m0, s77, 0
    s_nop 0
    buffer_load_dwordx4 v240, s[32:35], s84 offen lds
    s_add_u32 m0, s77, 4096
    s_nop 0
    buffer_load_dwordx4 v241, s[32:35], s84 offen lds
    s_add_u32 m0, s77, 8192
    s_nop 0
    buffer_load_dwordx4 v242, s[32:35], s84 offen lds
    s_add_u32 m0, s77, 12288
    s_nop 0
    buffer_load_dwordx4 v243, s[32:35], s84 offen lds
    s_add_u32 m0, s77, 16384
    s_nop 0
    buffer_load_dwordx4 v244, s[32:35], s84 offen lds
    s_add_u32 m0, s77, 20480
    s_nop 0
    buffer_load_dwordx4 v245, s[32:35], s84 offen lds
    s_add_u32 m0, s77, 24576
    s_nop 0
    buffer_load_dwordx4 v246, s[32:35], s84 offen lds
    s_nop 1
L_nw6:
    buffer_load_dword v4, v227, s[52:55], s0 offen sc1
    s_cmp_lg_u32 s5, 3
    s_cbranch_scc1 L_wk7
    s_mov_b64 exec, 0
    s_branch L_pad_cd_0
L_pad_cd_2:
    s_mov_b64 exec, -1
L_wk7:
    s_cmp_lg_u32 s5, 0
    s_cbranch_scc1 L_wk8
    s_mov_b64 exec, 0
    s_branch L_pad_m0_0
L_pad_m0_1:
    s_mov_b64 exec, -1
L_wk8:
    s_cmp_lg_u32 s5, 2
    s_cbranch_scc1 L_wk9
    s_mov_b64 exec, 0
    s_branch L_pad_m1_0
L_pad_m1_2:
    s_mov_b64 exec, -1
L_wk9:
    s_cmp_lg_u32 s5, 1
    s_cbranch_scc1 L_wk10
    s_mov_b64 exec, 0
    s_branch L_pad_m2_0
L_pad_m2_3:
    s_mov_b64 exec, -1
L_wk10:
    s_cmp_eq_u32 s71, 1
    s_cbranch_scc1 L_t1
    s_cmp_eq_u32 s71, 2
    s_cbranch_scc1 L_t2
    v_lshrrev_b32 v91, 4, v0
    v_bfe_u32 v92, v0, 2, 2
    v_and_b32 v93, 3, v0
    v_and_b32_e64 v94, 1, v92
    v_mul_u32_u24 v94, 4220, v94
    v_lshl_add_u32 v94, v91, 5, v94
    v_lshl_add_u32 v94, v93, 3, v94
    v_lshlrev_b32 v95, 2, v92
    v_sub_u32 v94, v94, v95
    s_add_u32 s75, s73, 16
    v_add_u32 v205, s75, v94
    v_bfe_u32 v94, v0, 1, 1
    v_lshl_add_u32 v94, v94, 2, v92
    v_sub_u32 v94, v94, v91
    v_and_b32 v96, 1, v0
    v_add_u32 v95, 10, v94
    v_bfe_u32 v97, v95, 1, 2
    v_xor_b32 v97, s5, v97
    v_lshlrev_b32_e64 v97, 4, v97
    v_lshl_add_u32 v97, v96, 6, v97
    v_lshl_add_u32 v97, v95, 7, v97
    v_add_u32 v206, 66816, v97
    v_add_u32 v95, 14, v94
    v_bfe_u32 v97, v95, 1, 2
    v_xor_b32 v97, s5, v97
    v_lshlrev_b32_e64 v97, 4, v97
    v_lshl_add_u32 v97, v96, 6, v97
    v_lshl_add_u32 v97, v95, 7, v97
    v_add_u32 v207, 66816, v97
    s_lshl_b32 s74, s5, 8
    s_add_u32 s74, s74, 102912
    v_lshl_add_u32 v208, v0, 2, s74
    s_lshl_b32 s74, s5, 11
    s_add_u32 s74, s74, 104960
    v_lshl_add_u32 v209, v0, 2, s74
    s_lshl_b32 s74, s5, 6
    s_add_u32 s74, s74, 4294967264
    v_add_u32 v98, s74, v0
    s_lshl_b32 s83, s70, 15
    s_add_u32 s83, s83, 0x390000
    s_mov_b32 s79, 0x40000
    s_lshl_b32 s68, s70, 4
    v_add_u32 v99, 0, v98
    v_max_i32 v100, 0, v99
    v_min_i32 v100, 1183, v100
    v_cmp_eq_u32 vcc, v99, v100
    v_lshlrev_b32 v220, 5, v100
    v_mul_u32_u24 v24, 1280, v100
    v_lshlrev_b32 v100, 4, v100
    v_cndmask_b32 v215, v231, v100, vcc
    v_add_u32 v99, 256, v98
    v_lshlrev_b32 v221, 5, v99
    v_lshlrev_b32 v216, 4, v99
    v_mul_u32_u24 v25, 1280, v99
    v_add_u32 v99, 512, v98
    v_lshlrev_b32 v222, 5, v99
    v_lshlrev_b32 v217, 4, v99
    v_mul_u32_u24 v26, 1280, v99
    v_add_u32 v99, 768, v98
    v_lshlrev_b32 v223, 5, v99
    v_lshlrev_b32 v218, 4, v99
    v_mul_u32_u24 v27, 1280, v99
    v_add_u32 v99, 1024, v98
    v_max_i32 v100, 0, v99
    v_min_i32 v100, 1183, v100
    v_cmp_eq_u32 vcc, v99, v100
    v_lshlrev_b32 v224, 5, v100
    v_mul_u32_u24 v28, 1280, v100
    v_lshlrev_b32 v100, 4, v100
    v_cndmask_b32 v219, v231, v100, vcc
    buffer_load_dwordx4 v[132:135], v24, s[8:11], s68 offen
    s_waitcnt vmcnt(3)
    ds_read_b32 v116, v115 offset:32
    v_lshlrev_b32 v117, 16, v117
    s_waitcnt lgkmcnt(0)
    v_lshlrev_b32 v123, 16, v116
    v_add_f32 v123, v117, v123
    v_and_b32 v116, 0xffff0000, v116
    v_cvt_pk_bf16_f32 v123, v123, v116
    ds_write_b32 v115, v123 offset:32
    ds_read_b64 v[56:57], v118 offset:32
    ds_read_b64 v[58:59], v118 offset:544
    ds_read_b64 v[60:61], v118 offset:1056
    ds_read_b64 v[62:63], v118 offset:1568
    ds_read_b64 v[64:65], v118 offset:2080
    ds_read_b64 v[66:67], v118 offset:2592
    ds_read_b64 v[68:69], v118 offset:3104
    ds_read_b64 v[70:71], v118 offset:3616
    ds_read_b64 v[72:73], v118 offset:33824
    ds_read_b64 v[74:75], v118 offset:34336
    ds_read_b64 v[76:77], v118 offset:34848
    ds_read_b64 v[78:79], v118 offset:35360
    ds_read_b64 v[80:81], v118 offset:35872
    ds_read_b64 v[82:83], v118 offset:36384
    ds_read_b64 v[84:85], v118 offset:36896
    ds_read_b64 v[86:87], v118 offset:37408
    s_waitcnt lgkmcnt(8)
    s_nop 0
    ds_write2_b32 v119, v56, v57 offset0:0 offset1:1
    ds_write2_b32 v119, v58, v59 offset0:128 offset1:129
    v_add_u32 v119, 1024, v119
    ds_write2_b32 v119, v60, v61 offset0:0 offset1:1
    ds_write2_b32 v119, v62, v63 offset0:128 offset1:129
    v_add_u32 v119, 1024, v119
    ds_write2_b32 v119, v64, v65 offset0:0 offset1:1
    ds_write2_b32 v119, v66, v67 offset0:128 offset1:129
    v_add_u32 v119, 1024, v119
    ds_write2_b32 v119, v68, v69 offset0:0 offset1:1
    ds_write2_b32 v119, v70, v71 offset0:128 offset1:129
    v_add_u32 v119, 30720, v119
    s_waitcnt lgkmcnt(8)
    s_nop 0
    ds_write2_b32 v119, v72, v73 offset0:0 offset1:1
    ds_write2_b32 v119, v74, v75 offset0:128 offset1:129
    v_add_u32 v119, 1024, v119
    ds_write2_b32 v119, v76, v77 offset0:0 offset1:1
    ds_write2_b32 v119, v78, v79 offset0:128 offset1:129
    v_add_u32 v119, 1024, v119
    ds_write2_b32 v119, v80, v81 offset0:0 offset1:1
    ds_write2_b32 v119, v82, v83 offset0:128 offset1:129
    v_add_u32 v119, 1024, v119
    ds_write2_b32 v119, v84, v85 offset0:0 offset1:1
    ds_write2_b32 v119, v86, v87 offset0:128 offset1:129
    s_cmp_lg_u32 s5, 1
    s_cbranch_scc1 L_wk11
    s_mov_b64 exec, 0
    s_branch L_pad_t0_0
L_pad_t0_1:
    s_mov_b64 exec, -1
L_wk11:
    s_cmp_lg_u32 s5, 0
    s_cbranch_scc1 L_post12
    buffer_store_dword v226, v227, s[52:55], s1 offen
L_post12:
    s_cmp_lg_u32 s5, 0
    s_cbranch_scc1 L_polld14
    s_mov_b64 s[90:91], 0
    s_mov_b32 s92, 0
    s_waitcnt vmcnt(0)
    buffer_load_dword v31, v214, s[52:55], s67 offen sc1
    buffer_load_dword v30, v214, s[52:55], s67 offen sc1
L_poll13:
    buffer_load_dword v3, v214, s[52:55], s67 offen sc1
    s_add_u32 s92, s92, 1
    s_waitcnt vmcnt(2)
    v_cmp_eq_u32 vcc, s6, v31
    s_nop 0
    s_or_b64 s[90:91], s[90:91], vcc
    s_cmp_eq_u64 s[90:91], -1
    s_cbranch_scc1 L_polld14
    buffer_load_dword v31, v214, s[52:55], s67 offen sc1
    s_waitcnt vmcnt(2)
    v_cmp_eq_u32 vcc, s6, v30
    s_nop 0
    s_or_b64 s[90:91], s[90:91], vcc
    s_cmp_eq_u64 s[90:91], -1
    s_cbranch_scc1 L_polld14
    s_cmp_lg_u32 s92, 64
    s_cbranch_scc1 L_polln15
    s_xor_b32 s93, s0, 0x8000
    buffer_store_dword v226, v227, s[52:55], s93 offen sc1
L_polln15:
    buffer_load_dword v30, v214, s[52:55], s67 offen sc1
    s_waitcnt vmcnt(2)
    v_cmp_eq_u32 vcc, s6, v3
    s_nop 0
    s_or_b64 s[90:91], s[90:91], vcc
    s_cmp_eq_u64 s[90:91], -1
    s_cbranch_scc1 L_polld14
    s_cmp_lt_u32 s92, 0x200000
    s_cbranch_scc1 L_poll13
L_polld14:
    s_waitcnt vmcnt(1)
    s_barrier
    s_add_u32 m0, s72, 68864
    s_add_u32 s75, s76, 0
    s_nop 0
    buffer_load_dwordx4 v1, s[52:55], s75 offen sc1 lds
    s_add_u32 m0, s72, 72960
    s_add_u32 s75, s76, 4096
    buffer_load_dwordx4 v1, s[52:55], s75 offen sc1 lds
    s_add_u32 m0, s72, 77056
    s_add_u32 s75, s76, 8192
    buffer_load_dwordx4 v1, s[52:55], s75 offen sc1 lds
    s_add_u32 m0, s72, 86528
    s_add_u32 s75, s76, 16384
    buffer_load_dwordx4 v1, s[52:55], s75 offen sc1 lds
    s_add_u32 m0, s72, 90624
    s_add_u32 s75, s76, 20480
    buffer_load_dwordx4 v1, s[52:55], s75 offen sc1 lds
    s_add_u32 m0, s72, 94720
    s_add_u32 s75, s76, 24576
    buffer_load_dwordx4 v1, s[52:55], s75 offen sc1 lds
    buffer_load_dwordx4 v[152:155], v220, s[52:55], s79 offen sc1
    buffer_load_dwordx4 v[156:159], v221, s[52:55], s79 offen sc1
    buffer_load_dwordx4 v[160:163], v222, s[52:55], s79 offen sc1
    buffer_load_dwordx4 v[164:167], v223, s[52:55], s79 offen sc1
    buffer_load_dwordx4 v[168:171], v224, s[52:55], s79 offen sc1
    s_mov_b32 s80, s77
    s_add_u32 s67, s67, 0x4000
    s_and_b32 s60, s3, 1
    s_lshl_b32 s60, s60, 3
    s_and_b32 s61, s4, 7
    s_add_u32 s60, s60, s61
    s_mul_i32 s61, s60, 143360
    s_add_u32 s61, s61, 0xd10000
    s_lshl_b32 s63, s5, 10
    s_add_u32 s62, s61, s63
    s_lshl_b32 s77, s5, 12
    s_add_u32 s75, s61, s77
    s_waitcnt vmcnt(10)
    s_waitcnt lgkmcnt(0)
    s_barrier
    ds_read_b64_tr_b16 v[40:41], v205 offset:16
    ds_read_b64_tr_b16 v[42:43], v205 offset:0
    ds_read_b128 v[44:47], v206 offset:0
    ds_read_b64_tr_b16 v[48:49], v205 offset:144
    ds_read_b64_tr_b16 v[50:51], v205 offset:128
    ds_read_b128 v[52:55], v207 offset:0
    ds_read_b128 v[56:59], v206 offset:1024
    ds_read_b64_tr_b16 v[60:61], v205 offset:272
    ds_read_b64_tr_b16 v[62:63], v205 offset:256
    ds_read_b128 v[64:67], v207 offset:1024
    ds_read_b64_tr_b16 v[68:69], v205 offset:400
    ds_read_b64_tr_b16 v[70:71], v205 offset:384
    ds_read_b128 v[72:75], v206 offset:2048
    ds_read_b64_tr_b16 v[76:77], v205 offset:528
    ds_read_b64_tr_b16 v[78:79], v205 offset:512
    s_waitcnt lgkmcnt(12)
    v_mfma_f32_16x16x32_bf16 v[32:35], v[44:47], v[40:43], 0
    ds_read_b128 v[80:83], v207 offset:2048
    ds_read_b64_tr_b16 v[84:85], v205 offset:656
    ds_read_b64_tr_b16 v[86:87], v205 offset:640
    s_waitcnt lgkmcnt(12)
    v_mfma_f32_16x16x32_bf16 v[36:39], v[52:55], v[48:51], 0
    ds_read_b128 v[88:91], v206 offset:3072
    ds_read_b64_tr_b16 v[92:93], v205 offset:784
    ds_read_b64_tr_b16 v[94:95], v205 offset:768
    s_waitcnt lgkmcnt(14)
    v_mfma_f32_16x16x32_bf16 v[36:39], v[56:59], v[40:43], v[36:39]
    ds_read_b128 v[96:99], v207 offset:3072
    ds_read_b64_tr_b16 v[100:101], v205 offset:912
    ds_read_b64_tr_b16 v[102:103], v205 offset:896
    s_waitcnt lgkmcnt(15)
    v_mfma_f32_16x16x32_bf16 v[36:39], v[44:47], v[60:63], v[36:39]
    v_mfma_f32_16x16x32_bf16 v[112:115], v[56:59], v[60:63], 0
    buffer_store_dwordx4 v[252:255], v210, s[52:55], s66 offen sc1
    s_waitcnt lgkmcnt(14)
    v_mfma_f32_16x16x32_bf16 v[112:115], v[64:67], v[48:51], v[112:115]
    v_add_f32_dpp v128, v33, v32 wave_shr:1 row_mask:0xf bank_mask:0xf bound_ctrl:0
    v_add_f32_dpp v129, v33, v34 wave_ror:1 row_mask:0xf bank_mask:0xf
    s_waitcnt lgkmcnt(12)
    v_mfma_f32_16x16x32_bf16 v[112:115], v[52:55], v[68:71], v[112:115]
    v_add_f32_dpp v129, v35, v34 wave_shr:1 row_mask:0xf bank_mask:0xf
    ds_write2st64_b32 v208, v128, v129 offset0:0 offset1:8
    s_waitcnt lgkmcnt(12)
    v_mfma_f32_16x16x32_bf16 v[112:115], v[72:75], v[40:43], v[112:115]
    s_waitcnt lgkmcnt(10)
    v_mfma_f32_16x16x32_bf16 v[112:115], v[44:47], v[76:79], v[112:115]
    v_add_f32_dpp v130, v35, v36 wave_ror:1 row_mask:0xf bank_mask:0xf
    v_add_f32_dpp v131, v37, v38 wave_ror:1 row_mask:0xf bank_mask:0xf
    v_mfma_f32_16x16x32_bf16 v[116:119], v[64:67], v[68:71], 0
    v_add_f32_dpp v130, v37, v36 wave_shr:1 row_mask:0xf bank_mask:0xf
    v_add_f32_dpp v131, v39, v38 wave_shr:1 row_mask:0xf bank_mask:0xf
    v_mfma_f32_16x16x32_bf16 v[116:119], v[72:75], v[60:63], v[116:119]
    buffer_load_dwordx4 v[136:139], v25, s[8:11], s68 offen
    ds_write2st64_b32 v208, v130, v131 offset0:16 offset1:24
    v_mfma_f32_16x16x32_bf16 v[116:119], v[56:59], v[76:79], v[116:119]
    s_waitcnt lgkmcnt(2)
    v_mfma_f32_16x16x32_bf16 v[116:119], v[80:83], v[48:51], v[116:119]
    v_mfma_f32_16x16x32_bf16 v[116:119], v[52:55], v[84:87], v[116:119]
    v_add_f32_dpp v128, v39, v112 wave_ror:1 row_mask:0xf bank_mask:0xf
    v_add_f32_dpp v129, v113, v114 wave_ror:1 row_mask:0xf bank_mask:0xf
    v_mfma_f32_16x16x32_bf16 v[116:119], v[88:91], v[40:43], v[116:119]
    v_add_f32_dpp v128, v113, v112 wave_shr:1 row_mask:0xf bank_mask:0xf
    v_add_f32_dpp v129, v115, v114 wave_shr:1 row_mask:0xf bank_mask:0xf
    v_mfma_f32_16x16x32_bf16 v[116:119], v[44:47], v[92:95], v[116:119]
    s_waitcnt vmcnt(10)
    s_barrier
    ds_read_b128 v[104:107], v206 offset:4096
    v_mfma_f32_16x16x32_bf16 v[120:123], v[72:75], v[76:79], 0
    ds_read_b64_tr_b16 v[108:109], v205 offset:1040
    ds_read_b64_tr_b16 v[110:111], v205 offset:1024
    v_mfma_f32_16x16x32_bf16 v[120:123], v[80:83], v[68:71], v[120:123]
    ds_write2st64_b32 v208, v128, v129 offset0:32 offset1:40
    ds_read_b128 a[160:163], v207 offset:4096
    v_mfma_f32_16x16x32_bf16 v[120:123], v[64:67], v[84:87], v[120:123]
    ds_read_b64_tr_b16 a[164:165], v205 offset:1168
    ds_read_b64_tr_b16 a[166:167], v205 offset:1152
    v_mfma_f32_16x16x32_bf16 v[120:123], v[88:91], v[60:63], v[120:123]
    ds_read_b128 a[168:171], v206 offset:5120
    ds_read_b64_tr_b16 a[172:173], v205 offset:1296
    ds_read_b64_tr_b16 a[174:175], v205 offset:1280
    v_mfma_f32_16x16x32_bf16 v[120:123], v[56:59], v[92:95], v[120:123]
    buffer_load_dwordx4 v[140:143], v26, s[8:11], s68 offen
    v_add_f32_dpp v130, v115, v116 wave_ror:1 row_mask:0xf bank_mask:0xf
    v_mfma_f32_16x16x32_bf16 v[120:123], v[96:99], v[48:51], v[120:123]
    v_add_f32_dpp v131, v117, v118 wave_ror:1 row_mask:0xf bank_mask:0xf
    v_add_f32_dpp v130, v117, v116 wave_shr:1 row_mask:0xf bank_mask:0xf
    v_mfma_f32_16x16x32_bf16 v[120:123], v[52:55], v[100:103], v[120:123]
    v_add_f32_dpp v131, v119, v118 wave_shr:1 row_mask:0xf bank_mask:0xf
    ds_write2st64_b32 v208, v130, v131 offset0:48 offset1:56
    s_waitcnt lgkmcnt(10)
    v_mfma_f32_16x16x32_bf16 v[120:123], v[104:107], v[40:43], v[120:123]
    ds_read_b128 a[176:179], v207 offset:5120
    ds_read_b64_tr_b16 a[180:181], v205 offset:1424
    ds_read_b64_tr_b16 a[182:183], v205 offset:1408
    s_waitcnt lgkmcnt(11)
    v_mfma_f32_16x16x32_bf16 v[120:123], v[44:47], v[108:111], v[120:123]
    ds_read_b128 a[184:187], v206 offset:6144
    ds_read_b64_tr_b16 a[188:189], v205 offset:1552
    ds_read_b64_tr_b16 a[190:191], v205 offset:1536
    v_mfma_f32_16x16x32_bf16 v[124:127], v[80:83], v[84:87], 0
    v_mfma_f32_16x16x32_bf16 v[124:127], v[88:91], v[76:79], v[124:127]
    v_mfma_f32_16x16x32_bf16 v[124:127], v[72:75], v[92:95], v[124:127]
    v_mfma_f32_16x16x32_bf16 v[124:127], v[96:99], v[68:71], v[124:127]
    v_mfma_f32_16x16x32_bf16 v[124:127], v[64:67], v[100:103], v[124:127]
    v_add_f32_dpp v128, v119, v120 wave_ror:1 row_mask:0xf bank_mask:0xf
    v_add_f32_dpp v129, v121, v122 wave_ror:1 row_mask:0xf bank_mask:0xf
    v_mfma_f32_16x16x32_bf16 v[124:127], v[104:107], v[60:63], v[124:127]
    buffer_load_dwordx4 v[144:147], v27, s[8:11], s68 offen
    v_add_f32_dpp v128, v121, v120 wave_shr:1 row_mask:0xf bank_mask:0xf
    v_mfma_f32_16x16x32_bf16 v[124:127], v[56:59], v[108:111], v[124:127]
    v_add_f32_dpp v129, v123, v122 wave_shr:1 row_mask:0xf bank_mask:0xf
    ds_write2st64_b32 v208, v128, v129 offset0:64 offset1:72
    s_waitcnt lgkmcnt(5)
    v_mfma_f32_16x16x32_bf16 v[124:127], a[160:163], v[48:51], v[124:127]
    v_mfma_f32_16x16x32_bf16 v[124:127], v[52:55], a[164:167], v[124:127]
    v_mfma_f32_16x16x32_bf16 v[124:127], a[168:171], v[40:43], v[124:127]
    v_mfma_f32_16x16x32_bf16 v[124:127], v[44:47], a[172:175], v[124:127]
    v_mfma_f32_16x16x32_bf16 v[4:7], v[88:91], v[92:95], 0
    ds_read_b128 a[192:195], v207 offset:6144
    v_mfma_f32_16x16x32_bf16 v[4:7], v[96:99], v[84:87], v[4:7]
    ds_read_b64_tr_b16 a[196:197], v205 offset:1680
    ds_read_b64_tr_b16 a[198:199], v205 offset:1664
    v_mfma_f32_16x16x32_bf16 v[4:7], v[80:83], v[100:103], v[4:7]
    ds_read_b128 a[200:203], v206 offset:7168
    v_mfma_f32_16x16x32_bf16 v[4:7], v[104:107], v[76:79], v[4:7]
    ds_read_b64_tr_b16 a[204:205], v205 offset:1808
    ds_read_b64_tr_b16 a[206:207], v205 offset:1792
    v_mfma_f32_16x16x32_bf16 v[4:7], v[72:75], v[108:111], v[4:7]
    v_add_f32_dpp v130, v123, v124 wave_ror:1 row_mask:0xf bank_mask:0xf
    v_add_f32_dpp v131, v125, v126 wave_ror:1 row_mask:0xf bank_mask:0xf
    v_mfma_f32_16x16x32_bf16 v[4:7], a[160:163], v[68:71], v[4:7]
    v_add_f32_dpp v130, v125, v124 wave_shr:1 row_mask:0xf bank_mask:0xf
    v_add_f32_dpp v131, v127, v126 wave_shr:1 row_mask:0xf bank_mask:0xf
    v_mfma_f32_16x16x32_bf16 v[4:7], v[64:67], a[164:167], v[4:7]
    ds_write2st64_b32 v208, v130, v131 offset0:80 offset1:88
    v_mfma_f32_16x16x32_bf16 v[4:7], a[168:171], v[60:63], v[4:7]
    v_mfma_f32_16x16x32_bf16 v[4:7], v[56:59], a[172:175], v[4:7]
    v_mfma_f32_16x16x32_bf16 v[4:7], a[176:179], v[48:51], v[4:7]
    s_waitcnt lgkmcnt(4)
    v_mfma_f32_16x16x32_bf16 v[4:7], v[52:55], a[180:183], v[4:7]
    v_mfma_f32_16x16x32_bf16 v[4:7], a[184:187], v[40:43], v[4:7]
    v_mfma_f32_16x16x32_bf16 v[4:7], v[44:47], a[188:191], v[4:7]
    v_mfma_f32_16x16x32_bf16 v[8:11], v[96:99], v[100:103], 0
    v_mfma_f32_16x16x32_bf16 v[8:11], v[104:107], v[92:95], v[8:11]
    v_mfma_f32_16x16x32_bf16 v[8:11], v[88:91], v[108:111], v[8:11]
    v_mfma_f32_16x16x32_bf16 v[8:11], a[160:163], v[84:87], v[8:11]
    v_mfma_f32_16x16x32_bf16 v[8:11], v[80:83], a[164:167], v[8:11]
    s_nop 2
    v_add_f32_dpp v128, v127, v4 wave_ror:1 row_mask:0xf bank_mask:0xf
    v_add_f32_dpp v129, v5, v6 wave_ror:1 row_mask:0xf bank_mask:0xf
    v_mfma_f32_16x16x32_bf16 v[8:11], a[168:171], v[76:79], v[8:11]
    v_add_f32_dpp v128, v5, v4 wave_shr:1 row_mask:0xf bank_mask:0xf
    v_add_f32_dpp v129, v7, v6 wave_shr:1 row_mask:0xf bank_mask:0xf
    v_mfma_f32_16x16x32_bf16 v[8:11], v[72:75], a[172:175], v[8:11]
    ds_write2st64_b32 v208, v128, v129 offset0:96 offset1:104
    ds_read_b128 a[208:211], v207 offset:7168
    v_mfma_f32_16x16x32_bf16 v[8:11], a[176:179], v[68:71], v[8:11]
    ds_read_b64_tr_b16 a[212:213], v205 offset:1936
    ds_read_b64_tr_b16 a[214:215], v205 offset:1920
    v_mfma_f32_16x16x32_bf16 v[8:11], v[64:67], a[180:183], v[8:11]
    ds_read_b128 a[216:219], v206 offset:8192
    ds_read_b64_tr_b16 a[220:221], v205 offset:2064
    ds_read_b64_tr_b16 a[222:223], v205 offset:2048
    v_mfma_f32_16x16x32_bf16 v[8:11], a[184:187], v[60:63], v[8:11]
    v_mfma_f32_16x16x32_bf16 v[8:11], v[56:59], a[188:191], v[8:11]
    v_mfma_f32_16x16x32_bf16 v[8:11], a[192:195], v[48:51], v[8:11]
    buffer_load_dwordx4 v[148:151], v28, s[8:11], s68 offen
    s_waitcnt vmcnt(10)
    s_barrier
    v_mfma_f32_16x16x32_bf16 v[8:11], v[52:55], a[196:199], v[8:11]
    s_waitcnt lgkmcnt(7)
    v_mfma_f32_16x16x32_bf16 v[8:11], a[200:203], v[40:43], v[8:11]
    v_mfma_f32_16x16x32_bf16 v[8:11], v[44:47], a[204:207], v[8:11]
    v_mfma_f32_16x16x32_bf16 v[12:15], v[104:107], v[108:111], 0
    buffer_load_dword v23, v227, s[52:55], s66 offen sc1
    v_mfma_f32_16x16x32_bf16 v[12:15], a[160:163], v[100:103], v[12:15]
    v_mfma_f32_16x16x32_bf16 v[12:15], v[96:99], a[164:167], v[12:15]
    v_mfma_f32_16x16x32_bf16 v[12:15], a[168:171], v[92:95], v[12:15]
    v_mfma_f32_16x16x32_bf16 v[12:15], v[88:91], a[172:175], v[12:15]
    s_nop 1
    v_add_f32_dpp v130, v7, v8 wave_ror:1 row_mask:0xf bank_mask:0xf
    v_add_f32_dpp v131, v9, v10 wave_ror:1 row_mask:0xf bank_mask:0xf
    v_mfma_f32_16x16x32_bf16 v[12:15], a[176:179], v[84:87], v[12:15]
    v_add_f32_dpp v130, v9, v8 wave_shr:1 row_mask:0xf bank_mask:0xf
    v_add_f32_dpp v131, v11, v10 wave_shr:1 row_mask:0xf bank_mask:0xf
    v_mfma_f32_16x16x32_bf16 v[12:15], v[80:83], a[180:183], v[12:15]
    s_waitcnt vmcnt(10)
    v_xor_b32 v30, s6, v154
    s_waitcnt vmcnt(9)
    v_bitop3_b32 v30, v30, v158, s6 bitop3:0xf6
    s_waitcnt vmcnt(8)
    v_bitop3_b32 v30, v30, v162, s6 bitop3:0xf6
    s_waitcnt vmcnt(7)
    v_bitop3_b32 v30, v30, v166, s6 bitop3:0xf6
    s_waitcnt vmcnt(6)
L_pad_t0_0:
    s_cbranch_execz L_pad_t0_1
    v_bitop3_b32 v30, v30, v170, s6 bitop3:0xf6
    v_cmp_ne_u32 vcc, 0, v30
    s_nop 0
    s_cmp_eq_u64 vcc, 0
    s_cbranch_scc0 L_stf18
L_sto17:
    ds_write2st64_b32 v208, v130, v131 offset0:112 offset1:120
    v_mfma_f32_16x16x32_bf16 v[12:15], a[184:187], v[76:79], v[12:15]
    v_mfma_f32_16x16x32_bf16 v[12:15], v[72:75], a[188:191], v[12:15]
    ds_read_b128 a[224:227], v207 offset:8192
    v_mfma_f32_16x16x32_bf16 v[12:15], a[192:195], v[68:71], v[12:15]
    ds_read_b64_tr_b16 a[228:229], v205 offset:2192
    ds_read_b64_tr_b16 a[230:231], v205 offset:2176
    v_mfma_f32_16x16x32_bf16 v[12:15], v[64:67], a[196:199], v[12:15]
    ds_read_b128 a[232:235], v206 offset:9216
    v_mfma_f32_16x16x32_bf16 v[12:15], a[200:203], v[60:63], v[12:15]
    ds_read_b64_tr_b16 a[236:237], v205 offset:2320
    ds_read_b64_tr_b16 a[238:239], v205 offset:2304
    v_mfma_f32_16x16x32_bf16 v[12:15], v[56:59], a[204:207], v[12:15]
    ds_read_b64_tr_b16 a[240:241], v205 offset:33808
    ds_read_b64_tr_b16 a[242:243], v205 offset:33792
    s_waitcnt lgkmcnt(9)
    v_mfma_f32_16x16x32_bf16 v[12:15], a[208:211], v[48:51], v[12:15]
    ds_read_b128 a[244:247], v206 offset:17664
    ds_read_b64_tr_b16 a[248:249], v205 offset:33936
    ds_read_b64_tr_b16 a[250:251], v205 offset:33920
    v_mfma_f32_16x16x32_bf16 v[12:15], v[52:55], a[212:215], v[12:15]
    ds_read_b128 a[252:255], v207 offset:17664
    v_mfma_f32_16x16x32_bf16 v[12:15], a[216:219], v[40:43], v[12:15]
    v_mfma_f32_16x16x32_bf16 v[12:15], v[44:47], a[220:223], v[12:15]
    v_mfma_f32_16x16x32_bf16 v[16:19], a[160:163], a[164:167], 0
    ds_read_b128 a[160:163], v206 offset:18688
    ds_read_b64_tr_b16 a[164:165], v205 offset:34064
    ds_read_b64_tr_b16 a[166:167], v205 offset:34048
    v_mfma_f32_16x16x32_bf16 v[16:19], a[168:171], v[108:111], v[16:19]
    ds_read_b128 a[168:171], v207 offset:18688
    ds_read_b64_tr_b16 v[108:109], v205 offset:34192
    ds_read_b64_tr_b16 v[110:111], v205 offset:34176
    v_mfma_f32_16x16x32_bf16 v[16:19], v[104:107], a[172:175], v[16:19]
    ds_read_b128 v[104:107], v206 offset:19712
    v_mfma_f32_16x16x32_bf16 v[16:19], a[176:179], v[100:103], v[16:19]
    ds_read_b64_tr_b16 a[172:173], v205 offset:34320
    ds_read_b64_tr_b16 a[174:175], v205 offset:34304
    v_mfma_f32_16x16x32_bf16 v[16:19], v[96:99], a[180:183], v[16:19]
    v_add_f32_dpp v128, v11, v12 wave_ror:1 row_mask:0xf bank_mask:0xf
    v_add_f32_dpp v129, v13, v14 wave_ror:1 row_mask:0xf bank_mask:0xf
    v_mfma_f32_16x16x32_bf16 v[16:19], a[184:187], v[92:95], v[16:19]
    v_add_f32_dpp v128, v13, v12 wave_shr:1 row_mask:0xf bank_mask:0xf
    v_add_f32_dpp v129, v15, v14 wave_shr:1 row_mask:0xf bank_mask:0xf
    v_mfma_f32_16x16x32_bf16 v[16:19], v[88:91], a[188:191], v[16:19]
    ds_write2st64_b32 v208, v128, v129 offset0:128 offset1:136
    v_mfma_f32_16x16x32_bf16 v[16:19], a[192:195], v[84:87], v[16:19]
    ds_read_b128 a[176:179], v207 offset:19712
    v_mfma_f32_16x16x32_bf16 v[16:19], v[80:83], a[196:199], v[16:19]
    ds_read_b64_tr_b16 v[100:101], v205 offset:34448
    ds_read_b64_tr_b16 v[102:103], v205 offset:34432
    v_mfma_f32_16x16x32_bf16 v[16:19], a[200:203], v[76:79], v[16:19]
    ds_read_b128 v[96:99], v206 offset:20736
    v_mfma_f32_16x16x32_bf16 v[16:19], v[72:75], a[204:207], v[16:19]
    ds_read_b64_tr_b16 a[180:181], v205 offset:34576
    ds_read_b64_tr_b16 a[182:183], v205 offset:34560
    v_mfma_f32_16x16x32_bf16 v[16:19], a[208:211], v[68:71], v[16:19]
    v_mfma_f32_16x16x32_bf16 v[16:19], v[64:67], a[212:215], v[16:19]
    v_mfma_f32_16x16x32_bf16 v[16:19], a[216:219], v[60:63], v[16:19]
    v_mfma_f32_16x16x32_bf16 v[16:19], v[56:59], a[220:223], v[16:19]
    s_waitcnt lgkmcnt(6)
    v_mfma_f32_16x16x32_bf16 v[16:19], a[224:227], v[48:51], v[16:19]
    v_mfma_f32_16x16x32_bf16 v[16:19], v[52:55], a[228:231], v[16:19]
    ds_read_b128 a[184:187], v207 offset:20736
    v_mfma_f32_16x16x32_bf16 v[16:19], a[232:235], v[40:43], v[16:19]
    ds_read_b64_tr_b16 v[92:93], v205 offset:34704
    ds_read_b64_tr_b16 v[94:95], v205 offset:34688
    v_mfma_f32_16x16x32_bf16 v[16:19], v[44:47], a[236:239], v[16:19]
    ds_read_b128 v[88:91], v206 offset:21760
    v_mfma_f32_16x16x32_bf16 v[32:35], a[244:247], a[240:243], 0
    ds_read_b64_tr_b16 a[188:189], v205 offset:34832
    ds_read_b64_tr_b16 a[190:191], v205 offset:34816
    v_mfma_f32_16x16x32_bf16 v[36:39], a[252:255], a[248:251], 0
    v_mfma_f32_16x16x32_bf16 v[36:39], a[160:163], a[240:243], v[36:39]
    v_mfma_f32_16x16x32_bf16 v[36:39], a[244:247], a[164:167], v[36:39]
    v_mfma_f32_16x16x32_bf16 v[112:115], a[160:163], a[164:167], 0
    v_add_f32_dpp v130, v15, v16 wave_ror:1 row_mask:0xf bank_mask:0xf
    v_add_f32_dpp v131, v17, v18 wave_ror:1 row_mask:0xf bank_mask:0xf
    v_mfma_f32_16x16x32_bf16 v[112:115], a[168:171], a[248:251], v[112:115]
    v_add_f32_dpp v130, v17, v16 wave_shr:1 row_mask:0xf bank_mask:0xf
    v_add_f32_dpp v131, v19, v18 wave_shr:1 row_mask:0xf bank_mask:0xf
    v_mfma_f32_16x16x32_bf16 v[112:115], a[252:255], v[108:111], v[112:115]
    ds_write2st64_b32 v208, v130, v131 offset0:144 offset1:152
    v_add_f32_dpp v128, v33, v32 wave_shr:1 row_mask:0xf bank_mask:0xf bound_ctrl:0
    v_mfma_f32_16x16x32_bf16 v[112:115], v[104:107], a[240:243], v[112:115]
    v_add_f32_dpp v129, v33, v34 wave_ror:1 row_mask:0xf bank_mask:0xf
    s_nop 1
    v_add_f32_dpp v129, v35, v34 wave_shr:1 row_mask:0xf bank_mask:0xf
    v_mfma_f32_16x16x32_bf16 v[112:115], a[244:247], a[172:175], v[112:115]
    ds_write2st64_b32 v208, v128, v129 offset0:4 offset1:12
    v_add_f32_dpp v130, v35, v36 wave_ror:1 row_mask:0xf bank_mask:0xf
    v_mfma_f32_16x16x32_bf16 v[116:119], a[168:171], v[108:111], 0
    v_add_f32_dpp v131, v37, v38 wave_ror:1 row_mask:0xf bank_mask:0xf
    v_add_f32_dpp v130, v37, v36 wave_shr:1 row_mask:0xf bank_mask:0xf
    v_mfma_f32_16x16x32_bf16 v[116:119], v[104:107], a[164:167], v[116:119]
    v_add_f32_dpp v131, v39, v38 wave_shr:1 row_mask:0xf bank_mask:0xf
    ds_write2st64_b32 v208, v130, v131 offset0:20 offset1:28
    v_mfma_f32_16x16x32_bf16 v[116:119], a[160:163], a[172:175], v[116:119]
    ds_read_b128 a[192:195], v207 offset:21760
    ds_read_b64_tr_b16 v[84:85], v205 offset:34960
    ds_read_b64_tr_b16 v[86:87], v205 offset:34944
    s_waitcnt lgkmcnt(6)
    v_mfma_f32_16x16x32_bf16 v[116:119], a[176:179], a[248:251], v[116:119]
    ds_read_b128 v[80:83], v206 offset:22784
    ds_read_b64_tr_b16 a[196:197], v205 offset:35088
    ds_read_b64_tr_b16 a[198:199], v205 offset:35072
    v_mfma_f32_16x16x32_bf16 v[116:119], a[252:255], v[100:103], v[116:119]
    v_add_f32_dpp v128, v39, v112 wave_ror:1 row_mask:0xf bank_mask:0xf
    v_add_f32_dpp v129, v113, v114 wave_ror:1 row_mask:0xf bank_mask:0xf
    v_mfma_f32_16x16x32_bf16 v[116:119], v[96:99], a[240:243], v[116:119]
    v_add_f32_dpp v128, v113, v112 wave_shr:1 row_mask:0xf bank_mask:0xf
    v_add_f32_dpp v129, v115, v114 wave_shr:1 row_mask:0xf bank_mask:0xf
    v_mfma_f32_16x16x32_bf16 v[116:119], a[244:247], a[180:183], v[116:119]
    ds_write2st64_b32 v208, v128, v129 offset0:36 offset1:44
    v_mfma_f32_16x16x32_bf16 v[120:123], v[104:107], a[172:175], 0
    v_mfma_f32_16x16x32_bf16 v[120:123], a[176:179], v[108:111], v[120:123]
    v_mfma_f32_16x16x32_bf16 v[120:123], a[168:171], v[100:103], v[120:123]
    v_mfma_f32_16x16x32_bf16 v[120:123], v[96:99], a[164:167], v[120:123]
    v_mfma_f32_16x16x32_bf16 v[120:123], a[160:163], a[180:183], v[120:123]
    s_nop 1
    v_add_f32_dpp v130, v115, v116 wave_ror:1 row_mask:0xf bank_mask:0xf
    v_add_f32_dpp v131, v117, v118 wave_ror:1 row_mask:0xf bank_mask:0xf
    v_mfma_f32_16x16x32_bf16 v[120:123], a[184:187], a[248:251], v[120:123]
    v_add_f32_dpp v130, v117, v116 wave_shr:1 row_mask:0xf bank_mask:0xf
    v_add_f32_dpp v131, v119, v118 wave_shr:1 row_mask:0xf bank_mask:0xf
    v_mfma_f32_16x16x32_bf16 v[120:123], a[252:255], v[92:95], v[120:123]
    ds_write2st64_b32 v208, v130, v131 offset0:52 offset1:60
    ds_read_b128 a[200:203], v207 offset:22784
    v_mfma_f32_16x16x32_bf16 v[120:123], v[88:91], a[240:243], v[120:123]
    ds_read_b64_tr_b16 v[76:77], v205 offset:35216
    ds_read_b64_tr_b16 v[78:79], v205 offset:35200
    v_mfma_f32_16x16x32_bf16 v[120:123], a[244:247], a[188:191], v[120:123]
    ds_read_b128 v[72:75], v206 offset:23808
    ds_read_b64_tr_b16 a[204:205], v205 offset:35344
    ds_read_b64_tr_b16 a[206:207], v205 offset:35328
    v_mfma_f32_16x16x32_bf16 v[124:127], a[176:179], v[100:103], 0
    v_mfma_f32_16x16x32_bf16 v[124:127], v[96:99], a[172:175], v[124:127]
    v_mfma_f32_16x16x32_bf16 v[124:127], v[104:107], a[180:183], v[124:127]
    v_mfma_f32_16x16x32_bf16 v[124:127], a[184:187], v[108:111], v[124:127]
    v_mfma_f32_16x16x32_bf16 v[124:127], a[168:171], v[92:95], v[124:127]
    v_add_f32_dpp v128, v119, v120 wave_ror:1 row_mask:0xf bank_mask:0xf
    v_add_f32_dpp v129, v121, v122 wave_ror:1 row_mask:0xf bank_mask:0xf
    v_mfma_f32_16x16x32_bf16 v[124:127], v[88:91], a[164:167], v[124:127]
    v_add_f32_dpp v128, v121, v120 wave_shr:1 row_mask:0xf bank_mask:0xf
    v_add_f32_dpp v129, v123, v122 wave_shr:1 row_mask:0xf bank_mask:0xf
    v_mfma_f32_16x16x32_bf16 v[124:127], a[160:163], a[188:191], v[124:127]
    ds_write2st64_b32 v208, v128, v129 offset0:68 offset1:76
    s_waitcnt lgkmcnt(4)
    v_mfma_f32_16x16x32_bf16 v[124:127], a[192:195], a[248:251], v[124:127]
    v_mfma_f32_16x16x32_bf16 v[124:127], a[252:255], v[84:87], v[124:127]
    v_mfma_f32_16x16x32_bf16 v[124:127], v[80:83], a[240:243], v[124:127]
    v_mfma_f32_16x16x32_bf16 v[124:127], a[244:247], a[196:199], v[124:127]
    v_mfma_f32_16x16x32_bf16 v[4:7], v[96:99], a[180:183], 0
    s_waitcnt lgkmcnt(0)
    s_barrier
    ds_read2st64_b32 v[172:173], v209 offset0:0 offset1:1
    v_mfma_f32_16x16x32_bf16 v[4:7], a[184:187], v[100:103], v[4:7]
    ds_read2st64_b32 v[174:175], v209 offset0:2 offset1:3
    ds_read2st64_b32 v[176:177], v209 offset0:4 offset1:5
    v_mfma_f32_16x16x32_bf16 v[4:7], a[176:179], v[92:95], v[4:7]
    ds_read2st64_b32 v[178:179], v209 offset0:6 offset1:7
    v_lshlrev_b32 v180, 16, v132
    v_mfma_f32_16x16x32_bf16 v[4:7], v[88:91], a[172:175], v[4:7]
    v_and_b32 v181, s69, v132
    v_lshlrev_b32 v182, 16, v133
    v_mfma_f32_16x16x32_bf16 v[4:7], v[104:107], a[188:191], v[4:7]
    v_and_b32 v183, s69, v133
    v_lshlrev_b32 v184, 16, v134
    v_mfma_f32_16x16x32_bf16 v[4:7], a[192:195], v[108:111], v[4:7]
    v_and_b32 v185, s69, v134
    v_lshlrev_b32 v186, 16, v135
    v_mfma_f32_16x16x32_bf16 v[4:7], a[168:171], v[84:87], v[4:7]
    v_and_b32 v187, s69, v135
    v_fma_f32 v188, v180, v152, v153
    v_mfma_f32_16x16x32_bf16 v[4:7], v[80:83], a[164:167], v[4:7]
    v_fma_f32 v189, v181, v152, v153
    v_fma_f32 v190, v182, v152, v153
    v_mfma_f32_16x16x32_bf16 v[4:7], a[160:163], a[196:199], v[4:7]
    v_fma_f32 v191, v183, v152, v153
    v_fma_f32 v192, v184, v152, v153
    v_mfma_f32_16x16x32_bf16 v[4:7], a[200:203], a[248:251], v[4:7]
    v_fma_f32 v193, v185, v152, v153
    v_fma_f32 v194, v186, v152, v153
    v_mfma_f32_16x16x32_bf16 v[4:7], a[252:255], v[76:79], v[4:7]
    v_fma_f32 v195, v187, v152, v153
    s_waitcnt lgkmcnt(3)
    v_fmac_f32 v180, v188, v172
    v_mfma_f32_16x16x32_bf16 v[4:7], v[72:75], a[240:243], v[4:7]
    v_fmac_f32 v181, v189, v173
    s_waitcnt lgkmcnt(2)
    v_fmac_f32 v182, v190, v174
    v_mfma_f32_16x16x32_bf16 v[4:7], a[244:247], a[204:207], v[4:7]
    v_fmac_f32 v183, v191, v175
    s_waitcnt lgkmcnt(1)
    v_fmac_f32 v184, v192, v176
    v_mfma_f32_16x16x32_bf16 v[8:11], a[184:187], v[92:95], 0
    v_fmac_f32 v185, v193, v177
    s_waitcnt lgkmcnt(0)
    v_fmac_f32 v186, v194, v178
    v_mfma_f32_16x16x32_bf16 v[8:11], v[88:91], a[180:183], v[8:11]
    v_fmac_f32 v187, v195, v179
    v_cvt_pk_bf16_f32 v196, v180, v181
    v_mfma_f32_16x16x32_bf16 v[8:11], v[96:99], a[188:191], v[8:11]
    v_cvt_pk_bf16_f32 v197, v182, v183
    v_cvt_pk_bf16_f32 v198, v184, v185
    v_mfma_f32_16x16x32_bf16 v[8:11], a[192:195], v[100:103], v[8:11]
    ds_read_b128 a[208:211], v207 offset:23808
    v_cvt_pk_bf16_f32 v199, v186, v187
    v_mfma_f32_16x16x32_bf16 v[8:11], a[176:179], v[84:87], v[8:11]
    ds_read_b64_tr_b16 v[68:69], v205 offset:35472
    ds_read_b64_tr_b16 v[70:71], v205 offset:35456
    v_mfma_f32_16x16x32_bf16 v[8:11], v[80:83], a[172:175], v[8:11]
    ds_read_b128 v[64:67], v206 offset:24832
    buffer_store_dwordx4 v[196:199], v215, s[52:55], s83 offen sc1
    v_mfma_f32_16x16x32_bf16 v[8:11], v[104:107], a[196:199], v[8:11]
    ds_read_b64_tr_b16 a[212:213], v205 offset:35600
    ds_read_b64_tr_b16 a[214:215], v205 offset:35584
    v_mfma_f32_16x16x32_bf16 v[8:11], a[200:203], v[108:111], v[8:11]
    ds_read2st64_b32 v[172:173], v209 offset0:32 offset1:33
    ds_read2st64_b32 v[174:175], v209 offset0:34 offset1:35
    v_mfma_f32_16x16x32_bf16 v[8:11], a[168:171], v[76:79], v[8:11]
    ds_read2st64_b32 v[176:177], v209 offset0:36 offset1:37
    ds_read2st64_b32 v[178:179], v209 offset0:38 offset1:39
    v_mfma_f32_16x16x32_bf16 v[8:11], v[72:75], a[164:167], v[8:11]
    s_waitcnt vmcnt(5)
    v_lshlrev_b32 v180, 16, v136
    v_and_b32 v181, s69, v136
    v_mfma_f32_16x16x32_bf16 v[8:11], a[160:163], a[204:207], v[8:11]
    v_lshlrev_b32 v182, 16, v137
    v_and_b32 v183, s69, v137
    s_waitcnt lgkmcnt(9)
    v_mfma_f32_16x16x32_bf16 v[8:11], a[208:211], a[248:251], v[8:11]
    v_lshlrev_b32 v184, 16, v138
    v_and_b32 v185, s69, v138
    s_waitcnt lgkmcnt(7)
    v_mfma_f32_16x16x32_bf16 v[8:11], a[252:255], v[68:71], v[8:11]
    v_lshlrev_b32 v186, 16, v139
    v_and_b32 v187, s69, v139
    s_waitcnt lgkmcnt(6)
    v_mfma_f32_16x16x32_bf16 v[8:11], v[64:67], a[240:243], v[8:11]
    v_fma_f32 v188, v180, v156, v157
    v_fma_f32 v189, v181, v156, v157
    s_waitcnt lgkmcnt(4)
    v_mfma_f32_16x16x32_bf16 v[8:11], a[244:247], a[212:215], v[8:11]
    v_fma_f32 v190, v182, v156, v157
    v_fma_f32 v191, v183, v156, v157
    v_mfma_f32_16x16x32_bf16 v[12:15], v[88:91], a[188:191], 0
    v_fma_f32 v192, v184, v156, v157
    v_fma_f32 v193, v185, v156, v157
    v_mfma_f32_16x16x32_bf16 v[12:15], a[192:195], v[92:95], v[12:15]
    v_fma_f32 v194, v186, v156, v157
    v_fma_f32 v195, v187, v156, v157
    v_mfma_f32_16x16x32_bf16 v[12:15], a[184:187], v[84:87], v[12:15]
    s_waitcnt lgkmcnt(3)
    v_fmac_f32 v180, v188, v172
    v_fmac_f32 v181, v189, v173
    v_mfma_f32_16x16x32_bf16 v[12:15], v[80:83], a[180:183], v[12:15]
    s_waitcnt lgkmcnt(2)
    v_fmac_f32 v182, v190, v174
    v_fmac_f32 v183, v191, v175
    v_mfma_f32_16x16x32_bf16 v[12:15], v[96:99], a[196:199], v[12:15]
    s_waitcnt lgkmcnt(1)
    v_fmac_f32 v184, v192, v176
    v_fmac_f32 v185, v193, v177
    v_mfma_f32_16x16x32_bf16 v[12:15], a[200:203], v[100:103], v[12:15]
    ds_read_b128 a[216:219], v207 offset:24832
    s_waitcnt lgkmcnt(1)
    v_fmac_f32 v186, v194, v178
    v_mfma_f32_16x16x32_bf16 v[12:15], a[176:179], v[76:79], v[12:15]
    ds_read_b64_tr_b16 v[60:61], v205 offset:35728
    ds_read_b64_tr_b16 v[62:63], v205 offset:35712
    v_mfma_f32_16x16x32_bf16 v[12:15], v[72:75], a[172:175], v[12:15]
    ds_read_b128 v[56:59], v206 offset:25856
    v_fmac_f32 v187, v195, v179
    v_mfma_f32_16x16x32_bf16 v[12:15], v[104:107], a[204:207], v[12:15]
    ds_read_b64_tr_b16 a[220:221], v205 offset:35856
    ds_read_b64_tr_b16 a[222:223], v205 offset:35840
    v_mfma_f32_16x16x32_bf16 v[12:15], a[208:211], v[108:111], v[12:15]
    v_cvt_pk_bf16_f32 v200, v180, v181
    v_cvt_pk_bf16_f32 v201, v182, v183
    v_mfma_f32_16x16x32_bf16 v[12:15], a[168:171], v[68:71], v[12:15]
    v_cvt_pk_bf16_f32 v202, v184, v185
    v_cvt_pk_bf16_f32 v203, v186, v187
    v_mfma_f32_16x16x32_bf16 v[12:15], v[64:67], a[164:167], v[12:15]
    buffer_store_dwordx4 v[200:203], v216, s[52:55], s83 offen sc1
    v_add_f32_dpp v130, v123, v124 wave_ror:1 row_mask:0xf bank_mask:0xf
    v_mfma_f32_16x16x32_bf16 v[12:15], a[160:163], a[212:215], v[12:15]
    v_add_f32_dpp v131, v125, v126 wave_ror:1 row_mask:0xf bank_mask:0xf
    v_add_f32_dpp v130, v125, v124 wave_shr:1 row_mask:0xf bank_mask:0xf
    s_waitcnt lgkmcnt(5)
    v_mfma_f32_16x16x32_bf16 v[12:15], a[216:219], a[248:251], v[12:15]
    v_add_f32_dpp v131, v127, v126 wave_shr:1 row_mask:0xf bank_mask:0xf
    ds_write2st64_b32 v208, v130, v131 offset0:84 offset1:92
    s_waitcnt lgkmcnt(4)
    v_mfma_f32_16x16x32_bf16 v[12:15], a[252:255], v[60:63], v[12:15]
    v_add_f32_dpp v128, v127, v4 wave_ror:1 row_mask:0xf bank_mask:0xf
    v_add_f32_dpp v129, v5, v6 wave_ror:1 row_mask:0xf bank_mask:0xf
    s_waitcnt lgkmcnt(3)
    v_mfma_f32_16x16x32_bf16 v[12:15], v[56:59], a[240:243], v[12:15]
    v_add_f32_dpp v128, v5, v4 wave_shr:1 row_mask:0xf bank_mask:0xf
    v_add_f32_dpp v129, v7, v6 wave_shr:1 row_mask:0xf bank_mask:0xf
    s_waitcnt lgkmcnt(1)
    v_mfma_f32_16x16x32_bf16 v[12:15], a[244:247], a[220:223], v[12:15]
    ds_write2st64_b32 v208, v128, v129 offset0:100 offset1:108
    s_waitcnt lgkmcnt(0)
    s_barrier
    v_mfma_f32_16x16x32_bf16 v[16:19], a[192:195], v[84:87], 0
    ds_read2st64_b32 v[172:173], v209 offset0:64 offset1:65
    ds_read2st64_b32 v[174:175], v209 offset0:66 offset1:67
    v_mfma_f32_16x16x32_bf16 v[16:19], v[80:83], a[188:191], v[16:19]
    ds_read2st64_b32 v[176:177], v209 offset0:68 offset1:69
    ds_read2st64_b32 v[178:179], v209 offset0:70 offset1:71
    v_mfma_f32_16x16x32_bf16 v[16:19], v[88:91], a[196:199], v[16:19]
    s_waitcnt vmcnt(5)
    v_lshlrev_b32 v180, 16, v140
    v_and_b32 v181, s69, v140
    v_mfma_f32_16x16x32_bf16 v[16:19], a[200:203], v[92:95], v[16:19]
    v_lshlrev_b32 v182, 16, v141
    v_and_b32 v183, s69, v141
    v_mfma_f32_16x16x32_bf16 v[16:19], a[184:187], v[76:79], v[16:19]
    v_lshlrev_b32 v184, 16, v142
    v_and_b32 v185, s69, v142
    v_mfma_f32_16x16x32_bf16 v[16:19], v[72:75], a[180:183], v[16:19]
    buffer_load_dword v3, v214, s[52:55], s67 offen sc1
    v_lshlrev_b32 v186, 16, v143
    v_mfma_f32_16x16x32_bf16 v[16:19], v[96:99], a[204:207], v[16:19]
    v_and_b32 v187, s69, v143
    v_fma_f32 v188, v180, v160, v161
    v_mfma_f32_16x16x32_bf16 v[16:19], a[208:211], v[100:103], v[16:19]
    ds_read_b128 a[224:227], v207 offset:25856
    v_fma_f32 v189, v181, v160, v161
    v_mfma_f32_16x16x32_bf16 v[16:19], a[176:179], v[68:71], v[16:19]
    ds_read_b64_tr_b16 v[48:49], v205 offset:35984
    ds_read_b64_tr_b16 v[50:51], v205 offset:35968
    v_mfma_f32_16x16x32_bf16 v[16:19], v[64:67], a[172:175], v[16:19]
    ds_read_b128 v[52:55], v206 offset:26880
    v_fma_f32 v190, v182, v160, v161
    v_mfma_f32_16x16x32_bf16 v[16:19], v[104:107], a[212:215], v[16:19]
    ds_read_b64_tr_b16 a[228:229], v205 offset:36112
    ds_read_b64_tr_b16 a[230:231], v205 offset:36096
    v_mfma_f32_16x16x32_bf16 v[16:19], a[216:219], v[108:111], v[16:19]
    v_fma_f32 v191, v183, v160, v161
    v_fma_f32 v192, v184, v160, v161
    v_mfma_f32_16x16x32_bf16 v[16:19], a[168:171], v[60:63], v[16:19]
    v_fma_f32 v193, v185, v160, v161
    v_fma_f32 v194, v186, v160, v161
    v_mfma_f32_16x16x32_bf16 v[16:19], v[56:59], a[164:167], v[16:19]
    v_fma_f32 v195, v187, v160, v161
    s_waitcnt lgkmcnt(9)
    v_fmac_f32 v180, v188, v172
    v_mfma_f32_16x16x32_bf16 v[16:19], a[160:163], a[220:223], v[16:19]
    v_fmac_f32 v181, v189, v173
    s_waitcnt lgkmcnt(8)
    v_fmac_f32 v182, v190, v174
    s_waitcnt lgkmcnt(5)
    v_mfma_f32_16x16x32_bf16 v[16:19], a[224:227], a[248:251], v[16:19]
    v_fmac_f32 v183, v191, v175
    v_fmac_f32 v184, v192, v176
    s_waitcnt lgkmcnt(3)
    v_mfma_f32_16x16x32_bf16 v[16:19], a[252:255], v[48:51], v[16:19]
    v_fmac_f32 v185, v193, v177
    v_fmac_f32 v186, v194, v178
    s_waitcnt lgkmcnt(2)
    v_mfma_f32_16x16x32_bf16 v[16:19], v[52:55], a[240:243], v[16:19]
    v_fmac_f32 v187, v195, v179
    v_cvt_pk_bf16_f32 v196, v180, v181
    s_waitcnt lgkmcnt(0)
    v_mfma_f32_16x16x32_bf16 v[16:19], a[244:247], a[228:231], v[16:19]
    v_cvt_pk_bf16_f32 v197, v182, v183
    v_cvt_pk_bf16_f32 v198, v184, v185
    s_waitcnt vmcnt(5)
    v_lshlrev_b32 v48, 16, v144
    v_and_b32 v49, s69, v144
    v_lshlrev_b32 v50, 16, v145
    v_and_b32 v51, s69, v145
    v_lshlrev_b32 v52, 16, v146
    v_and_b32 v53, s69, v146
    v_lshlrev_b32 v54, 16, v147
    v_and_b32 v55, s69, v147
    v_cvt_pk_bf16_f32 v199, v186, v187
    buffer_store_dwordx4 v[196:199], v217, s[52:55], s83 offen sc1
    v_add_f32_dpp v130, v7, v8 wave_ror:1 row_mask:0xf bank_mask:0xf
    v_add_f32_dpp v131, v9, v10 wave_ror:1 row_mask:0xf bank_mask:0xf
    s_nop 0
    v_add_f32_dpp v130, v9, v8 wave_shr:1 row_mask:0xf bank_mask:0xf
    v_add_f32_dpp v131, v11, v10 wave_shr:1 row_mask:0xf bank_mask:0xf
    ds_write2st64_b32 v208, v130, v131 offset0:116 offset1:124
    v_add_f32_dpp v128, v11, v12 wave_ror:1 row_mask:0xf bank_mask:0xf
    v_add_f32_dpp v129, v13, v14 wave_ror:1 row_mask:0xf bank_mask:0xf
    s_nop 0
    v_add_f32_dpp v128, v13, v12 wave_shr:1 row_mask:0xf bank_mask:0xf
    v_add_f32_dpp v129, v15, v14 wave_shr:1 row_mask:0xf bank_mask:0xf
    ds_write2st64_b32 v208, v128, v129 offset0:132 offset1:140
    v_add_f32_dpp v130, v15, v16 wave_ror:1 row_mask:0xf bank_mask:0xf
    v_add_f32_dpp v131, v17, v18 wave_ror:1 row_mask:0xf bank_mask:0xf
    s_nop 0
    v_add_f32_dpp v130, v17, v16 wave_shr:1 row_mask:0xf bank_mask:0xf
    v_add_f32_dpp v131, v19, v18 wave_shr:1 row_mask:0xf bank_mask:0xf
    ds_write2st64_b32 v208, v130, v131 offset0:148 offset1:156
    v_pk_fma_f32 v[56:57], v[48:49], v[164:165], v[164:165] op_sel:[0,0,1] op_sel_hi:[1,0,1]
    v_pk_fma_f32 v[58:59], v[50:51], v[164:165], v[164:165] op_sel:[0,0,1] op_sel_hi:[1,0,1]
    v_pk_fma_f32 v[60:61], v[52:53], v[164:165], v[164:165] op_sel:[0,0,1] op_sel_hi:[1,0,1]
    v_pk_fma_f32 v[62:63], v[54:55], v[164:165], v[164:165] op_sel:[0,0,1] op_sel_hi:[1,0,1]
    s_waitcnt vmcnt(5)
    v_lshlrev_b32 v72, 16, v148
    v_and_b32 v73, s69, v148
    v_lshlrev_b32 v74, 16, v149
    v_and_b32 v75, s69, v149
    v_lshlrev_b32 v76, 16, v150
    v_and_b32 v77, s69, v150
    v_lshlrev_b32 v78, 16, v151
    v_and_b32 v79, s69, v151
    v_pk_fma_f32 v[80:81], v[72:73], v[168:169], v[168:169] op_sel:[0,0,1] op_sel_hi:[1,0,1]
    v_pk_fma_f32 v[82:83], v[74:75], v[168:169], v[168:169] op_sel:[0,0,1] op_sel_hi:[1,0,1]
    v_pk_fma_f32 v[84:85], v[76:77], v[168:169], v[168:169] op_sel:[0,0,1] op_sel_hi:[1,0,1]
    v_pk_fma_f32 v[86:87], v[78:79], v[168:169], v[168:169] op_sel:[0,0,1] op_sel_hi:[1,0,1]
    s_waitcnt lgkmcnt(0)
    s_barrier
    ds_read2st64_b32 v[40:41], v209 offset0:96 offset1:97
    ds_read2st64_b32 v[42:43], v209 offset0:98 offset1:99
    ds_read2st64_b32 v[44:45], v209 offset0:100 offset1:101
    ds_read2st64_b32 v[46:47], v209 offset0:102 offset1:103
    ds_read2st64_b32 v[64:65], v209 offset0:128 offset1:129
    ds_read2st64_b32 v[66:67], v209 offset0:130 offset1:131
    ds_read2st64_b32 v[68:69], v209 offset0:132 offset1:133
    ds_read2st64_b32 v[70:71], v209 offset0:134 offset1:135
    s_waitcnt lgkmcnt(7)
    v_pk_fma_f32 v[48:49], v[56:57], v[40:41], v[48:49]
    s_waitcnt lgkmcnt(6)
    v_pk_fma_f32 v[50:51], v[58:59], v[42:43], v[50:51]
    s_waitcnt lgkmcnt(5)
    v_pk_fma_f32 v[52:53], v[60:61], v[44:45], v[52:53]
    s_waitcnt lgkmcnt(4)
    v_pk_fma_f32 v[54:55], v[62:63], v[46:47], v[54:55]
    v_cvt_pk_bf16_f32 v200, v48, v49
    v_cvt_pk_bf16_f32 v201, v50, v51
    v_cvt_pk_bf16_f32 v202, v52, v53
    v_cvt_pk_bf16_f32 v203, v54, v55
    buffer_store_dwordx4 v[200:203], v218, s[52:55], s83 offen sc1
    s_waitcnt lgkmcnt(3)
    v_pk_fma_f32 v[72:73], v[80:81], v[64:65], v[72:73]
    s_waitcnt lgkmcnt(2)
    v_pk_fma_f32 v[74:75], v[82:83], v[66:67], v[74:75]
    s_waitcnt lgkmcnt(1)
    v_pk_fma_f32 v[76:77], v[84:85], v[68:69], v[76:77]
    s_waitcnt lgkmcnt(0)
    v_pk_fma_f32 v[78:79], v[86:87], v[70:71], v[78:79]
    v_cvt_pk_bf16_f32 v196, v72, v73
    v_cvt_pk_bf16_f32 v197, v74, v75
    v_cvt_pk_bf16_f32 v198, v76, v77
    v_cvt_pk_bf16_f32 v199, v78, v79
    buffer_store_dwordx4 v[196:199], v219, s[52:55], s83 offen sc1
    s_waitcnt vmcnt(3)
    v_cmp_eq_u32 s[90:91], s6, v3
    s_nop 0
    s_cmp_eq_u64 s[90:91], -1
    s_cbranch_scc0 L_pollf22
L_polld20:
    s_add_u32 m0, s77, 0
    s_add_u32 s74, s75, 0
    buffer_load_dwordx4 v1, s[52:55], s74 offen sc1 lds
    buffer_load_dwordx4 v1, s[52:55], s74 offen offset:1024 sc1 lds
    buffer_load_dwordx4 v1, s[52:55], s74 offen offset:2048 sc1 lds
    buffer_load_dwordx4 v1, s[52:55], s74 offen offset:3072 sc1 lds
    s_mul_i32 s61, s60, 20
    v_add_u32 v14, 65536, v1
    v_add_u32 v15, 81920, v1
    s_and_b32 s80, s3, 1
    s_and_b32 s68, s4, 7
    v_lshrrev_b32 v8, 4, v0
    v_and_b32 v9, 15, v0
    v_lshlrev_b32 v9, 4, v9
    v_lshl_add_u32 v9, v8, 15, v9
    s_lshl_b32 s73, s80, 8
    v_add_u32 v21, s73, v9
    v_xor_b32 v16, 256, v21
    s_lshr_b32 s64, s4, 3
    s_and_b32 s65, s3, 6
    s_lshl_b32 s65, s65, 1
    s_add_u32 s67, s64, s65
    s_lshl_b32 s64, s67, 2
    s_add_u32 s65, s64, s5
    s_lshl_b32 s64, s65, 9
    s_add_u32 s64, s64, 0x390000
    s_mul_i32 s79, s68, 327680
    s_add_u32 s79, s79, s64
    s_lshl_b32 s73, s5, 10
    s_add_u32 s73, s73, 155648
    v_lshl_add_u32 v20, v8, 4, s73
    s_lshl_b32 s81, s65, 1
    s_add_u32 s81, s81, s80
    s_mul_i32 s81, s81, 57344
    s_add_u32 s81, s81, 0x610000
    s_mul_i32 s76, s68, 7168
    s_add_u32 s76, s76, s81
    s_add_u32 s69, s76, 3072
    s_mov_b32 s1, s57
    s_lshl_b32 s0, s68, 2
    s_add_u32 s0, s0, s57
    s_add_u32 s59, s0, 64
    v_lshrrev_b32 v5, 6, v225
    v_bfe_u32 v9, v0, 2, 2
    v_and_b32 v13, 15, v0
    v_lshl_add_u32 v12, v9, 4, v13
    v_lshlrev_b32_e64 v12, 2, v12
    v_lshl_add_u32 v13, v13, 2, 64
    v_add_u32 v13, 128, v13
    v_mov_b32 v11, 0x3f800054
    s_mov_b32 s86, 0x3acccccd
    s_mov_b32 s88, 0xaaaaaaaa
    s_mov_b32 s89, 0xaaaaaaaa
    s_mov_b32 s82, 0xcccccccc
    s_mov_b32 s83, 0xcccccccc
    s_mov_b32 s84, 0
    s_mov_b32 s85, 0xffff0000
    v_mov_b32 v22, 0xc0135761
    v_mov_b32 v23, 0xbdd2d3e8
    s_waitcnt vmcnt(4)
    s_barrier
    s_cmp_lg_u32 s5, 0
    s_cbranch_scc1 L_post23
    buffer_store_dword v226, v227, s[52:55], s99 offen
L_post23:
    v_min_u32 v17, 55, v0
    v_lshlrev_b32 v18, 3, v17
    v_lshlrev_b32 v17, 2, v17
    s_mul_i32 s72, s5, 5
    s_add_u32 s72, s72, s61
    s_mul_i32 s72, s72, 448
    s_add_u32 s72, s72, 0x1170000
    s_mul_i32 s70, s60, 216
    buffer_load_dwordx2 v[176:177], v18, s[52:55], s72 offen offset:0 sc1
    buffer_load_dwordx2 v[178:179], v18, s[52:55], s72 offen offset:448 sc1
    buffer_load_dwordx2 v[180:181], v18, s[52:55], s72 offen offset:896 sc1
    buffer_load_dwordx2 v[182:183], v18, s[52:55], s72 offen offset:1344 sc1
    buffer_load_dwordx2 v[184:185], v18, s[52:55], s72 offen offset:1792 sc1
    buffer_load_dword v187, v17, s[36:39], s70 offen
    v_lshrrev_b32 v10, 4, v0
    v_lshlrev_b32 v4, 4, v10
    s_mul_i32 s72, s68, 160
    v_lshlrev_b32_e64 v8, 3, v10
    buffer_load_dwordx4 v[122:125], v4, s[44:47], s72 offen
    buffer_load_dwordx4 v[126:129], v4, s[44:47], s72 offen offset:64
    buffer_load_dwordx2 v[130:131], v8, s[44:47], s72 offen offset:128
    v_and_b32 v6, 0x1f0, v21
    v_lshrrev_b32 v4, 5, v0
    v_lshl_add_u32 v6, v4, 15, v6
    v_and_b32 v4, 1, v10
    v_lshl_add_u32 v6, v4, 3, v6
    s_add_u32 s70, s79, 131072
    s_add_u32 s71, s79, 262144
    s_add_u32 m0, s77, 16384
    s_add_u32 s74, s75, 16384
    buffer_load_dwordx4 v1, s[52:55], s74 offen sc1 lds
    buffer_load_dwordx4 v1, s[52:55], s74 offen offset:1024 sc1 lds
    buffer_load_dwordx4 v1, s[52:55], s74 offen offset:2048 sc1 lds
    buffer_load_dwordx4 v1, s[52:55], s74 offen offset:3072 sc1 lds
    s_add_u32 m0, s77, 32768
    s_add_u32 s74, s75, 32768
    buffer_load_dwordx4 v1, s[52:55], s74 offen sc1 lds
    buffer_load_dwordx4 v1, s[52:55], s74 offen offset:1024 sc1 lds
    buffer_load_dwordx4 v1, s[52:55], s74 offen offset:2048 sc1 lds
    buffer_load_dwordx4 v1, s[52:55], s74 offen offset:3072 sc1 lds
    s_add_u32 m0, s77, 49152
    s_add_u32 s74, s75, 49152
    buffer_load_dwordx4 v1, s[52:55], s74 offen sc1 lds
    buffer_load_dwordx4 v1, s[52:55], s74 offen offset:1024 sc1 lds
    buffer_load_dwordx4 v1, s[52:55], s74 offen offset:2048 sc1 lds
    buffer_load_dwordx4 v1, s[52:55], s74 offen offset:3072 sc1 lds
    s_add_u32 m0, s77, 65536
    s_add_u32 s74, s75, 65536
    buffer_load_dwordx4 v1, s[52:55], s74 offen sc1 lds
    buffer_load_dwordx4 v1, s[52:55], s74 offen offset:1024 sc1 lds
    buffer_load_dwordx4 v1, s[52:55], s74 offen offset:2048 sc1 lds
    buffer_load_dwordx4 v1, s[52:55], s74 offen offset:3072 sc1 lds
    s_branch L_convdone
L_t1:
    v_lshrrev_b32 v91, 4, v0
    v_bfe_u32 v92, v0, 2, 2
    v_and_b32 v93, 3, v0
    v_and_b32 v94, 1, v92
    v_mul_u32_u24 v94, 4220, v94
    v_lshl_add_u32 v94, v91, 5, v94
    v_lshl_add_u32 v94, v93, 3, v94
    v_lshlrev_b32 v95, 2, v92
    v_sub_u32 v94, v94, v95
    s_add_u32 s75, s73, 16
    v_add_u32 v205, s75, v94
    v_bfe_u32 v94, v0, 1, 1
    v_lshl_add_u32 v94, v94, 2, v92
    v_sub_u32 v94, v94, v91
    v_and_b32 v96, 1, v0
    v_add_u32 v95, 9, v94
    v_bfe_u32 v97, v95, 1, 2
    v_xor_b32 v97, s5, v97
    v_lshlrev_b32_e64 v97, 4, v97
    v_lshl_add_u32 v97, v96, 6, v97
    v_lshl_add_u32 v97, v95, 7, v97
    v_add_u32 v206, 66816, v97
    v_add_u32 v95, 13, v94
    v_bfe_u32 v97, v95, 1, 2
    v_xor_b32 v97, s5, v97
    v_lshlrev_b32_e64 v97, 4, v97
    v_lshl_add_u32 v97, v96, 6, v97
    v_lshl_add_u32 v97, v95, 7, v97
    v_add_u32 v207, 66816, v97
    s_lshl_b32 s74, s5, 8
    s_add_u32 s74, s74, 102912
    v_lshl_add_u32 v208, v0, 2, s74
    s_lshl_b32 s74, s5, 11
    s_add_u32 s74, s74, 102912
    v_lshl_add_u32 v209, v0, 2, s74
    s_lshl_b32 s74, s5, 6
    s_add_u32 s74, s74, 1168
    v_add_u32 v98, s74, v0
    s_lshl_b32 s83, s70, 15
    s_add_u32 s83, s83, 0x390000
    s_mov_b32 s79, 0x40000
    s_lshl_b32 s68, s70, 4
    v_add_u32 v99, 0, v98
    v_max_i32 v100, 1184, v99
    v_min_i32 v100, 1679, v100
    v_cmp_eq_u32 vcc, v99, v100
    v_lshlrev_b32 v220, 5, v100
    v_mul_u32_u24 v24, 1280, v100
    v_lshlrev_b32 v100, 4, v100
    v_cndmask_b32 v215, v231, v100, vcc
    v_add_u32 v99, 256, v98
    v_lshlrev_b32 v221, 5, v99
    v_lshlrev_b32 v216, 4, v99
    v_mul_u32_u24 v25, 1280, v99
    buffer_load_dwordx4 v[132:135], v24, s[8:11], s68 offen
    s_waitcnt vmcnt(8)
    ds_read_b32 v116, v115 offset:32
    v_lshlrev_b32 v117, 16, v117
    s_waitcnt lgkmcnt(0)
    v_lshlrev_b32 v123, 16, v116
    v_add_f32 v123, v117, v123
    v_and_b32 v116, 0xffff0000, v116
    v_cvt_pk_bf16_f32 v123, v123, v116
    ds_write_b32 v115, v123 offset:32
    ds_read_b64 v[56:57], v118 offset:32
    ds_read_b64 v[58:59], v118 offset:544
    ds_read_b64 v[60:61], v118 offset:1056
    ds_read_b64 v[62:63], v118 offset:1568
    ds_read_b64 v[64:65], v118 offset:2080
    ds_read_b64 v[66:67], v118 offset:2592
    ds_read_b64 v[68:69], v118 offset:3104
    ds_read_b64 v[70:71], v118 offset:3616
    ds_read_b64 v[72:73], v118 offset:33824
    ds_read_b64 v[74:75], v118 offset:34336
    ds_read_b64 v[76:77], v118 offset:34848
    ds_read_b64 v[78:79], v118 offset:35360
    ds_read_b64 v[80:81], v118 offset:35872
    ds_read_b64 v[82:83], v118 offset:36384
    ds_read_b64 v[84:85], v118 offset:36896
    ds_read_b64 v[86:87], v118 offset:37408
    s_waitcnt lgkmcnt(8)
    s_nop 0
    ds_write2_b32 v119, v56, v57 offset0:0 offset1:1
    ds_write2_b32 v119, v58, v59 offset0:128 offset1:129
    v_add_u32 v119, 1024, v119
    ds_write2_b32 v119, v60, v61 offset0:0 offset1:1
    ds_write2_b32 v119, v62, v63 offset0:128 offset1:129
    v_add_u32 v119, 1024, v119
    ds_write2_b32 v119, v64, v65 offset0:0 offset1:1
    ds_write2_b32 v119, v66, v67 offset0:128 offset1:129
    v_add_u32 v119, 1024, v119
    ds_write2_b32 v119, v68, v69 offset0:0 offset1:1
    ds_write2_b32 v119, v70, v71 offset0:128 offset1:129
    v_add_u32 v119, 30720, v119
    s_waitcnt lgkmcnt(8)
    s_nop 0
    ds_write2_b32 v119, v72, v73 offset0:0 offset1:1
    ds_write2_b32 v119, v74, v75 offset0:128 offset1:129
    v_add_u32 v119, 1024, v119
    ds_write2_b32 v119, v76, v77 offset0:0 offset1:1
    ds_write2_b32 v119, v78, v79 offset0:128 offset1:129
    v_add_u32 v119, 1024, v119
    ds_write2_b32 v119, v80, v81 offset0:0 offset1:1
    ds_write2_b32 v119, v82, v83 offset0:128 offset1:129
    v_add_u32 v119, 1024, v119
    ds_write2_b32 v119, v84, v85 offset0:0 offset1:1
    ds_write2_b32 v119, v86, v87 offset0:128 offset1:129
    s_cmp_lg_u32 s5, 1
    s_cbranch_scc1 L_wk24
    s_mov_b64 exec, 0
    s_branch L_pad_t1_0
L_pad_t1_1:
    s_mov_b64 exec, -1
L_wk24:
    s_cmp_lg_u32 s5, 0
    s_cbranch_scc1 L_post25
    buffer_store_dword v226, v227, s[52:55], s1 offen
L_post25:
    s_cmp_lg_u32 s5, 0
    s_cbranch_scc1 L_polld27
    s_mov_b64 s[90:91], 0
    s_mov_b32 s92, 0
    s_waitcnt vmcnt(0)
    buffer_load_dword v31, v214, s[52:55], s67 offen sc1
    buffer_load_dword v30, v214, s[52:55], s67 offen sc1
L_poll26:
    buffer_load_dword v3, v214, s[52:55], s67 offen sc1
    s_add_u32 s92, s92, 1
    s_waitcnt vmcnt(2)
    v_cmp_eq_u32 vcc, s6, v31
    s_nop 0
    s_or_b64 s[90:91], s[90:91], vcc
    s_cmp_eq_u64 s[90:91], -1
    s_cbranch_scc1 L_polld27
    buffer_load_dword v31, v214, s[52:55], s67 offen sc1
    s_waitcnt vmcnt(2)
    v_cmp_eq_u32 vcc, s6, v30
    s_nop 0
    s_or_b64 s[90:91], s[90:91], vcc
    s_cmp_eq_u64 s[90:91], -1
    s_cbranch_scc1 L_polld27
    s_cmp_lg_u32 s92, 64
    s_cbranch_scc1 L_polln28
    s_xor_b32 s93, s0, 0x8000
    buffer_store_dword v226, v227, s[52:55], s93 offen sc1
L_polln28:
    buffer_load_dword v30, v214, s[52:55], s67 offen sc1
    s_waitcnt vmcnt(2)
    v_cmp_eq_u32 vcc, s6, v3
    s_nop 0
    s_or_b64 s[90:91], s[90:91], vcc
    s_cmp_eq_u64 s[90:91], -1
    s_cbranch_scc1 L_polld27
    s_cmp_lt_u32 s92, 0x200000
    s_cbranch_scc1 L_poll26
L_polld27:
    s_waitcnt vmcnt(1)
    s_barrier
    s_add_u32 m0, s72, 81152
    s_add_u32 s75, s76, 12288
    buffer_load_dwordx4 v1, s[52:55], s75 offen sc1 lds
    s_add_u32 m0, s72, 77056
    s_add_u32 s75, s76, 8192
    buffer_load_dwordx4 v1, s[52:55], s75 offen sc1 lds
    s_add_u32 m0, s72, 72960
    s_add_u32 s75, s76, 4096
    buffer_load_dwordx4 v1, s[52:55], s75 offen sc1 lds
    s_add_u32 m0, s72, 68864
    s_add_u32 s75, s76, 0
    s_nop 0
    buffer_load_dwordx4 v1, s[52:55], s75 offen sc1 lds
    s_add_u32 m0, s72, 98816
    s_add_u32 s75, s76, 28672
    buffer_load_dwordx4 v1, s[52:55], s75 offen sc1 lds
    s_add_u32 m0, s72, 94720
    s_add_u32 s75, s76, 24576
    buffer_load_dwordx4 v1, s[52:55], s75 offen sc1 lds
    s_add_u32 m0, s72, 90624
    s_add_u32 s75, s76, 20480
    buffer_load_dwordx4 v1, s[52:55], s75 offen sc1 lds
    s_add_u32 m0, s72, 86528
    s_add_u32 s75, s76, 16384
    buffer_load_dwordx4 v1, s[52:55], s75 offen sc1 lds
    ds_read_b64_tr_b16 v[172:173], v245 offset:0
    ds_read_b64_tr_b16 v[174:175], v245 offset:10240
    ds_read_b64_tr_b16 v[176:177], v245 offset:8
    ds_read_b64_tr_b16 v[178:179], v245 offset:10248
    ds_read_b64_tr_b16 v[180:181], v245 offset:64
    ds_read_b64_tr_b16 v[182:183], v245 offset:10304
    ds_read_b64_tr_b16 v[184:185], v245 offset:72
    ds_read_b64_tr_b16 v[186:187], v245 offset:10312
    ds_read_b64_tr_b16 v[188:189], v246 offset:128
    ds_read_b64_tr_b16 v[190:191], v246 offset:10368
    s_waitcnt lgkmcnt(8)
    buffer_store_dwordx4 v[172:175], v1, s[52:55], s81 offen offset:0 sc1
    s_waitcnt lgkmcnt(6)
    buffer_store_dwordx4 v[176:179], v1, s[52:55], s81 offen offset:1024 sc1
    s_mov_b32 s80, s77
    s_add_u32 s67, s67, 0x4000
    s_and_b32 s60, s3, 1
    s_lshl_b32 s60, s60, 3
    s_and_b32 s61, s4, 7
    s_add_u32 s60, s60, s61
    s_mul_i32 s61, s60, 143360
    s_add_u32 s61, s61, 0xd10000
    s_lshl_b32 s63, s5, 10
    s_add_u32 s62, s61, s63
    s_lshl_b32 s77, s5, 12
    s_add_u32 s75, s61, s77
    s_waitcnt vmcnt(8)
    s_waitcnt lgkmcnt(0)
    s_barrier
    ds_read_b64_tr_b16 v[40:41], v205 offset:16
    ds_read_b64_tr_b16 v[42:43], v205 offset:0
    ds_read_b128 v[44:47], v206 offset:10240
    ds_read_b128 v[48:51], v206 offset:11264
    ds_read_b128 v[52:55], v206 offset:12288
    ds_read_b128 v[56:59], v206 offset:13312
    ds_read_b64_tr_b16 v[60:61], v205 offset:144
    ds_read_b64_tr_b16 v[62:63], v205 offset:128
    ds_read_b128 v[64:67], v207 offset:9216
    ds_read_b128 v[68:71], v207 offset:10240
    ds_read_b128 v[72:75], v207 offset:11264
    ds_read_b128 v[76:79], v207 offset:12288
    ds_read_b64_tr_b16 v[80:81], v205 offset:272
    ds_read_b64_tr_b16 v[82:83], v205 offset:256
    s_waitcnt lgkmcnt(11)
    v_mfma_f32_16x16x32_bf16 v[32:35], v[44:47], v[40:43], 0
    s_waitcnt vmcnt(6)
    s_barrier
    ds_read_b128 v[84:87], v206 offset:9216
    s_waitcnt lgkmcnt(11)
    v_mfma_f32_16x16x32_bf16 v[36:39], v[48:51], v[40:43], 0
    ds_read_b64_tr_b16 v[88:89], v205 offset:400
    ds_read_b64_tr_b16 v[90:91], v205 offset:384
    s_waitcnt lgkmcnt(12)
    v_mfma_f32_16x16x32_bf16 v[112:115], v[52:55], v[40:43], 0
    buffer_load_dwordx4 v[152:155], v220, s[52:55], s79 offen sc1
    ds_read_b128 v[92:95], v207 offset:8192
    s_waitcnt lgkmcnt(12)
    v_mfma_f32_16x16x32_bf16 v[116:119], v[56:59], v[40:43], 0
    ds_read_b64_tr_b16 v[96:97], v205 offset:528
    ds_read_b64_tr_b16 v[98:99], v205 offset:512
    s_waitcnt lgkmcnt(11)
    v_mfma_f32_16x16x32_bf16 v[32:35], v[64:67], v[60:63], v[32:35]
    buffer_store_dwordx4 v[252:255], v210, s[52:55], s66 offen sc1
    ds_read_b128 v[100:103], v206 offset:8192
    s_waitcnt lgkmcnt(11)
    v_mfma_f32_16x16x32_bf16 v[36:39], v[68:71], v[60:63], v[36:39]
    buffer_load_dwordx4 v[156:159], v221, s[52:55], s79 offen sc1
    ds_read_b64_tr_b16 v[104:105], v205 offset:656
    ds_read_b64_tr_b16 v[106:107], v205 offset:640
    s_waitcnt lgkmcnt(12)
    v_mfma_f32_16x16x32_bf16 v[112:115], v[72:75], v[60:63], v[112:115]
    ds_read_b128 v[108:111], v207 offset:7168
    ds_read_b64_tr_b16 a[160:161], v205 offset:784
    ds_read_b64_tr_b16 a[162:163], v205 offset:768
    s_waitcnt lgkmcnt(14)
    v_mfma_f32_16x16x32_bf16 v[116:119], v[76:79], v[60:63], v[116:119]
    ds_read_b128 a[164:167], v206 offset:7168
    s_waitcnt lgkmcnt(12)
    v_mfma_f32_16x16x32_bf16 v[32:35], v[84:87], v[80:83], v[32:35]
    buffer_load_dwordx4 v[136:139], v25, s[8:11], s68 offen
    v_mfma_f32_16x16x32_bf16 v[36:39], v[44:47], v[80:83], v[36:39]
    v_mfma_f32_16x16x32_bf16 v[112:115], v[48:51], v[80:83], v[112:115]
    ds_read_b64_tr_b16 a[168:169], v205 offset:912
    ds_read_b64_tr_b16 a[170:171], v205 offset:896
    v_mfma_f32_16x16x32_bf16 v[116:119], v[52:55], v[80:83], v[116:119]
    ds_read_b128 a[172:175], v207 offset:6144
    s_waitcnt lgkmcnt(10)
    v_mfma_f32_16x16x32_bf16 v[32:35], v[92:95], v[88:91], v[32:35]
    v_mfma_f32_16x16x32_bf16 v[36:39], v[64:67], v[88:91], v[36:39]
    v_mfma_f32_16x16x32_bf16 v[112:115], v[68:71], v[88:91], v[112:115]
    ds_read_b64_tr_b16 a[176:177], v205 offset:1040
    ds_read_b64_tr_b16 a[178:179], v205 offset:1024
    v_mfma_f32_16x16x32_bf16 v[116:119], v[72:75], v[88:91], v[116:119]
    ds_read_b128 a[180:183], v206 offset:6144
    s_waitcnt lgkmcnt(6)
    v_mfma_f32_16x16x32_bf16 v[32:35], v[100:103], v[96:99], v[32:35]
    v_mfma_f32_16x16x32_bf16 v[36:39], v[84:87], v[96:99], v[36:39]
    v_mfma_f32_16x16x32_bf16 v[112:115], v[44:47], v[96:99], v[112:115]
    ds_read_b64_tr_b16 a[184:185], v205 offset:1168
    ds_read_b64_tr_b16 a[186:187], v205 offset:1152
    v_mfma_f32_16x16x32_bf16 v[116:119], v[48:51], v[96:99], v[116:119]
    ds_read_b128 a[188:191], v207 offset:5120
    v_mfma_f32_16x16x32_bf16 v[32:35], v[108:111], v[104:107], v[32:35]
    v_mfma_f32_16x16x32_bf16 v[36:39], v[92:95], v[104:107], v[36:39]
    v_mfma_f32_16x16x32_bf16 v[112:115], v[64:67], v[104:107], v[112:115]
    ds_read_b64_tr_b16 a[192:193], v205 offset:1296
    ds_read_b64_tr_b16 a[194:195], v205 offset:1280
    v_mfma_f32_16x16x32_bf16 v[116:119], v[68:71], v[104:107], v[116:119]
    ds_read_b128 a[196:199], v206 offset:5120
    v_mfma_f32_16x16x32_bf16 v[32:35], a[164:167], a[160:163], v[32:35]
    v_mfma_f32_16x16x32_bf16 v[36:39], v[100:103], a[160:163], v[36:39]
    v_mfma_f32_16x16x32_bf16 v[112:115], v[84:87], a[160:163], v[112:115]
    ds_read_b64_tr_b16 a[200:201], v205 offset:1424
    ds_read_b64_tr_b16 a[202:203], v205 offset:1408
    v_mfma_f32_16x16x32_bf16 v[116:119], v[44:47], a[160:163], v[116:119]
    ds_read_b128 a[204:207], v207 offset:4096
    s_waitcnt lgkmcnt(6)
    v_mfma_f32_16x16x32_bf16 v[32:35], a[172:175], a[168:171], v[32:35]
    v_mfma_f32_16x16x32_bf16 v[36:39], v[108:111], a[168:171], v[36:39]
    v_mfma_f32_16x16x32_bf16 v[112:115], v[92:95], a[168:171], v[112:115]
    ds_read_b64_tr_b16 a[208:209], v205 offset:1552
    ds_read_b64_tr_b16 a[210:211], v205 offset:1536
    v_mfma_f32_16x16x32_bf16 v[116:119], v[64:67], a[168:171], v[116:119]
    ds_read_b128 a[212:215], v206 offset:4096
    v_mfma_f32_16x16x32_bf16 v[32:35], a[180:183], a[176:179], v[32:35]
    v_mfma_f32_16x16x32_bf16 v[36:39], a[164:167], a[176:179], v[36:39]
    v_mfma_f32_16x16x32_bf16 v[112:115], v[100:103], a[176:179], v[112:115]
    ds_read_b64_tr_b16 a[216:217], v205 offset:1680
    ds_read_b64_tr_b16 a[218:219], v205 offset:1664
    v_mfma_f32_16x16x32_bf16 v[116:119], v[84:87], a[176:179], v[116:119]
    ds_read_b128 a[220:223], v207 offset:3072
    v_mfma_f32_16x16x32_bf16 v[32:35], a[188:191], a[184:187], v[32:35]
    v_mfma_f32_16x16x32_bf16 v[36:39], a[172:175], a[184:187], v[36:39]
    v_mfma_f32_16x16x32_bf16 v[112:115], v[108:111], a[184:187], v[112:115]
    ds_read_b64_tr_b16 a[224:225], v205 offset:1808
    ds_read_b64_tr_b16 a[226:227], v205 offset:1792
    v_mfma_f32_16x16x32_bf16 v[116:119], v[92:95], a[184:187], v[116:119]
    ds_read_b128 a[228:231], v206 offset:3072
    s_waitcnt lgkmcnt(6)
    v_mfma_f32_16x16x32_bf16 v[32:35], a[196:199], a[192:195], v[32:35]
    v_mfma_f32_16x16x32_bf16 v[36:39], a[180:183], a[192:195], v[36:39]
    v_mfma_f32_16x16x32_bf16 v[112:115], a[164:167], a[192:195], v[112:115]
    ds_read_b64_tr_b16 a[232:233], v205 offset:1936
    ds_read_b64_tr_b16 a[234:235], v205 offset:1920
    v_mfma_f32_16x16x32_bf16 v[116:119], v[100:103], a[192:195], v[116:119]
    ds_read_b128 a[236:239], v207 offset:2048
    v_mfma_f32_16x16x32_bf16 v[32:35], a[204:207], a[200:203], v[32:35]
    v_mfma_f32_16x16x32_bf16 v[36:39], a[188:191], a[200:203], v[36:39]
    v_mfma_f32_16x16x32_bf16 v[112:115], a[172:175], a[200:203], v[112:115]
    ds_read_b64_tr_b16 a[240:241], v205 offset:2064
    ds_read_b64_tr_b16 a[242:243], v205 offset:2048
    v_mfma_f32_16x16x32_bf16 v[116:119], v[108:111], a[200:203], v[116:119]
    ds_read_b128 a[244:247], v206 offset:2048
    v_mfma_f32_16x16x32_bf16 v[32:35], a[212:215], a[208:211], v[32:35]
    v_mfma_f32_16x16x32_bf16 v[36:39], a[196:199], a[208:211], v[36:39]
    v_mfma_f32_16x16x32_bf16 v[112:115], a[180:183], a[208:211], v[112:115]
    ds_read_b64_tr_b16 a[248:249], v205 offset:2192
    ds_read_b64_tr_b16 a[250:251], v205 offset:2176
    v_mfma_f32_16x16x32_bf16 v[116:119], a[164:167], a[208:211], v[116:119]
    ds_read_b128 a[252:255], v207 offset:1024
    s_waitcnt lgkmcnt(6)
    v_mfma_f32_16x16x32_bf16 v[32:35], a[220:223], a[216:219], v[32:35]
    v_mfma_f32_16x16x32_bf16 v[36:39], a[204:207], a[216:219], v[36:39]
    v_mfma_f32_16x16x32_bf16 v[112:115], a[188:191], a[216:219], v[112:115]
    ds_read_b64_tr_b16 v[56:57], v205 offset:2320
    ds_read_b64_tr_b16 v[58:59], v205 offset:2304
    v_mfma_f32_16x16x32_bf16 v[116:119], a[172:175], a[216:219], v[116:119]
    ds_read_b128 v[40:43], v206 offset:1024
    v_mfma_f32_16x16x32_bf16 v[32:35], a[228:231], a[224:227], v[32:35]
    v_mfma_f32_16x16x32_bf16 v[36:39], a[212:215], a[224:227], v[36:39]
    v_mfma_f32_16x16x32_bf16 v[112:115], a[196:199], a[224:227], v[112:115]
    ds_read_b64_tr_b16 v[76:77], v205 offset:2448
    ds_read_b64_tr_b16 v[78:79], v205 offset:2432
    v_mfma_f32_16x16x32_bf16 v[116:119], a[180:183], a[224:227], v[116:119]
    ds_read_b128 v[60:63], v207 offset:0
    v_mfma_f32_16x16x32_bf16 v[32:35], a[236:239], a[232:235], v[32:35]
    s_waitcnt vmcnt(6)
    s_barrier
    v_mfma_f32_16x16x32_bf16 v[36:39], a[220:223], a[232:235], v[36:39]
    v_mfma_f32_16x16x32_bf16 v[112:115], a[204:207], a[232:235], v[112:115]
    ds_read_b64_tr_b16 v[52:53], v205 offset:2576
    ds_read_b64_tr_b16 v[54:55], v205 offset:2560
    v_mfma_f32_16x16x32_bf16 v[116:119], a[188:191], a[232:235], v[116:119]
    ds_read_b128 v[80:83], v206 offset:0
    s_waitcnt lgkmcnt(6)
    v_mfma_f32_16x16x32_bf16 v[32:35], a[244:247], a[240:243], v[32:35]
    buffer_load_dword v23, v227, s[52:55], s66 offen sc1
    v_mfma_f32_16x16x32_bf16 v[36:39], a[228:231], a[240:243], v[36:39]
    v_mfma_f32_16x16x32_bf16 v[112:115], a[212:215], a[240:243], v[112:115]
    ds_read_b64_tr_b16 v[72:73], v205 offset:2704
    ds_read_b64_tr_b16 v[74:75], v205 offset:2688
    v_mfma_f32_16x16x32_bf16 v[116:119], a[196:199], a[240:243], v[116:119]
    v_mfma_f32_16x16x32_bf16 v[32:35], a[252:255], a[248:251], v[32:35]
    v_mfma_f32_16x16x32_bf16 v[36:39], a[236:239], a[248:251], v[36:39]
    ds_read_b64_tr_b16 v[88:89], v205 offset:2832
    ds_read_b64_tr_b16 v[90:91], v205 offset:2816
    v_mfma_f32_16x16x32_bf16 v[112:115], a[220:223], a[248:251], v[112:115]
    buffer_store_dwordx4 v[180:183], v1, s[52:55], s81 offen offset:2048 sc1
    v_mfma_f32_16x16x32_bf16 v[116:119], a[204:207], a[248:251], v[116:119]
    v_mfma_f32_16x16x32_bf16 v[32:35], v[40:43], v[56:59], v[32:35]
    buffer_store_dwordx4 v[184:187], v1, s[52:55], s81 offen offset:3072 sc1
    ds_read_b64_tr_b16 v[48:49], v205 offset:2960
    ds_read_b64_tr_b16 v[50:51], v205 offset:2944
    v_mfma_f32_16x16x32_bf16 v[36:39], a[244:247], v[56:59], v[36:39]
    v_mfma_f32_16x16x32_bf16 v[112:115], a[228:231], v[56:59], v[112:115]
    buffer_store_dwordx4 v[188:191], v1, s[52:55], s82 offen offset:0 sc1
    ds_read_b64_tr_b16 v[96:97], v205 offset:3088
    ds_read_b64_tr_b16 v[98:99], v205 offset:3072
    v_mfma_f32_16x16x32_bf16 v[116:119], a[212:215], v[56:59], v[116:119]
    s_waitcnt lgkmcnt(6)
    v_mfma_f32_16x16x32_bf16 v[32:35], v[60:63], v[76:79], v[32:35]
    ds_read_b64_tr_b16 v[68:69], v205 offset:3216
    ds_read_b64_tr_b16 v[70:71], v205 offset:3200
    v_mfma_f32_16x16x32_bf16 v[36:39], a[252:255], v[76:79], v[36:39]
    ds_read_b64_tr_b16 v[104:105], v205 offset:3344
    ds_read_b64_tr_b16 v[106:107], v205 offset:3328
    v_mfma_f32_16x16x32_bf16 v[112:115], a[236:239], v[76:79], v[112:115]
    ds_read_b64_tr_b16 v[44:45], v205 offset:33808
    ds_read_b64_tr_b16 v[46:47], v205 offset:33792
    v_mfma_f32_16x16x32_bf16 v[116:119], a[220:223], v[76:79], v[116:119]
    ds_read_b128 a[160:163], v206 offset:27904
    ds_read_b128 v[64:67], v206 offset:28928
    v_mfma_f32_16x16x32_bf16 v[32:35], v[80:83], v[52:55], v[32:35]
    ds_read_b128 a[168:171], v206 offset:29952
    v_mfma_f32_16x16x32_bf16 v[36:39], v[40:43], v[52:55], v[36:39]
    ds_read_b128 v[84:87], v206 offset:30976
    v_mfma_f32_16x16x32_bf16 v[112:115], a[244:247], v[52:55], v[112:115]
    ds_read_b64_tr_b16 a[176:177], v205 offset:33936
    ds_read_b64_tr_b16 a[178:179], v205 offset:33920
    v_mfma_f32_16x16x32_bf16 v[116:119], a[228:231], v[52:55], v[116:119]
    ds_read_b128 v[92:95], v207 offset:26880
    ds_read_b128 a[184:187], v207 offset:27904
    v_mfma_f32_16x16x32_bf16 v[36:39], v[60:63], v[72:75], v[36:39]
    ds_read_b128 v[100:103], v207 offset:28928
    v_mfma_f32_16x16x32_bf16 v[112:115], a[252:255], v[72:75], v[112:115]
    v_add_f32_dpp v128, v33, v32 wave_shr:1 row_mask:0xf bank_mask:0xf bound_ctrl:0
    v_add_f32_dpp v129, v33, v34 wave_ror:1 row_mask:0xf bank_mask:0xf
    v_mfma_f32_16x16x32_bf16 v[116:119], a[236:239], v[72:75], v[116:119]
    s_nop 0
    v_add_f32_dpp v129, v35, v34 wave_shr:1 row_mask:0xf bank_mask:0xf
    ds_write2st64_b32 v208, v128, v129 offset0:0 offset1:8
    s_waitcnt lgkmcnt(10)
    v_mfma_f32_16x16x32_bf16 v[36:39], v[80:83], v[88:91], v[36:39]
    ds_read_b128 a[192:195], v207 offset:29952
    ds_read_b64_tr_b16 v[108:109], v205 offset:34064
    ds_read_b64_tr_b16 v[110:111], v205 offset:34048
    v_mfma_f32_16x16x32_bf16 v[112:115], v[40:43], v[88:91], v[112:115]
    ds_read_b128 a[200:203], v206 offset:26880
    v_mfma_f32_16x16x32_bf16 v[116:119], a[244:247], v[88:91], v[116:119]
    v_mfma_f32_16x16x32_bf16 v[112:115], v[60:63], v[48:51], v[112:115]
    ds_read_b64_tr_b16 a[164:165], v205 offset:34192
    ds_read_b64_tr_b16 a[166:167], v205 offset:34176
    v_mfma_f32_16x16x32_bf16 v[116:119], a[252:255], v[48:51], v[116:119]
    ds_read_b128 a[208:211], v207 offset:25856
    v_mfma_f32_16x16x32_bf16 v[112:115], v[80:83], v[96:99], v[112:115]
    v_add_f32_dpp v130, v35, v36 wave_ror:1 row_mask:0xf bank_mask:0xf
    v_add_f32_dpp v131, v37, v38 wave_ror:1 row_mask:0xf bank_mask:0xf
    v_mfma_f32_16x16x32_bf16 v[116:119], v[40:43], v[96:99], v[116:119]
    v_add_f32_dpp v130, v37, v36 wave_shr:1 row_mask:0xf bank_mask:0xf
    v_add_f32_dpp v131, v39, v38 wave_shr:1 row_mask:0xf bank_mask:0xf
    v_mfma_f32_16x16x32_bf16 v[116:119], v[60:63], v[68:71], v[116:119]
    ds_write2st64_b32 v208, v130, v131 offset0:16 offset1:24
    ds_read_b64_tr_b16 a[172:173], v205 offset:34320
    ds_read_b64_tr_b16 a[174:175], v205 offset:34304
    v_mfma_f32_16x16x32_bf16 v[116:119], v[80:83], v[104:107], v[116:119]
    ds_read_b128 a[216:219], v206 offset:25856
    s_waitcnt lgkmcnt(9)
    v_mfma_f32_16x16x32_bf16 v[120:123], a[160:163], v[44:47], 0
    v_mfma_f32_16x16x32_bf16 v[124:127], v[64:67], v[44:47], 0
    v_add_f32_dpp v128, v39, v112 wave_ror:1 row_mask:0xf bank_mask:0xf
    v_add_f32_dpp v129, v113, v114 wave_ror:1 row_mask:0xf bank_mask:0xf
    v_mfma_f32_16x16x32_bf16 v[4:7], a[168:171], v[44:47], 0
    v_add_f32_dpp v128, v113, v112 wave_shr:1 row_mask:0xf bank_mask:0xf
    v_add_f32_dpp v129, v115, v114 wave_shr:1 row_mask:0xf bank_mask:0xf
    v_mfma_f32_16x16x32_bf16 v[8:11], v[84:87], v[44:47], 0
    ds_write2st64_b32 v208, v128, v129 offset0:32 offset1:40
    ds_read_b64_tr_b16 a[180:181], v205 offset:34448
    ds_read_b64_tr_b16 a[182:183], v205 offset:34432
    v_mfma_f32_16x16x32_bf16 v[120:123], v[92:95], a[176:179], v[120:123]
    s_add_u32 s59, s58, 4294885376
    v_add_f32_dpp v130, v115, v116 wave_ror:1 row_mask:0xf bank_mask:0xf
    v_mfma_f32_16x16x32_bf16 v[124:127], a[184:187], a[176:179], v[124:127]
    v_add_f32_dpp v131, v117, v118 wave_ror:1 row_mask:0xf bank_mask:0xf
    v_add_f32_dpp v130, v117, v116 wave_shr:1 row_mask:0xf bank_mask:0xf
    v_mfma_f32_16x16x32_bf16 v[4:7], v[100:103], a[176:179], v[4:7]
    v_add_f32_dpp v131, v119, v118 wave_shr:1 row_mask:0xf bank_mask:0xf
    ds_write2st64_b32 v208, v130, v131 offset0:48 offset1:56
    v_mfma_f32_16x16x32_bf16 v[8:11], a[192:195], a[176:179], v[8:11]
    ds_read_b128 a[224:227], v207 offset:24832
    ds_read_b64_tr_b16 a[188:189], v205 offset:34576
    ds_read_b64_tr_b16 a[190:191], v205 offset:34560
    s_waitcnt lgkmcnt(7)
    v_mfma_f32_16x16x32_bf16 v[120:123], a[200:203], v[108:111], v[120:123]
    ds_read_b128 a[232:235], v206 offset:24832
    v_mfma_f32_16x16x32_bf16 v[124:127], a[160:163], v[108:111], v[124:127]
    buffer_store_dwordx4 v[248:251], v1, s[52:55], s59 offen offset:0 sc1
    v_mfma_f32_16x16x32_bf16 v[4:7], v[64:67], v[108:111], v[4:7]
    ds_read_b64_tr_b16 a[196:197], v205 offset:34704
    ds_read_b64_tr_b16 a[198:199], v205 offset:34688
    v_mfma_f32_16x16x32_bf16 v[8:11], a[168:171], v[108:111], v[8:11]
    ds_read_b128 a[240:243], v207 offset:23808
    v_mfma_f32_16x16x32_bf16 v[120:123], a[208:211], a[164:167], v[120:123]
    v_mfma_f32_16x16x32_bf16 v[124:127], v[92:95], a[164:167], v[124:127]
    v_mfma_f32_16x16x32_bf16 v[4:7], a[184:187], a[164:167], v[4:7]
    buffer_store_dwordx4 v[248:251], v1, s[52:55], s59 offen offset:1024 sc1
    ds_read_b64_tr_b16 a[204:205], v205 offset:34832
    ds_read_b64_tr_b16 a[206:207], v205 offset:34816
    v_mfma_f32_16x16x32_bf16 v[8:11], v[100:103], a[164:167], v[8:11]
    ds_read_b128 a[248:251], v206 offset:23808
    v_mfma_f32_16x16x32_bf16 v[120:123], a[216:219], a[172:175], v[120:123]
    v_mfma_f32_16x16x32_bf16 v[124:127], a[200:203], a[172:175], v[124:127]
    v_mfma_f32_16x16x32_bf16 v[4:7], a[160:163], a[172:175], v[4:7]
    ds_read_b64_tr_b16 a[212:213], v205 offset:34960
    ds_read_b64_tr_b16 a[214:215], v205 offset:34944
    v_mfma_f32_16x16x32_bf16 v[8:11], v[64:67], a[172:175], v[8:11]
    buffer_store_dwordx4 v[248:251], v212, s[52:55], s59 offen offset:2048 sc1
    ds_read_b128 v[56:59], v207 offset:22784
    s_waitcnt lgkmcnt(6)
    v_mfma_f32_16x16x32_bf16 v[120:123], a[224:227], a[180:183], v[120:123]
    v_mfma_f32_16x16x32_bf16 v[124:127], a[208:211], a[180:183], v[124:127]
    v_mfma_f32_16x16x32_bf16 v[4:7], v[92:95], a[180:183], v[4:7]
    ds_read_b64_tr_b16 a[220:221], v205 offset:35088
    ds_read_b64_tr_b16 a[222:223], v205 offset:35072
    v_mfma_f32_16x16x32_bf16 v[8:11], a[184:187], a[180:183], v[8:11]
    ds_read_b128 v[76:79], v206 offset:22784
    v_mfma_f32_16x16x32_bf16 v[120:123], a[232:235], a[188:191], v[120:123]
    s_add_u32 s59, s58, 0
    v_mfma_f32_16x16x32_bf16 v[124:127], a[216:219], a[188:191], v[124:127]
    v_mfma_f32_16x16x32_bf16 v[4:7], a[200:203], a[188:191], v[4:7]
    ds_read_b64_tr_b16 a[228:229], v205 offset:35216
    ds_read_b64_tr_b16 a[230:231], v205 offset:35200
    v_mfma_f32_16x16x32_bf16 v[8:11], a[160:163], a[188:191], v[8:11]
    ds_read_b128 v[52:55], v207 offset:21760
    v_mfma_f32_16x16x32_bf16 v[120:123], a[240:243], a[196:199], v[120:123]
    v_mfma_f32_16x16x32_bf16 v[124:127], a[224:227], a[196:199], v[124:127]
    buffer_store_dwordx4 v[248:251], v1, s[52:55], s59 offen offset:0 sc1
    v_mfma_f32_16x16x32_bf16 v[4:7], a[208:211], a[196:199], v[4:7]
    ds_read_b64_tr_b16 a[236:237], v205 offset:35344
    ds_read_b64_tr_b16 a[238:239], v205 offset:35328
    v_mfma_f32_16x16x32_bf16 v[8:11], v[92:95], a[196:199], v[8:11]
    ds_read_b128 v[72:75], v206 offset:21760
    s_waitcnt lgkmcnt(6)
    v_mfma_f32_16x16x32_bf16 v[120:123], a[248:251], a[204:207], v[120:123]
    v_mfma_f32_16x16x32_bf16 v[124:127], a[232:235], a[204:207], v[124:127]
    v_mfma_f32_16x16x32_bf16 v[4:7], a[216:219], a[204:207], v[4:7]
    buffer_store_dwordx4 v[248:251], v1, s[52:55], s59 offen offset:1024 sc1
    ds_read_b64_tr_b16 a[244:245], v205 offset:35472
    ds_read_b64_tr_b16 a[246:247], v205 offset:35456
    v_mfma_f32_16x16x32_bf16 v[8:11], a[200:203], a[204:207], v[8:11]
    ds_read_b128 v[88:91], v207 offset:20736
    v_mfma_f32_16x16x32_bf16 v[120:123], v[56:59], a[212:215], v[120:123]
    v_mfma_f32_16x16x32_bf16 v[124:127], a[240:243], a[212:215], v[124:127]
    v_mfma_f32_16x16x32_bf16 v[4:7], a[224:227], a[212:215], v[4:7]
    ds_read_b64_tr_b16 a[252:253], v205 offset:35600
    ds_read_b64_tr_b16 a[254:255], v205 offset:35584
    v_mfma_f32_16x16x32_bf16 v[8:11], a[208:211], a[212:215], v[8:11]
    buffer_store_dwordx4 v[248:251], v212, s[52:55], s59 offen offset:2048 sc1
    ds_read_b128 v[48:51], v206 offset:20736
    v_mfma_f32_16x16x32_bf16 v[120:123], v[76:79], a[220:223], v[120:123]
    v_mfma_f32_16x16x32_bf16 v[124:127], a[248:251], a[220:223], v[124:127]
    v_mfma_f32_16x16x32_bf16 v[4:7], a[232:235], a[220:223], v[4:7]
    ds_read_b64_tr_b16 v[40:41], v205 offset:35728
    ds_read_b64_tr_b16 v[42:43], v205 offset:35712
    v_mfma_f32_16x16x32_bf16 v[8:11], a[216:219], a[220:223], v[8:11]
    ds_read_b128 v[96:99], v207 offset:19712
    s_waitcnt lgkmcnt(6)
    v_mfma_f32_16x16x32_bf16 v[120:123], v[52:55], a[228:231], v[120:123]
    s_add_u32 s59, s58, 81920
    v_mfma_f32_16x16x32_bf16 v[124:127], v[56:59], a[228:231], v[124:127]
    v_mfma_f32_16x16x32_bf16 v[4:7], a[240:243], a[228:231], v[4:7]
    ds_read_b64_tr_b16 v[60:61], v205 offset:35856
    ds_read_b64_tr_b16 v[62:63], v205 offset:35840
    v_mfma_f32_16x16x32_bf16 v[8:11], a[224:227], a[228:231], v[8:11]
    ds_read_b128 v[68:71], v206 offset:19712
    v_mfma_f32_16x16x32_bf16 v[120:123], v[72:75], a[236:239], v[120:123]
    v_mfma_f32_16x16x32_bf16 v[124:127], v[76:79], a[236:239], v[124:127]
    buffer_store_dwordx4 v[248:251], v1, s[52:55], s59 offen offset:0 sc1
    v_mfma_f32_16x16x32_bf16 v[4:7], a[248:251], a[236:239], v[4:7]
    ds_read_b64_tr_b16 v[80:81], v205 offset:35984
    ds_read_b64_tr_b16 v[82:83], v205 offset:35968
    v_mfma_f32_16x16x32_bf16 v[8:11], a[232:235], a[236:239], v[8:11]
    ds_read_b128 v[104:107], v207 offset:18688
    v_mfma_f32_16x16x32_bf16 v[120:123], v[88:91], a[244:247], v[120:123]
    v_mfma_f32_16x16x32_bf16 v[124:127], v[52:55], a[244:247], v[124:127]
    v_mfma_f32_16x16x32_bf16 v[4:7], v[56:59], a[244:247], v[4:7]
    buffer_store_dwordx4 v[248:251], v1, s[52:55], s59 offen offset:1024 sc1
    ds_read_b64_tr_b16 v[84:85], v205 offset:36112
    ds_read_b64_tr_b16 v[86:87], v205 offset:36096
    v_mfma_f32_16x16x32_bf16 v[8:11], a[240:243], a[244:247], v[8:11]
    ds_read_b128 v[44:47], v206 offset:18688
    s_waitcnt lgkmcnt(6)
    v_mfma_f32_16x16x32_bf16 v[120:123], v[48:51], a[252:255], v[120:123]
    v_mfma_f32_16x16x32_bf16 v[124:127], v[72:75], a[252:255], v[124:127]
    v_mfma_f32_16x16x32_bf16 v[4:7], v[76:79], a[252:255], v[4:7]
    ds_read_b64_tr_b16 a[192:193], v205 offset:36240
    ds_read_b64_tr_b16 a[194:195], v205 offset:36224
    v_mfma_f32_16x16x32_bf16 v[8:11], a[248:251], a[252:255], v[8:11]
    buffer_store_dwordx4 v[248:251], v212, s[52:55], s59 offen offset:2048 sc1
    ds_read_b128 a[176:179], v207 offset:17664
    v_mfma_f32_16x16x32_bf16 v[120:123], v[96:99], v[40:43], v[120:123]
    v_mfma_f32_16x16x32_bf16 v[124:127], v[88:91], v[40:43], v[124:127]
    v_mfma_f32_16x16x32_bf16 v[4:7], v[52:55], v[40:43], v[4:7]
    ds_read_b64_tr_b16 a[168:169], v205 offset:36368
    ds_read_b64_tr_b16 a[170:171], v205 offset:36352
    v_mfma_f32_16x16x32_bf16 v[8:11], v[56:59], v[40:43], v[8:11]
    ds_read_b128 v[108:111], v206 offset:17664
    v_mfma_f32_16x16x32_bf16 v[120:123], v[68:71], v[60:63], v[120:123]
    v_mfma_f32_16x16x32_bf16 v[124:127], v[48:51], v[60:63], v[124:127]
    v_mfma_f32_16x16x32_bf16 v[4:7], v[72:75], v[60:63], v[4:7]
L_pad_t1_0:
    s_cbranch_execz L_pad_t1_1
    ds_read_b64_tr_b16 v[100:101], v205 offset:36496
    ds_read_b64_tr_b16 v[102:103], v205 offset:36480
    v_mfma_f32_16x16x32_bf16 v[8:11], v[76:79], v[60:63], v[8:11]
    s_waitcnt lgkmcnt(5)
    v_mfma_f32_16x16x32_bf16 v[120:123], v[104:107], v[80:83], v[120:123]
    v_mfma_f32_16x16x32_bf16 v[124:127], v[96:99], v[80:83], v[124:127]
    ds_read_b64_tr_b16 a[164:165], v205 offset:36624
    ds_read_b64_tr_b16 a[166:167], v205 offset:36608
    v_mfma_f32_16x16x32_bf16 v[4:7], v[88:91], v[80:83], v[4:7]
    v_mfma_f32_16x16x32_bf16 v[8:11], v[52:55], v[80:83], v[8:11]
    v_mfma_f32_16x16x32_bf16 v[120:123], v[44:47], v[84:87], v[120:123]
    ds_read_b64_tr_b16 v[64:65], v205 offset:36752
    ds_read_b64_tr_b16 v[66:67], v205 offset:36736
    v_mfma_f32_16x16x32_bf16 v[124:127], v[68:71], v[84:87], v[124:127]
    v_mfma_f32_16x16x32_bf16 v[4:7], v[48:51], v[84:87], v[4:7]
    ds_read_b64_tr_b16 a[172:173], v205 offset:36880
    ds_read_b64_tr_b16 a[174:175], v205 offset:36864
    v_mfma_f32_16x16x32_bf16 v[8:11], v[72:75], v[84:87], v[8:11]
    v_mfma_f32_16x16x32_bf16 v[120:123], a[176:179], a[192:195], v[120:123]
    ds_read_b64_tr_b16 a[184:185], v205 offset:37008
    ds_read_b64_tr_b16 a[186:187], v205 offset:36992
    v_mfma_f32_16x16x32_bf16 v[124:127], v[104:107], a[192:195], v[124:127]
    ds_read_b64_tr_b16 a[180:181], v205 offset:37136
    ds_read_b64_tr_b16 a[182:183], v205 offset:37120
    v_mfma_f32_16x16x32_bf16 v[4:7], v[96:99], a[192:195], v[4:7]
    v_mfma_f32_16x16x32_bf16 v[8:11], v[88:91], a[192:195], v[8:11]
    s_waitcnt lgkmcnt(8)
    v_mfma_f32_16x16x32_bf16 v[120:123], v[108:111], a[168:171], v[120:123]
    v_mfma_f32_16x16x32_bf16 v[124:127], v[44:47], a[168:171], v[124:127]
    v_mfma_f32_16x16x32_bf16 v[4:7], v[68:71], a[168:171], v[4:7]
    buffer_load_dword v3, v214, s[52:55], s67 offen sc1
    v_mfma_f32_16x16x32_bf16 v[8:11], v[48:51], a[168:171], v[8:11]
    v_mfma_f32_16x16x32_bf16 v[124:127], a[176:179], v[100:103], v[124:127]
    v_mfma_f32_16x16x32_bf16 v[4:7], v[104:107], v[100:103], v[4:7]
    s_nop 1
    v_add_f32_dpp v128, v121, v120 wave_shr:1 row_mask:0xf bank_mask:0xf bound_ctrl:0
    v_add_f32_dpp v129, v121, v122 wave_ror:1 row_mask:0xf bank_mask:0xf
    v_mfma_f32_16x16x32_bf16 v[8:11], v[96:99], v[100:103], v[8:11]
    s_nop 0
    v_add_f32_dpp v129, v123, v122 wave_shr:1 row_mask:0xf bank_mask:0xf
    ds_write2st64_b32 v208, v128, v129 offset0:4 offset1:12
    v_mfma_f32_16x16x32_bf16 v[124:127], v[108:111], a[164:167], v[124:127]
    v_mfma_f32_16x16x32_bf16 v[4:7], v[44:47], a[164:167], v[4:7]
    s_waitcnt vmcnt(17)
    v_xor_b32 v30, s6, v154
    s_waitcnt vmcnt(15)
    v_bitop3_b32 v30, v30, v158, s6 bitop3:0xf6
    v_cmp_ne_u32 vcc, 0, v30
    s_nop 0
    s_cmp_eq_u64 vcc, 0
    s_cbranch_scc0 L_stf31
L_sto30:
    v_mfma_f32_16x16x32_bf16 v[8:11], v[68:71], a[164:167], v[8:11]
    s_waitcnt lgkmcnt(1)
    v_mfma_f32_16x16x32_bf16 v[4:7], a[176:179], v[64:67], v[4:7]
    v_mfma_f32_16x16x32_bf16 v[8:11], v[104:107], v[64:67], v[8:11]
    v_mfma_f32_16x16x32_bf16 v[4:7], v[108:111], a[172:175], v[4:7]
    v_add_f32_dpp v130, v123, v124 wave_ror:1 row_mask:0xf bank_mask:0xf
    v_add_f32_dpp v131, v125, v126 wave_ror:1 row_mask:0xf bank_mask:0xf
    v_mfma_f32_16x16x32_bf16 v[8:11], v[44:47], a[172:175], v[8:11]
    v_add_f32_dpp v130, v125, v124 wave_shr:1 row_mask:0xf bank_mask:0xf
    v_add_f32_dpp v131, v127, v126 wave_shr:1 row_mask:0xf bank_mask:0xf
    v_mfma_f32_16x16x32_bf16 v[8:11], a[176:179], a[184:187], v[8:11]
    ds_write2st64_b32 v208, v130, v131 offset0:20 offset1:28
    v_mfma_f32_16x16x32_bf16 v[8:11], v[108:111], a[180:183], v[8:11]
    v_lshlrev_b32 v48, 16, v132
    v_and_b32 v49, s69, v132
    v_lshlrev_b32 v50, 16, v133
    v_and_b32 v51, s69, v133
    v_lshlrev_b32 v52, 16, v134
    v_and_b32 v53, s69, v134
    v_lshlrev_b32 v54, 16, v135
    v_and_b32 v55, s69, v135
    v_add_f32_dpp v128, v127, v4 wave_ror:1 row_mask:0xf bank_mask:0xf
    v_add_f32_dpp v129, v5, v6 wave_ror:1 row_mask:0xf bank_mask:0xf
    s_nop 0
    v_add_f32_dpp v128, v5, v4 wave_shr:1 row_mask:0xf bank_mask:0xf
    v_add_f32_dpp v129, v7, v6 wave_shr:1 row_mask:0xf bank_mask:0xf
    ds_write2st64_b32 v208, v128, v129 offset0:36 offset1:44
    v_add_f32_dpp v130, v7, v8 wave_ror:1 row_mask:0xf bank_mask:0xf
    v_add_f32_dpp v131, v9, v10 wave_ror:1 row_mask:0xf bank_mask:0xf
    s_nop 0
    v_add_f32_dpp v130, v9, v8 wave_shr:1 row_mask:0xf bank_mask:0xf
    v_add_f32_dpp v131, v11, v10 wave_shr:1 row_mask:0xf bank_mask:0xf
    ds_write2st64_b32 v208, v130, v131 offset0:52 offset1:60
    v_pk_fma_f32 v[56:57], v[48:49], v[152:153], v[152:153] op_sel:[0,0,1] op_sel_hi:[1,0,1]
    v_pk_fma_f32 v[58:59], v[50:51], v[152:153], v[152:153] op_sel:[0,0,1] op_sel_hi:[1,0,1]
    v_pk_fma_f32 v[60:61], v[52:53], v[152:153], v[152:153] op_sel:[0,0,1] op_sel_hi:[1,0,1]
    v_pk_fma_f32 v[62:63], v[54:55], v[152:153], v[152:153] op_sel:[0,0,1] op_sel_hi:[1,0,1]
    s_waitcnt vmcnt(14)
    v_lshlrev_b32 v72, 16, v136
    v_and_b32 v73, s69, v136
    v_lshlrev_b32 v74, 16, v137
    v_and_b32 v75, s69, v137
    v_lshlrev_b32 v76, 16, v138
    v_and_b32 v77, s69, v138
    v_lshlrev_b32 v78, 16, v139
    v_and_b32_e64 v79, s69, v139
    v_pk_fma_f32 v[80:81], v[72:73], v[156:157], v[156:157] op_sel:[0,0,1] op_sel_hi:[1,0,1]
    v_pk_fma_f32 v[82:83], v[74:75], v[156:157], v[156:157] op_sel:[0,0,1] op_sel_hi:[1,0,1]
    v_pk_fma_f32 v[84:85], v[76:77], v[156:157], v[156:157] op_sel:[0,0,1] op_sel_hi:[1,0,1]
    v_pk_fma_f32 v[86:87], v[78:79], v[156:157], v[156:157] op_sel:[0,0,1] op_sel_hi:[1,0,1]
    s_waitcnt lgkmcnt(0)
    s_barrier
    ds_read2st64_b32 v[40:41], v209 offset0:0 offset1:1
    ds_read2st64_b32 v[42:43], v209 offset0:2 offset1:3
    ds_read2st64_b32 v[44:45], v209 offset0:4 offset1:5
    ds_read2st64_b32 v[46:47], v209 offset0:6 offset1:7
    ds_read2st64_b32 v[64:65], v209 offset0:32 offset1:33
    ds_read2st64_b32 v[66:67], v209 offset0:34 offset1:35
    ds_read2st64_b32 v[68:69], v209 offset0:36 offset1:37
    ds_read2st64_b32 v[70:71], v209 offset0:38 offset1:39
    s_waitcnt lgkmcnt(7)
    v_pk_fma_f32 v[48:49], v[56:57], v[40:41], v[48:49]
    s_waitcnt lgkmcnt(6)
    v_pk_fma_f32 v[50:51], v[58:59], v[42:43], v[50:51]
    s_waitcnt lgkmcnt(5)
    v_pk_fma_f32 v[52:53], v[60:61], v[44:45], v[52:53]
    s_waitcnt lgkmcnt(4)
    v_pk_fma_f32 v[54:55], v[62:63], v[46:47], v[54:55]
    v_cvt_pk_bf16_f32 v196, v48, v49
    v_cvt_pk_bf16_f32 v197, v50, v51
    v_cvt_pk_bf16_f32 v198, v52, v53
    v_cvt_pk_bf16_f32 v199, v54, v55
    buffer_store_dwordx4 v[196:199], v215, s[52:55], s83 offen sc1
    s_waitcnt lgkmcnt(3)
    v_pk_fma_f32 v[72:73], v[80:81], v[64:65], v[72:73]
    s_waitcnt lgkmcnt(2)
    v_pk_fma_f32 v[74:75], v[82:83], v[66:67], v[74:75]
    s_waitcnt lgkmcnt(1)
    v_pk_fma_f32 v[76:77], v[84:85], v[68:69], v[76:77]
    s_waitcnt lgkmcnt(0)
    v_pk_fma_f32 v[78:79], v[86:87], v[70:71], v[78:79]
    v_cvt_pk_bf16_f32 v200, v72, v73
    v_cvt_pk_bf16_f32 v201, v74, v75
    v_cvt_pk_bf16_f32 v202, v76, v77
    v_cvt_pk_bf16_f32 v203, v78, v79
    buffer_store_dwordx4 v[200:203], v216, s[52:55], s83 offen sc1
    s_waitcnt vmcnt(2)
    v_cmp_eq_u32 s[90:91], s6, v3
    s_nop 0
    s_cmp_eq_u64 s[90:91], -1
    s_cbranch_scc0 L_pollf35
L_polld33:
    s_add_u32 m0, s77, 0
    s_add_u32 s74, s75, 0
    buffer_load_dwordx4 v1, s[52:55], s74 offen sc1 lds
    buffer_load_dwordx4 v1, s[52:55], s74 offen offset:1024 sc1 lds
    buffer_load_dwordx4 v1, s[52:55], s74 offen offset:2048 sc1 lds
    buffer_load_dwordx4 v1, s[52:55], s74 offen offset:3072 sc1 lds
    s_mul_i32 s61, s60, 20
    v_add_u32 v14, 65536, v1
    v_add_u32 v15, 81920, v1
    s_and_b32 s80, s3, 1
    s_and_b32 s68, s4, 7
    v_lshrrev_b32 v8, 4, v0
    v_and_b32 v9, 15, v0
    v_lshlrev_b32 v9, 4, v9
    v_lshl_add_u32 v9, v8, 15, v9
    s_lshl_b32 s73, s80, 8
    v_add_u32 v21, s73, v9
    v_xor_b32 v16, 256, v21
    s_lshr_b32 s64, s4, 3
    s_and_b32 s65, s3, 6
    s_lshl_b32 s65, s65, 1
    s_add_u32 s67, s64, s65
    s_lshl_b32 s64, s67, 2
    s_add_u32 s65, s64, s5
    s_lshl_b32 s64, s65, 9
    s_add_u32 s64, s64, 0x390000
    s_mul_i32 s79, s68, 327680
    s_add_u32 s79, s79, s64
    s_lshl_b32 s73, s5, 10
    s_add_u32 s73, s73, 155648
    v_lshl_add_u32 v20, v8, 4, s73
    s_lshl_b32 s81, s65, 1
    s_add_u32 s81, s81, s80
    s_mul_i32 s81, s81, 57344
    s_add_u32 s81, s81, 0x610000
    s_mul_i32 s76, s68, 7168
    s_add_u32 s76, s76, s81
    s_add_u32 s69, s76, 3072
    s_mov_b32 s1, s57
    s_lshl_b32 s0, s68, 2
    s_add_u32 s0, s0, s57
    s_add_u32 s59, s0, 64
    v_lshrrev_b32 v5, 6, v225
    v_bfe_u32 v9, v0, 2, 2
    v_and_b32 v13, 15, v0
    v_lshl_add_u32 v12, v9, 4, v13
    v_lshlrev_b32_e64 v12, 2, v12
    v_lshl_add_u32 v13, v13, 2, 64
    v_add_u32 v13, 128, v13
    v_mov_b32 v11, 0x3f800054
    s_mov_b32 s86, 0x3acccccd
    s_mov_b32 s88, 0xaaaaaaaa
    s_mov_b32 s89, 0xaaaaaaaa
    s_mov_b32 s82, 0xcccccccc
    s_mov_b32 s83, 0xcccccccc
    s_mov_b32 s84, 0
    s_mov_b32 s85, 0xffff0000
    v_mov_b32 v22, 0xc0135761
    v_mov_b32 v23, 0xbdd2d3e8
    s_waitcnt vmcnt(4)
    s_barrier
    s_cmp_lg_u32 s5, 0
    s_cbranch_scc1 L_post36
    buffer_store_dword v226, v227, s[52:55], s99 offen
L_post36:
    v_min_u32 v17, 55, v0
    v_lshlrev_b32 v18, 3, v17
    v_lshlrev_b32 v17, 2, v17
    s_mul_i32 s72, s5, 5
    s_add_u32 s72, s72, s61
    s_mul_i32 s72, s72, 448
    s_add_u32 s72, s72, 0x1170000
    s_mul_i32 s70, s60, 216
    buffer_load_dwordx2 v[176:177], v18, s[52:55], s72 offen offset:0 sc1
    buffer_load_dwordx2 v[178:179], v18, s[52:55], s72 offen offset:448 sc1
    buffer_load_dwordx2 v[180:181], v18, s[52:55], s72 offen offset:896 sc1
    buffer_load_dwordx2 v[182:183], v18, s[52:55], s72 offen offset:1344 sc1
    buffer_load_dwordx2 v[184:185], v18, s[52:55], s72 offen offset:1792 sc1
    buffer_load_dword v187, v17, s[36:39], s70 offen
    v_lshrrev_b32 v10, 4, v0
    v_lshlrev_b32 v4, 4, v10
    s_mul_i32 s72, s68, 160
    v_lshlrev_b32_e64 v8, 3, v10
    buffer_load_dwordx4 v[122:125], v4, s[44:47], s72 offen
    buffer_load_dwordx4 v[126:129], v4, s[44:47], s72 offen offset:64
    buffer_load_dwordx2 v[130:131], v8, s[44:47], s72 offen offset:128
    v_and_b32 v6, 0x1f0, v21
    v_lshrrev_b32 v4, 5, v0
    v_lshl_add_u32 v6, v4, 15, v6
    v_and_b32 v4, 1, v10
    v_lshl_add_u32 v6, v4, 3, v6
    s_add_u32 s70, s79, 131072
    s_add_u32 s71, s79, 262144
    s_add_u32 m0, s77, 16384
    s_add_u32 s74, s75, 16384
    buffer_load_dwordx4 v1, s[52:55], s74 offen sc1 lds
    buffer_load_dwordx4 v1, s[52:55], s74 offen offset:1024 sc1 lds
    buffer_load_dwordx4 v1, s[52:55], s74 offen offset:2048 sc1 lds
    buffer_load_dwordx4 v1, s[52:55], s74 offen offset:3072 sc1 lds
    s_add_u32 m0, s77, 32768
    s_add_u32 s74, s75, 32768
    buffer_load_dwordx4 v1, s[52:55], s74 offen sc1 lds
    buffer_load_dwordx4 v1, s[52:55], s74 offen offset:1024 sc1 lds
    buffer_load_dwordx4 v1, s[52:55], s74 offen offset:2048 sc1 lds
    buffer_load_dwordx4 v1, s[52:55], s74 offen offset:3072 sc1 lds
    s_add_u32 m0, s77, 49152
    s_add_u32 s74, s75, 49152
    buffer_load_dwordx4 v1, s[52:55], s74 offen sc1 lds
    buffer_load_dwordx4 v1, s[52:55], s74 offen offset:1024 sc1 lds
    buffer_load_dwordx4 v1, s[52:55], s74 offen offset:2048 sc1 lds
    buffer_load_dwordx4 v1, s[52:55], s74 offen offset:3072 sc1 lds
    s_add_u32 m0, s77, 65536
    s_add_u32 s74, s75, 65536
    buffer_load_dwordx4 v1, s[52:55], s74 offen sc1 lds
    buffer_load_dwordx4 v1, s[52:55], s74 offen offset:1024 sc1 lds
    buffer_load_dwordx4 v1, s[52:55], s74 offen offset:2048 sc1 lds
    buffer_load_dwordx4 v1, s[52:55], s74 offen offset:3072 sc1 lds
    s_branch L_convdone
L_t2:
    v_lshrrev_b32 v91, 4, v0
    v_bfe_u32 v92, v0, 2, 2
    v_and_b32 v93, 3, v0
    v_and_b32 v94, 1, v92
    v_mul_u32_u24 v94, 4220, v94
    v_lshl_add_u32 v94, v91, 5, v94
    v_lshl_add_u32 v94, v93, 3, v94
    v_lshlrev_b32 v95, 2, v92
    v_sub_u32 v94, v94, v95
    s_add_u32 s75, s73, 16
    v_add_u32 v205, s75, v94
    v_bfe_u32 v94, v0, 1, 1
    v_lshl_add_u32 v94, v94, 2, v92
    v_sub_u32 v94, v94, v91
    v_and_b32 v96, 1, v0
    v_add_u32 v95, 12, v94
    v_bfe_u32 v97, v95, 1, 2
    v_xor_b32 v97, s5, v97
    v_lshlrev_b32_e64 v97, 4, v97
    v_lshl_add_u32 v97, v96, 6, v97
    v_lshl_add_u32 v97, v95, 7, v97
    v_add_u32 v206, 66816, v97
    v_add_u32 v95, 16, v94
    v_bfe_u32 v97, v95, 1, 2
    v_xor_b32 v97, s5, v97
    v_lshlrev_b32_e64 v97, 4, v97
    v_lshl_add_u32 v97, v96, 6, v97
    v_lshl_add_u32 v97, v95, 7, v97
    v_add_u32 v207, 66816, v97
    s_lshl_b32 s74, s5, 8
    s_add_u32 s74, s74, 102912
    v_lshl_add_u32 v208, v0, 2, s74
    s_lshl_b32 s74, s5, 11
    s_add_u32 s74, s74, 102912
    v_lshl_add_u32 v209, v0, 2, s74
    s_lshl_b32 s74, s5, 6
    s_add_u32 s74, s74, 1664
    v_add_u32 v98, s74, v0
    s_lshl_b32 s83, s70, 15
    s_add_u32 s83, s83, 0x390000
    s_mov_b32 s79, 0x40000
    s_lshl_b32 s68, s70, 4
    v_add_u32 v99, 0, v98
    v_max_i32 v100, 1680, v99
    v_min_i32 v100, 2047, v100
    v_cmp_eq_u32 vcc, v99, v100
    v_lshlrev_b32 v220, 5, v100
    v_mul_u32_u24 v24, 1280, v100
    v_lshlrev_b32_e64 v100, 4, v100
    v_cndmask_b32 v215, v231, v100, vcc
    v_add_u32 v99, 256, v98
    v_max_i32 v100, 1680, v99
    v_min_i32 v100, 2047, v100
    v_cmp_eq_u32 vcc, v99, v100
    v_lshlrev_b32 v221, 5, v100
    v_mul_u32_u24 v25, 1280, v100
    v_lshlrev_b32 v100, 4, v100
    v_cndmask_b32 v216, v231, v100, vcc
    s_waitcnt vmcnt(9)
    ds_read_b32 v116, v115 offset:32
    v_lshlrev_b32 v117, 16, v117
    s_waitcnt lgkmcnt(0)
    v_lshlrev_b32 v123, 16, v116
    v_add_f32_e64 v123, v117, v123
    v_and_b32 v116, 0xffff0000, v116
    v_cvt_pk_bf16_f32 v123, v123, v116
    ds_write_b32 v115, v123 offset:32
    ds_read_b64 v[56:57], v118 offset:32
    ds_read_b64 v[58:59], v118 offset:544
    ds_read_b64 v[60:61], v118 offset:1056
    ds_read_b64 v[62:63], v118 offset:1568
    ds_read_b64 v[64:65], v118 offset:2080
    ds_read_b64 v[66:67], v118 offset:2592
    ds_read_b64 v[68:69], v118 offset:3104
    ds_read_b64 v[70:71], v118 offset:3616
    ds_read_b64 v[72:73], v118 offset:33824
    ds_read_b64 v[74:75], v118 offset:34336
    ds_read_b64 v[76:77], v118 offset:34848
    ds_read_b64 v[78:79], v118 offset:35360
    ds_read_b64 v[80:81], v118 offset:35872
    ds_read_b64 v[82:83], v118 offset:36384
    ds_read_b64 v[84:85], v118 offset:36896
    ds_read_b64 v[86:87], v118 offset:37408
    s_waitcnt lgkmcnt(8)
    s_nop 0
    ds_write2_b32 v119, v56, v57 offset0:0 offset1:1
    ds_write2_b32 v119, v58, v59 offset0:128 offset1:129
    v_add_u32 v119, 1024, v119
    ds_write2_b32 v119, v60, v61 offset0:0 offset1:1
    ds_write2_b32 v119, v62, v63 offset0:128 offset1:129
    v_add_u32 v119, 1024, v119
    ds_write2_b32 v119, v64, v65 offset0:0 offset1:1
    ds_write2_b32 v119, v66, v67 offset0:128 offset1:129
    v_add_u32 v119, 1024, v119
    ds_write2_b32 v119, v68, v69 offset0:0 offset1:1
    ds_write2_b32 v119, v70, v71 offset0:128 offset1:129
    v_add_u32 v119, 30720, v119
    s_waitcnt lgkmcnt(8)
    s_nop 0
    ds_write2_b32 v119, v72, v73 offset0:0 offset1:1
    ds_write2_b32 v119, v74, v75 offset0:128 offset1:129
    v_add_u32 v119, 1024, v119
    ds_write2_b32 v119, v76, v77 offset0:0 offset1:1
    ds_write2_b32 v119, v78, v79 offset0:128 offset1:129
    v_add_u32 v119, 1024, v119
    ds_write2_b32 v119, v80, v81 offset0:0 offset1:1
    ds_write2_b32 v119, v82, v83 offset0:128 offset1:129
    v_add_u32 v119, 1024, v119
    ds_write2_b32 v119, v84, v85 offset0:0 offset1:1
    ds_write2_b32 v119, v86, v87 offset0:128 offset1:129
    s_cmp_lg_u32 s5, 1
    s_cbranch_scc1 L_wk37
    s_mov_b64 exec, 0
    s_branch L_pad_t2_0
L_pad_t2_1:
    s_mov_b64 exec, -1
L_wk37:
    s_cmp_lg_u32 s5, 0
    s_cbranch_scc1 L_polld39
    s_mov_b64 s[90:91], 0
    s_mov_b32 s92, 0
    s_waitcnt vmcnt(0)
    buffer_load_dword v31, v214, s[52:55], s67 offen sc1
    buffer_load_dword v30, v214, s[52:55], s67 offen sc1
L_poll38:
    buffer_load_dword v3, v214, s[52:55], s67 offen sc1
    s_add_u32 s92, s92, 1
    s_waitcnt vmcnt(2)
    v_cmp_eq_u32 vcc, s6, v31
    s_nop 0
    s_or_b64 s[90:91], s[90:91], vcc
    s_cmp_eq_u64 s[90:91], -1
    s_cbranch_scc1 L_polld39
    buffer_load_dword v31, v214, s[52:55], s67 offen sc1
    s_waitcnt vmcnt(2)
    v_cmp_eq_u32 vcc, s6, v30
    s_nop 0
    s_or_b64 s[90:91], s[90:91], vcc
    s_cmp_eq_u64 s[90:91], -1
    s_cbranch_scc1 L_polld39
    s_cmp_lg_u32 s92, 64
    s_cbranch_scc1 L_polln40
    s_xor_b32 s93, s0, 0x8000
    buffer_store_dword v226, v227, s[52:55], s93 offen sc1
L_polln40:
    buffer_load_dword v30, v214, s[52:55], s67 offen sc1
    s_waitcnt vmcnt(2)
    v_cmp_eq_u32 vcc, s6, v3
    s_nop 0
    s_or_b64 s[90:91], s[90:91], vcc
    s_cmp_eq_u64 s[90:91], -1
    s_cbranch_scc1 L_polld39
    s_cmp_lt_u32 s92, 0x200000
    s_cbranch_scc1 L_poll38
L_polld39:
    s_waitcnt vmcnt(0)
    s_barrier
    s_add_u32 m0, s72, 81152
    s_add_u32 s75, s76, 12288
    buffer_load_dwordx4 v1, s[52:55], s75 offen sc1 lds
    s_add_u32 m0, s72, 77056
    s_add_u32 s75, s76, 8192
    buffer_load_dwordx4 v1, s[52:55], s75 offen sc1 lds
    s_add_u32 m0, s72, 72960
    s_add_u32 s75, s76, 4096
    buffer_load_dwordx4 v1, s[52:55], s75 offen sc1 lds
    s_add_u32 m0, s72, 68864
    s_add_u32 s75, s76, 0
    s_nop 0
    buffer_load_dwordx4 v1, s[52:55], s75 offen sc1 lds
    s_add_u32 m0, s72, 98816
    s_add_u32 s75, s76, 28672
    buffer_load_dwordx4 v1, s[52:55], s75 offen sc1 lds
    s_add_u32 m0, s72, 94720
    s_add_u32 s75, s76, 24576
    buffer_load_dwordx4 v1, s[52:55], s75 offen sc1 lds
    s_add_u32 m0, s72, 90624
    s_add_u32 s75, s76, 20480
    buffer_load_dwordx4 v1, s[52:55], s75 offen sc1 lds
    s_add_u32 m0, s72, 86528
    s_add_u32 s75, s76, 16384
    buffer_load_dwordx4 v1, s[52:55], s75 offen sc1 lds
    ds_read_b64_tr_b16 v[160:161], v247 offset:0
    ds_read_b64_tr_b16 v[162:163], v247 offset:3520
    ds_read_b64_tr_b16 v[164:165], v247 offset:32
    ds_read_b64_tr_b16 v[166:167], v247 offset:3552
    ds_read_b64_tr_b16 v[168:169], v247 offset:64
    ds_read_b64_tr_b16 v[170:171], v247 offset:3584
    ds_read_b64_tr_b16 v[172:173], v247 offset:96
    ds_read_b64_tr_b16 v[174:175], v247 offset:3616
    ds_read_b64_tr_b16 v[176:177], v247 offset:128
    ds_read_b64_tr_b16 v[178:179], v247 offset:3648
    ds_read_b64_tr_b16 v[180:181], v247 offset:160
    ds_read_b64_tr_b16 v[182:183], v247 offset:3680
    ds_read_b64_tr_b16 v[184:185], v247 offset:192
    ds_read_b64_tr_b16 v[186:187], v247 offset:3712
    s_mov_b32 s90, 0xf000f000
    s_mov_b32 s91, 0xf000f000
    s_mov_b32 s92, 0xffff0000
    s_mov_b32 s93, 0xffff0000
    s_mov_b32 vcc_lo, 0
    s_mov_b32 vcc_hi, -1
    s_waitcnt lgkmcnt(0)
    v_mfma_f32_16x16x32_bf16 v[140:143], v[232:235], v[160:163], 0
    v_mfma_f32_16x16x32_bf16 v[144:147], v[232:235], v[164:167], 0
    v_mfma_f32_16x16x32_bf16 v[148:151], v[232:235], v[168:171], 0
    v_mfma_f32_16x16x32_bf16 v[188:191], v[232:235], v[172:175], 0
    v_mfma_f32_16x16x32_bf16 v[192:195], v[232:235], v[176:179], 0
    v_mfma_f32_16x16x32_bf16 v[196:199], v[232:235], v[180:183], 0
    v_mfma_f32_16x16x32_bf16 v[200:203], v[232:235], v[184:187], 0
    v_cndmask_b32 v184, v184, v232, s[90:91]
    v_cndmask_b32 v185, v185, v232, s[90:91]
    v_cndmask_b32 v186, v186, v232, s[90:91]
    v_cndmask_b32 v187, v187, v232, s[90:91]
    v_cndmask_b32 v236, v140, v144, s[92:93]
    v_cndmask_b32 v237, v148, v188, s[92:93]
    v_cndmask_b32 v236, v236, v237, vcc
    v_cndmask_b32 v237, v192, v196, s[92:93]
    v_cndmask_b32 v237, v237, v200, vcc
    buffer_store_dwordx4 v[160:163], v1, s[52:55], s85 offen offset:0 sc1
    buffer_store_dwordx4 v[164:167], v1, s[52:55], s85 offen offset:1024 sc1
    s_mov_b32 s80, s77
    s_add_u32 s67, s67, 0x4000
    s_and_b32 s60, s3, 1
    s_lshl_b32 s60, s60, 3
    s_and_b32 s61, s4, 7
    s_add_u32 s60, s60, s61
    s_mul_i32 s61, s60, 143360
    s_add_u32 s61, s61, 0xd10000
    s_lshl_b32 s63, s5, 10
    s_add_u32 s62, s61, s63
    s_lshl_b32 s77, s5, 12
    s_add_u32 s75, s61, s77
    s_waitcnt vmcnt(8)
    s_barrier
    ds_read_b64_tr_b16 v[40:41], v205 offset:16
    ds_read_b64_tr_b16 v[42:43], v205 offset:0
    ds_read_b128 v[44:47], v207 offset:13312
    ds_read_b128 v[48:51], v207 offset:14336
    ds_read_b128 v[52:55], v207 offset:15360
    ds_read_b64_tr_b16 v[56:57], v205 offset:144
    ds_read_b64_tr_b16 v[58:59], v205 offset:128
    ds_read_b128 v[60:63], v206 offset:13312
    ds_read_b128 v[64:67], v206 offset:14336
    ds_read_b128 v[68:71], v206 offset:15360
    ds_read_b64_tr_b16 v[72:73], v205 offset:272
    ds_read_b64_tr_b16 v[74:75], v205 offset:256
    ds_read_b128 v[76:79], v207 offset:12288
    s_waitcnt lgkmcnt(10)
    v_mfma_f32_16x16x32_bf16 v[32:35], v[44:47], v[40:43], 0
    ds_read_b64_tr_b16 v[80:81], v205 offset:400
    ds_read_b64_tr_b16 v[82:83], v205 offset:384
    s_waitcnt lgkmcnt(11)
    v_mfma_f32_16x16x32_bf16 v[36:39], v[48:51], v[40:43], 0
    buffer_store_dwordx4 v[168:171], v1, s[52:55], s85 offen offset:2048 sc1
    ds_read_b128 v[84:87], v206 offset:12288
    s_waitcnt lgkmcnt(11)
    v_mfma_f32_16x16x32_bf16 v[112:115], v[52:55], v[40:43], 0
    ds_read_b64_tr_b16 v[88:89], v205 offset:528
    ds_read_b64_tr_b16 v[90:91], v205 offset:512
    s_waitcnt lgkmcnt(10)
    v_mfma_f32_16x16x32_bf16 v[32:35], v[60:63], v[56:59], v[32:35]
    buffer_store_dwordx4 v[172:175], v1, s[52:55], s86 offen offset:0 sc1
    ds_read_b128 v[92:95], v207 offset:11264
    s_waitcnt lgkmcnt(10)
    v_mfma_f32_16x16x32_bf16 v[36:39], v[64:67], v[56:59], v[36:39]
    buffer_store_dwordx4 v[252:255], v210, s[52:55], s66 offen sc1
    ds_read_b64_tr_b16 v[96:97], v205 offset:656
    ds_read_b64_tr_b16 v[98:99], v205 offset:640
    s_waitcnt lgkmcnt(11)
    v_mfma_f32_16x16x32_bf16 v[112:115], v[68:71], v[56:59], v[112:115]
    buffer_store_dwordx4 v[176:179], v1, s[52:55], s86 offen offset:1024 sc1
    ds_read_b128 v[100:103], v206 offset:11264
    s_waitcnt lgkmcnt(9)
    v_mfma_f32_16x16x32_bf16 v[32:35], v[76:79], v[72:75], v[32:35]
    ds_read_b64_tr_b16 v[104:105], v205 offset:784
    ds_read_b64_tr_b16 v[106:107], v205 offset:768
    v_mfma_f32_16x16x32_bf16 v[36:39], v[44:47], v[72:75], v[36:39]
    buffer_store_dwordx4 v[180:183], v1, s[52:55], s86 offen offset:2048 sc1
    ds_read_b128 v[108:111], v207 offset:10240
    v_mfma_f32_16x16x32_bf16 v[112:115], v[48:51], v[72:75], v[112:115]
    ds_read_b64_tr_b16 a[160:161], v205 offset:912
    ds_read_b64_tr_b16 a[162:163], v205 offset:896
    s_waitcnt lgkmcnt(11)
    v_mfma_f32_16x16x32_bf16 v[32:35], v[84:87], v[80:83], v[32:35]
    buffer_store_dwordx4 v[184:187], v1, s[52:55], s86 offen offset:3072 sc1
    ds_read_b128 a[164:167], v206 offset:10240
    v_mfma_f32_16x16x32_bf16 v[36:39], v[60:63], v[80:83], v[36:39]
    ds_read_b64_tr_b16 a[168:169], v205 offset:1040
    ds_read_b64_tr_b16 a[170:171], v205 offset:1024
    v_mfma_f32_16x16x32_bf16 v[112:115], v[64:67], v[80:83], v[112:115]
    buffer_store_dword v236, v238, s[52:55], s87 offen sc1
    ds_read_b128 a[172:175], v207 offset:9216
    s_waitcnt lgkmcnt(12)
    v_mfma_f32_16x16x32_bf16 v[32:35], v[92:95], v[88:91], v[32:35]
    ds_read_b64_tr_b16 a[176:177], v205 offset:1168
    ds_read_b64_tr_b16 a[178:179], v205 offset:1152
    v_mfma_f32_16x16x32_bf16 v[36:39], v[76:79], v[88:91], v[36:39]
    buffer_store_dword v237, v239, s[52:55], s87 offen offset:256 sc1
    ds_read_b128 a[180:183], v206 offset:9216
    v_mfma_f32_16x16x32_bf16 v[112:115], v[44:47], v[88:91], v[112:115]
    ds_read_b64_tr_b16 a[184:185], v205 offset:1296
    ds_read_b64_tr_b16 a[186:187], v205 offset:1280
    s_waitcnt lgkmcnt(12)
    v_mfma_f32_16x16x32_bf16 v[32:35], v[100:103], v[96:99], v[32:35]
    v_mfma_f32_16x16x32_bf16 v[36:39], v[84:87], v[96:99], v[36:39]
    v_mfma_f32_16x16x32_bf16 v[112:115], v[60:63], v[96:99], v[112:115]
    s_waitcnt lgkmcnt(8)
    v_mfma_f32_16x16x32_bf16 v[32:35], v[108:111], v[104:107], v[32:35]
    v_mfma_f32_16x16x32_bf16 v[36:39], v[92:95], v[104:107], v[36:39]
    v_mfma_f32_16x16x32_bf16 v[112:115], v[76:79], v[104:107], v[112:115]
    v_mfma_f32_16x16x32_bf16 v[32:35], a[164:167], a[160:163], v[32:35]
    v_mfma_f32_16x16x32_bf16 v[36:39], v[100:103], a[160:163], v[36:39]
    s_waitcnt vmcnt(14)
    s_barrier
    ds_read_b128 a[188:191], v207 offset:8192
    v_mfma_f32_16x16x32_bf16 v[112:115], v[84:87], a[160:163], v[112:115]
    ds_read_b64_tr_b16 a[192:193], v205 offset:1424
    ds_read_b64_tr_b16 a[194:195], v205 offset:1408
    s_waitcnt lgkmcnt(3)
    v_mfma_f32_16x16x32_bf16 v[32:35], a[172:175], a[168:171], v[32:35]
    buffer_load_dwordx4 v[152:155], v220, s[52:55], s79 offen sc1
    ds_read_b128 a[196:199], v206 offset:8192
    v_mfma_f32_16x16x32_bf16 v[36:39], v[108:111], a[168:171], v[36:39]
    ds_read_b64_tr_b16 a[200:201], v205 offset:1552
    ds_read_b64_tr_b16 a[202:203], v205 offset:1536
    v_mfma_f32_16x16x32_bf16 v[112:115], v[92:95], a[168:171], v[112:115]
    ds_read_b128 a[204:207], v207 offset:7168
    ds_read_b64_tr_b16 a[208:209], v205 offset:1680
    ds_read_b64_tr_b16 a[210:211], v205 offset:1664
    v_mfma_f32_16x16x32_bf16 v[32:35], a[180:183], a[176:179], v[32:35]
    buffer_load_dwordx4 v[156:159], v221, s[52:55], s79 offen sc1
    ds_read_b128 a[212:215], v206 offset:7168
    v_mfma_f32_16x16x32_bf16 v[36:39], a[164:167], a[176:179], v[36:39]
    ds_read_b64_tr_b16 a[216:217], v205 offset:1808
    ds_read_b64_tr_b16 a[218:219], v205 offset:1792
    v_mfma_f32_16x16x32_bf16 v[112:115], v[100:103], a[176:179], v[112:115]
    ds_read_b128 a[220:223], v207 offset:6144
    ds_read_b64_tr_b16 a[224:225], v205 offset:1936
    ds_read_b64_tr_b16 a[226:227], v205 offset:1920
    s_waitcnt lgkmcnt(14)
    v_mfma_f32_16x16x32_bf16 v[32:35], a[188:191], a[184:187], v[32:35]
    buffer_load_dwordx4 v[132:135], v24, s[8:11], s68 offen
    ds_read_b128 a[228:231], v206 offset:6144
    v_mfma_f32_16x16x32_bf16 v[36:39], a[172:175], a[184:187], v[36:39]
    ds_read_b64_tr_b16 a[232:233], v205 offset:2064
    ds_read_b64_tr_b16 a[234:235], v205 offset:2048
    v_mfma_f32_16x16x32_bf16 v[112:115], v[108:111], a[184:187], v[112:115]
    ds_read_b128 a[236:239], v207 offset:5120
    s_waitcnt lgkmcnt(15)
    v_mfma_f32_16x16x32_bf16 v[32:35], a[196:199], a[192:195], v[32:35]
    ds_read_b64_tr_b16 a[240:241], v205 offset:2192
L_pad_t2_0:
    s_cbranch_execz L_pad_t2_1
    ds_read_b64_tr_b16 a[242:243], v205 offset:2176
    v_mfma_f32_16x16x32_bf16 v[36:39], a[180:183], a[192:195], v[36:39]
    ds_read_b128 a[244:247], v206 offset:5120
    v_mfma_f32_16x16x32_bf16 v[112:115], a[164:167], a[192:195], v[112:115]
    s_waitcnt lgkmcnt(12)
    v_mfma_f32_16x16x32_bf16 v[32:35], a[204:207], a[200:203], v[32:35]
    ds_read_b64_tr_b16 a[248:249], v205 offset:2320
    ds_read_b64_tr_b16 a[250:251], v205 offset:2304
    v_mfma_f32_16x16x32_bf16 v[36:39], a[188:191], a[200:203], v[36:39]
    ds_read_b128 a[252:255], v207 offset:4096
    v_mfma_f32_16x16x32_bf16 v[112:115], a[172:175], a[200:203], v[112:115]
    v_mfma_f32_16x16x32_bf16 v[32:35], a[212:215], a[208:211], v[32:35]
    ds_read_b64_tr_b16 v[52:53], v205 offset:2448
    ds_read_b64_tr_b16 v[54:55], v205 offset:2432
    v_mfma_f32_16x16x32_bf16 v[36:39], a[196:199], a[208:211], v[36:39]
    ds_read_b128 v[40:43], v206 offset:4096
    v_mfma_f32_16x16x32_bf16 v[112:115], a[180:183], a[208:211], v[112:115]
    s_waitcnt lgkmcnt(7)
    v_mfma_f32_16x16x32_bf16 v[32:35], a[220:223], a[216:219], v[32:35]
    ds_read_b64_tr_b16 v[68:69], v205 offset:2576
    ds_read_b64_tr_b16 v[70:71], v205 offset:2560
    v_mfma_f32_16x16x32_bf16 v[36:39], a[204:207], a[216:219], v[36:39]
    ds_read_b128 v[56:59], v207 offset:3072
    v_mfma_f32_16x16x32_bf16 v[112:115], a[188:191], a[216:219], v[112:115]
    v_mfma_f32_16x16x32_bf16 v[32:35], a[228:231], a[224:227], v[32:35]
    ds_read_b64_tr_b16 v[48:49], v205 offset:2704
    ds_read_b64_tr_b16 v[50:51], v205 offset:2688
    v_mfma_f32_16x16x32_bf16 v[36:39], a[212:215], a[224:227], v[36:39]
    ds_read_b128 v[72:75], v206 offset:3072
    v_mfma_f32_16x16x32_bf16 v[112:115], a[196:199], a[224:227], v[112:115]
    v_mfma_f32_16x16x32_bf16 v[32:35], a[236:239], a[232:235], v[32:35]
    ds_read_b64_tr_b16 v[64:65], v205 offset:2832
    ds_read_b64_tr_b16 v[66:67], v205 offset:2816
    v_mfma_f32_16x16x32_bf16 v[36:39], a[220:223], a[232:235], v[36:39]
    ds_read_b128 v[80:83], v207 offset:2048
    v_mfma_f32_16x16x32_bf16 v[112:115], a[204:207], a[232:235], v[112:115]
    s_waitcnt lgkmcnt(7)
    v_mfma_f32_16x16x32_bf16 v[32:35], a[244:247], a[240:243], v[32:35]
    ds_read_b64_tr_b16 v[44:45], v205 offset:2960
    ds_read_b64_tr_b16 v[46:47], v205 offset:2944
    v_mfma_f32_16x16x32_bf16 v[36:39], a[228:231], a[240:243], v[36:39]
    ds_read_b128 v[88:91], v206 offset:2048
    v_mfma_f32_16x16x32_bf16 v[112:115], a[212:215], a[240:243], v[112:115]
    v_mfma_f32_16x16x32_bf16 v[32:35], a[252:255], a[248:251], v[32:35]
    ds_read_b64_tr_b16 v[60:61], v205 offset:3088
    ds_read_b64_tr_b16 v[62:63], v205 offset:3072
    v_mfma_f32_16x16x32_bf16 v[36:39], a[236:239], a[248:251], v[36:39]
    ds_read_b128 v[96:99], v207 offset:1024
    v_mfma_f32_16x16x32_bf16 v[112:115], a[220:223], a[248:251], v[112:115]
    v_mfma_f32_16x16x32_bf16 v[32:35], v[40:43], v[52:55], v[32:35]
    ds_read_b64_tr_b16 v[76:77], v205 offset:3216
    ds_read_b64_tr_b16 v[78:79], v205 offset:3200
    v_mfma_f32_16x16x32_bf16 v[36:39], a[244:247], v[52:55], v[36:39]
    ds_read_b128 v[104:107], v206 offset:1024
    v_mfma_f32_16x16x32_bf16 v[112:115], a[228:231], v[52:55], v[112:115]
    s_waitcnt lgkmcnt(7)
    v_mfma_f32_16x16x32_bf16 v[32:35], v[56:59], v[68:71], v[32:35]
    s_waitcnt vmcnt(13)
    s_barrier
    ds_read_b64_tr_b16 v[84:85], v205 offset:3344
    ds_read_b64_tr_b16 v[86:87], v205 offset:3328
    v_mfma_f32_16x16x32_bf16 v[36:39], a[252:255], v[68:71], v[36:39]
    ds_read_b128 a[160:163], v207 offset:0
    v_mfma_f32_16x16x32_bf16 v[112:115], a[236:239], v[68:71], v[112:115]
    v_mfma_f32_16x16x32_bf16 v[32:35], v[72:75], v[48:51], v[32:35]
    ds_read_b64_tr_b16 v[92:93], v205 offset:3472
    ds_read_b64_tr_b16 v[94:95], v205 offset:3456
    v_mfma_f32_16x16x32_bf16 v[36:39], v[40:43], v[48:51], v[36:39]
    s_waitcnt vmcnt(3)
    s_barrier
    s_cmp_lg_u32 s5, 0
    s_cbranch_scc1 L_post41
    buffer_store_dword v226, v227, s[52:55], s1 offen
L_post41:
    buffer_load_dword v23, v227, s[52:55], s66 offen sc1
    v_mfma_f32_16x16x32_bf16 v[112:115], a[244:247], v[48:51], v[112:115]
    ds_read_b128 a[168:171], v206 offset:0
    v_mfma_f32_16x16x32_bf16 v[32:35], v[80:83], v[64:67], v[32:35]
    ds_read_b64_tr_b16 v[100:101], v205 offset:3600
    ds_read_b64_tr_b16 v[102:103], v205 offset:3584
    v_mfma_f32_16x16x32_bf16 v[36:39], v[56:59], v[64:67], v[36:39]
    v_mfma_f32_16x16x32_bf16 v[112:115], a[252:255], v[64:67], v[112:115]
    ds_read_b64_tr_b16 a[176:177], v205 offset:3728
    ds_read_b64_tr_b16 a[178:179], v205 offset:3712
    s_waitcnt lgkmcnt(9)
    v_mfma_f32_16x16x32_bf16 v[32:35], v[88:91], v[44:47], v[32:35]
    v_mfma_f32_16x16x32_bf16 v[36:39], v[72:75], v[44:47], v[36:39]
    ds_read_b64_tr_b16 v[108:109], v205 offset:3856
    ds_read_b64_tr_b16 v[110:111], v205 offset:3840
    v_mfma_f32_16x16x32_bf16 v[112:115], v[40:43], v[44:47], v[112:115]
    ds_read_b64_tr_b16 a[184:185], v205 offset:3984
    ds_read_b64_tr_b16 a[186:187], v205 offset:3968
    v_mfma_f32_16x16x32_bf16 v[32:35], v[96:99], v[60:63], v[32:35]
    ds_read_b64_tr_b16 a[164:165], v205 offset:33808
    ds_read_b64_tr_b16 a[166:167], v205 offset:33792
    v_mfma_f32_16x16x32_bf16 v[36:39], v[80:83], v[60:63], v[36:39]
    ds_read_b128 a[192:195], v207 offset:30976
    ds_read_b128 a[172:175], v207 offset:32000
    v_mfma_f32_16x16x32_bf16 v[112:115], v[56:59], v[60:63], v[112:115]
    buffer_load_dwordx4 v[136:139], v25, s[8:11], s68 offen
    ds_read_b128 a[200:203], v207 offset:33024
    v_mfma_f32_16x16x32_bf16 v[32:35], v[104:107], v[76:79], v[32:35]
    ds_read_b64_tr_b16 a[180:181], v205 offset:33936
    ds_read_b64_tr_b16 a[182:183], v205 offset:33920
    v_mfma_f32_16x16x32_bf16 v[36:39], v[88:91], v[76:79], v[36:39]
    ds_read_b128 a[208:211], v206 offset:30976
    ds_read_b128 a[188:191], v206 offset:32000
    v_mfma_f32_16x16x32_bf16 v[112:115], v[72:75], v[76:79], v[112:115]
    ds_read_b128 a[216:219], v206 offset:33024
    s_waitcnt lgkmcnt(14)
    v_mfma_f32_16x16x32_bf16 v[32:35], a[160:163], v[84:87], v[32:35]
    ds_read_b64_tr_b16 a[196:197], v205 offset:34064
    ds_read_b64_tr_b16 a[198:199], v205 offset:34048
    v_mfma_f32_16x16x32_bf16 v[36:39], v[96:99], v[84:87], v[36:39]
    ds_read_b128 a[224:227], v207 offset:29952
    v_mfma_f32_16x16x32_bf16 v[112:115], v[80:83], v[84:87], v[112:115]
    v_mfma_f32_16x16x32_bf16 v[32:35], a[168:171], v[92:95], v[32:35]
    ds_read_b64_tr_b16 a[204:205], v205 offset:34192
    ds_read_b64_tr_b16 a[206:207], v205 offset:34176
    v_mfma_f32_16x16x32_bf16 v[36:39], v[104:107], v[92:95], v[36:39]
    ds_read_b128 a[232:235], v206 offset:29952
    v_mfma_f32_16x16x32_bf16 v[112:115], v[88:91], v[92:95], v[112:115]
    v_mfma_f32_16x16x32_bf16 v[36:39], a[160:163], v[100:103], v[36:39]
    ds_read_b64_tr_b16 a[212:213], v205 offset:34320
    ds_read_b64_tr_b16 a[214:215], v205 offset:34304
    v_mfma_f32_16x16x32_bf16 v[112:115], v[96:99], v[100:103], v[112:115]
    ds_read_b128 a[240:243], v207 offset:28928
    v_mfma_f32_16x16x32_bf16 v[36:39], a[168:171], a[176:179], v[36:39]
    v_add_f32_dpp v128, v33, v32 wave_shr:1 row_mask:0xf bank_mask:0xf bound_ctrl:0
    v_add_f32_dpp v129, v33, v34 wave_ror:1 row_mask:0xf bank_mask:0xf
    v_mfma_f32_16x16x32_bf16 v[112:115], v[104:107], a[176:179], v[112:115]
    s_nop 0
    v_add_f32_dpp v129, v35, v34 wave_shr:1 row_mask:0xf bank_mask:0xf
    ds_write2st64_b32 v208, v128, v129 offset0:0 offset1:8
    s_waitcnt lgkmcnt(7)
    v_mfma_f32_16x16x32_bf16 v[112:115], a[160:163], v[108:111], v[112:115]
    ds_read_b64_tr_b16 a[220:221], v205 offset:34448
    ds_read_b64_tr_b16 a[222:223], v205 offset:34432
    v_mfma_f32_16x16x32_bf16 v[112:115], a[168:171], a[184:187], v[112:115]
    ds_read_b128 a[248:251], v206 offset:28928
    v_mfma_f32_16x16x32_bf16 v[116:119], a[192:195], a[164:167], 0
    ds_read_b64_tr_b16 a[228:229], v205 offset:34576
    ds_read_b64_tr_b16 a[230:231], v205 offset:34560
    v_mfma_f32_16x16x32_bf16 v[120:123], a[172:175], a[164:167], 0
    v_add_f32_dpp v130, v35, v36 wave_ror:1 row_mask:0xf bank_mask:0xf
    v_add_f32_dpp v131, v37, v38 wave_ror:1 row_mask:0xf bank_mask:0xf
    v_mfma_f32_16x16x32_bf16 v[124:127], a[200:203], a[164:167], 0
    v_add_f32_dpp v130, v37, v36 wave_shr:1 row_mask:0xf bank_mask:0xf
    v_add_f32_dpp v131, v39, v38 wave_shr:1 row_mask:0xf bank_mask:0xf
    v_mfma_f32_16x16x32_bf16 v[116:119], a[208:211], a[180:183], v[116:119]
    ds_write2st64_b32 v208, v130, v131 offset0:16 offset1:24
    ds_read_b128 v[52:55], v207 offset:27904
    v_mfma_f32_16x16x32_bf16 v[120:123], a[188:191], a[180:183], v[120:123]
    v_add_f32_dpp v128, v39, v112 wave_ror:1 row_mask:0xf bank_mask:0xf
    v_add_f32_dpp v129, v113, v114 wave_ror:1 row_mask:0xf bank_mask:0xf
    v_mfma_f32_16x16x32_bf16 v[124:127], a[216:219], a[180:183], v[124:127]
    v_add_f32_dpp v128, v113, v112 wave_shr:1 row_mask:0xf bank_mask:0xf
    v_add_f32_dpp v129, v115, v114 wave_shr:1 row_mask:0xf bank_mask:0xf
    v_mfma_f32_16x16x32_bf16 v[116:119], a[224:227], a[196:199], v[116:119]
    ds_write2st64_b32 v208, v128, v129 offset0:32 offset1:40
    ds_read_b64_tr_b16 a[236:237], v205 offset:34704
    ds_read_b64_tr_b16 a[238:239], v205 offset:34688
    v_mfma_f32_16x16x32_bf16 v[120:123], a[192:195], a[196:199], v[120:123]
    ds_read_b128 v[68:71], v206 offset:27904
    ds_read_b64_tr_b16 a[244:245], v205 offset:34832
    ds_read_b64_tr_b16 a[246:247], v205 offset:34816
    v_mfma_f32_16x16x32_bf16 v[124:127], a[172:175], a[196:199], v[124:127]
    ds_read_b128 v[48:51], v207 offset:26880
    s_waitcnt lgkmcnt(10)
    v_mfma_f32_16x16x32_bf16 v[116:119], a[232:235], a[204:207], v[116:119]
    ds_read_b64_tr_b16 a[252:253], v205 offset:34960
    ds_read_b64_tr_b16 a[254:255], v205 offset:34944
    v_mfma_f32_16x16x32_bf16 v[120:123], a[208:211], a[204:207], v[120:123]
    ds_read_b128 v[64:67], v206 offset:26880
    v_mfma_f32_16x16x32_bf16 v[124:127], a[188:191], a[204:207], v[124:127]
    v_mfma_f32_16x16x32_bf16 v[116:119], a[240:243], a[212:215], v[116:119]
    ds_read_b64_tr_b16 v[40:41], v205 offset:35088
    ds_read_b64_tr_b16 v[42:43], v205 offset:35072
    v_mfma_f32_16x16x32_bf16 v[120:123], a[224:227], a[212:215], v[120:123]
    ds_read_b128 v[44:47], v207 offset:25856
    v_mfma_f32_16x16x32_bf16 v[124:127], a[192:195], a[212:215], v[124:127]
    v_mfma_f32_16x16x32_bf16 v[116:119], a[248:251], a[220:223], v[116:119]
    ds_read_b64_tr_b16 v[56:57], v205 offset:35216
    ds_read_b64_tr_b16 v[58:59], v205 offset:35200
    v_mfma_f32_16x16x32_bf16 v[120:123], a[232:235], a[220:223], v[120:123]
    ds_read_b128 v[60:63], v206 offset:25856
    v_mfma_f32_16x16x32_bf16 v[124:127], a[208:211], a[220:223], v[124:127]
    s_waitcnt lgkmcnt(7)
    v_mfma_f32_16x16x32_bf16 v[116:119], v[52:55], a[228:231], v[116:119]
    ds_read_b64_tr_b16 v[72:73], v205 offset:35344
    ds_read_b64_tr_b16 v[74:75], v205 offset:35328
    v_mfma_f32_16x16x32_bf16 v[120:123], a[240:243], a[228:231], v[120:123]
    ds_read_b128 v[76:79], v207 offset:24832
    v_mfma_f32_16x16x32_bf16 v[124:127], a[224:227], a[228:231], v[124:127]
    v_mfma_f32_16x16x32_bf16 v[116:119], v[68:71], a[236:239], v[116:119]
    ds_read_b64_tr_b16 v[80:81], v205 offset:35472
    ds_read_b64_tr_b16 v[82:83], v205 offset:35456
    v_mfma_f32_16x16x32_bf16 v[120:123], a[248:251], a[236:239], v[120:123]
    ds_read_b128 v[84:87], v206 offset:24832
    v_mfma_f32_16x16x32_bf16 v[124:127], a[232:235], a[236:239], v[124:127]
    v_mfma_f32_16x16x32_bf16 v[116:119], v[48:51], a[244:247], v[116:119]
    ds_read_b64_tr_b16 v[88:89], v205 offset:35600
    ds_read_b64_tr_b16 v[90:91], v205 offset:35584
    v_mfma_f32_16x16x32_bf16 v[120:123], v[52:55], a[244:247], v[120:123]
    ds_read_b128 v[92:95], v207 offset:23808
    v_mfma_f32_16x16x32_bf16 v[124:127], a[240:243], a[244:247], v[124:127]
    s_waitcnt lgkmcnt(7)
    v_mfma_f32_16x16x32_bf16 v[116:119], v[64:67], a[252:255], v[116:119]
    ds_read_b64_tr_b16 v[96:97], v205 offset:35728
    ds_read_b64_tr_b16 v[98:99], v205 offset:35712
    v_mfma_f32_16x16x32_bf16 v[120:123], v[68:71], a[252:255], v[120:123]
    ds_read_b128 v[100:103], v206 offset:23808
    v_mfma_f32_16x16x32_bf16 v[124:127], a[248:251], a[252:255], v[124:127]
    v_mfma_f32_16x16x32_bf16 v[116:119], v[44:47], v[40:43], v[116:119]
    ds_read_b64_tr_b16 v[104:105], v205 offset:35856
    ds_read_b64_tr_b16 v[106:107], v205 offset:35840
    v_mfma_f32_16x16x32_bf16 v[120:123], v[48:51], v[40:43], v[120:123]
    ds_read_b128 a[176:179], v207 offset:22784
    v_mfma_f32_16x16x32_bf16 v[124:127], v[52:55], v[40:43], v[124:127]
    v_mfma_f32_16x16x32_bf16 v[116:119], v[60:63], v[56:59], v[116:119]
    ds_read_b64_tr_b16 a[160:161], v205 offset:35984
    ds_read_b64_tr_b16 a[162:163], v205 offset:35968
    v_mfma_f32_16x16x32_bf16 v[120:123], v[64:67], v[56:59], v[120:123]
    ds_read_b128 v[108:111], v206 offset:22784
    v_mfma_f32_16x16x32_bf16 v[124:127], v[68:71], v[56:59], v[124:127]
    s_waitcnt lgkmcnt(7)
    v_mfma_f32_16x16x32_bf16 v[116:119], v[76:79], v[72:75], v[116:119]
    ds_read_b64_tr_b16 a[168:169], v205 offset:36112
    ds_read_b64_tr_b16 a[170:171], v205 offset:36096
    v_mfma_f32_16x16x32_bf16 v[120:123], v[44:47], v[72:75], v[120:123]
    ds_read_b128 a[184:187], v207 offset:21760
    v_mfma_f32_16x16x32_bf16 v[124:127], v[48:51], v[72:75], v[124:127]
    v_mfma_f32_16x16x32_bf16 v[116:119], v[84:87], v[80:83], v[116:119]
    ds_read_b64_tr_b16 a[200:201], v205 offset:36240
    ds_read_b64_tr_b16 a[202:203], v205 offset:36224
    v_mfma_f32_16x16x32_bf16 v[120:123], v[60:63], v[80:83], v[120:123]
    ds_read_b128 a[164:167], v206 offset:21760
    v_mfma_f32_16x16x32_bf16 v[124:127], v[64:67], v[80:83], v[124:127]
    v_mfma_f32_16x16x32_bf16 v[116:119], v[92:95], v[88:91], v[116:119]
    ds_read_b64_tr_b16 a[216:217], v205 offset:36368
    ds_read_b64_tr_b16 a[218:219], v205 offset:36352
    v_mfma_f32_16x16x32_bf16 v[120:123], v[76:79], v[88:91], v[120:123]
    ds_read_b128 a[180:183], v207 offset:20736
    v_mfma_f32_16x16x32_bf16 v[124:127], v[44:47], v[88:91], v[124:127]
    s_waitcnt lgkmcnt(7)
    v_mfma_f32_16x16x32_bf16 v[116:119], v[100:103], v[96:99], v[116:119]
    ds_read_b64_tr_b16 a[172:173], v205 offset:36496
    ds_read_b64_tr_b16 a[174:175], v205 offset:36480
    v_mfma_f32_16x16x32_bf16 v[120:123], v[84:87], v[96:99], v[120:123]
    ds_read_b128 a[196:199], v206 offset:20736
    v_mfma_f32_16x16x32_bf16 v[124:127], v[60:63], v[96:99], v[124:127]
    v_mfma_f32_16x16x32_bf16 v[116:119], a[176:179], v[104:107], v[116:119]
    ds_read_b64_tr_b16 a[188:189], v205 offset:36624
    ds_read_b64_tr_b16 a[190:191], v205 offset:36608
    v_mfma_f32_16x16x32_bf16 v[120:123], v[92:95], v[104:107], v[120:123]
    ds_read_b128 a[204:207], v207 offset:19712
    v_mfma_f32_16x16x32_bf16 v[124:127], v[76:79], v[104:107], v[124:127]
    v_mfma_f32_16x16x32_bf16 v[116:119], v[108:111], a[160:163], v[116:119]
    ds_read_b64_tr_b16 a[192:193], v205 offset:36752
    ds_read_b64_tr_b16 a[194:195], v205 offset:36736
    v_mfma_f32_16x16x32_bf16 v[120:123], v[100:103], a[160:163], v[120:123]
    ds_read_b128 a[212:215], v206 offset:19712
    v_mfma_f32_16x16x32_bf16 v[124:127], v[84:87], a[160:163], v[124:127]
    s_waitcnt lgkmcnt(7)
    v_mfma_f32_16x16x32_bf16 v[116:119], a[184:187], a[168:171], v[116:119]
    ds_read_b64_tr_b16 a[208:209], v205 offset:36880
    ds_read_b64_tr_b16 a[210:211], v205 offset:36864
    v_mfma_f32_16x16x32_bf16 v[120:123], a[176:179], a[168:171], v[120:123]
    ds_read_b128 a[220:223], v207 offset:18688
    v_mfma_f32_16x16x32_bf16 v[124:127], v[92:95], a[168:171], v[124:127]
    v_mfma_f32_16x16x32_bf16 v[116:119], a[164:167], a[200:203], v[116:119]
    ds_read_b64_tr_b16 a[224:225], v205 offset:37008
    ds_read_b64_tr_b16 a[226:227], v205 offset:36992
    v_mfma_f32_16x16x32_bf16 v[120:123], v[108:111], a[200:203], v[120:123]
    ds_read_b128 a[228:231], v206 offset:18688
    v_mfma_f32_16x16x32_bf16 v[124:127], v[100:103], a[200:203], v[124:127]
    v_mfma_f32_16x16x32_bf16 v[116:119], a[180:183], a[216:219], v[116:119]
    ds_read_b64_tr_b16 a[232:233], v205 offset:37136
    ds_read_b64_tr_b16 a[234:235], v205 offset:37120
    v_mfma_f32_16x16x32_bf16 v[120:123], a[184:187], a[216:219], v[120:123]
    ds_read_b128 a[236:239], v207 offset:17664
    v_mfma_f32_16x16x32_bf16 v[124:127], a[176:179], a[216:219], v[124:127]
    s_waitcnt lgkmcnt(7)
    v_mfma_f32_16x16x32_bf16 v[116:119], a[196:199], a[172:175], v[116:119]
    ds_read_b64_tr_b16 a[240:241], v205 offset:37264
    ds_read_b64_tr_b16 a[242:243], v205 offset:37248
    v_mfma_f32_16x16x32_bf16 v[120:123], a[164:167], a[172:175], v[120:123]
    ds_read_b128 a[244:247], v206 offset:17664
    v_mfma_f32_16x16x32_bf16 v[124:127], v[108:111], a[172:175], v[124:127]
    v_mfma_f32_16x16x32_bf16 v[116:119], a[204:207], a[188:191], v[116:119]
    ds_read_b64_tr_b16 a[248:249], v205 offset:37392
    ds_read_b64_tr_b16 a[250:251], v205 offset:37376
    v_mfma_f32_16x16x32_bf16 v[120:123], a[180:183], a[188:191], v[120:123]
    v_mfma_f32_16x16x32_bf16 v[124:127], a[184:187], a[188:191], v[124:127]
    ds_read_b64_tr_b16 a[252:253], v205 offset:37520
    ds_read_b64_tr_b16 a[254:255], v205 offset:37504
    v_mfma_f32_16x16x32_bf16 v[116:119], a[212:215], a[192:195], v[116:119]
    v_mfma_f32_16x16x32_bf16 v[120:123], a[196:199], a[192:195], v[120:123]
    ds_read_b64_tr_b16 v[52:53], v205 offset:37648
    ds_read_b64_tr_b16 v[54:55], v205 offset:37632
    v_mfma_f32_16x16x32_bf16 v[124:127], a[164:167], a[192:195], v[124:127]
    ds_read_b64_tr_b16 v[40:41], v205 offset:37776
    ds_read_b64_tr_b16 v[42:43], v205 offset:37760
    s_waitcnt lgkmcnt(9)
    v_mfma_f32_16x16x32_bf16 v[116:119], a[220:223], a[208:211], v[116:119]
    v_mfma_f32_16x16x32_bf16 v[120:123], a[204:207], a[208:211], v[120:123]
    v_mfma_f32_16x16x32_bf16 v[124:127], a[180:183], a[208:211], v[124:127]
    v_mfma_f32_16x16x32_bf16 v[116:119], a[228:231], a[224:227], v[116:119]
    v_mfma_f32_16x16x32_bf16 v[120:123], a[212:215], a[224:227], v[120:123]
    buffer_load_dword v3, v214, s[52:55], s67 offen sc1
    v_mfma_f32_16x16x32_bf16 v[124:127], a[196:199], a[224:227], v[124:127]
    v_mfma_f32_16x16x32_bf16 v[116:119], a[236:239], a[232:235], v[116:119]
    v_mfma_f32_16x16x32_bf16 v[120:123], a[220:223], a[232:235], v[120:123]
    v_mfma_f32_16x16x32_bf16 v[124:127], a[204:207], a[232:235], v[124:127]
    s_waitcnt lgkmcnt(0)
    v_mfma_f32_16x16x32_bf16 v[116:119], a[244:247], a[240:243], v[116:119]
    v_mfma_f32_16x16x32_bf16 v[120:123], a[228:231], a[240:243], v[120:123]
    s_waitcnt vmcnt(5)
    v_xor_b32 v30, s6, v154
    s_waitcnt vmcnt(4)
    v_bitop3_b32 v30, v30, v158, s6 bitop3:0xf6
    v_cmp_ne_u32 vcc, 0, v30
    s_nop 0
    s_cmp_eq_u64 vcc, 0
    s_cbranch_scc0 L_stf44
L_sto43:
    v_mfma_f32_16x16x32_bf16 v[124:127], a[212:215], a[240:243], v[124:127]
    v_mfma_f32_16x16x32_bf16 v[120:123], a[236:239], a[248:251], v[120:123]
    v_mfma_f32_16x16x32_bf16 v[124:127], a[220:223], a[248:251], v[124:127]
    v_mfma_f32_16x16x32_bf16 v[120:123], a[244:247], a[252:255], v[120:123]
    v_add_f32_dpp v130, v117, v116 wave_shr:1 row_mask:0xf bank_mask:0xf bound_ctrl:0
    v_add_f32_dpp v131, v117, v118 wave_ror:1 row_mask:0xf bank_mask:0xf
    v_mfma_f32_16x16x32_bf16 v[124:127], a[228:231], a[252:255], v[124:127]
    s_nop 0
    v_add_f32_dpp v131, v119, v118 wave_shr:1 row_mask:0xf bank_mask:0xf
    ds_write2st64_b32 v208, v130, v131 offset0:4 offset1:12
    v_mfma_f32_16x16x32_bf16 v[124:127], a[236:239], v[52:55], v[124:127]
    v_mfma_f32_16x16x32_bf16 v[124:127], a[244:247], v[40:43], v[124:127]
    s_waitcnt vmcnt(3)
    v_lshlrev_b32 v48, 16, v132
    v_and_b32 v49, s69, v132
    v_lshlrev_b32 v50, 16, v133
    v_and_b32 v51, s69, v133
    v_lshlrev_b32 v52, 16, v134
    v_and_b32 v53, s69, v134
    v_lshlrev_b32 v54, 16, v135
    v_and_b32 v55, s69, v135
    v_add_f32_dpp v128, v119, v120 wave_ror:1 row_mask:0xf bank_mask:0xf
    v_add_f32_dpp v129, v121, v122 wave_ror:1 row_mask:0xf bank_mask:0xf
    s_nop 0
    v_add_f32_dpp v128, v121, v120 wave_shr:1 row_mask:0xf bank_mask:0xf
    v_add_f32_dpp v129, v123, v122 wave_shr:1 row_mask:0xf bank_mask:0xf
    ds_write2st64_b32 v208, v128, v129 offset0:20 offset1:28
    v_add_f32_dpp v130, v123, v124 wave_ror:1 row_mask:0xf bank_mask:0xf
    v_add_f32_dpp v131, v125, v126 wave_ror:1 row_mask:0xf bank_mask:0xf
    s_nop 0
    v_add_f32_dpp v130, v125, v124 wave_shr:1 row_mask:0xf bank_mask:0xf
    v_add_f32_dpp v131, v127, v126 wave_shr:1 row_mask:0xf bank_mask:0xf
    ds_write2st64_b32 v208, v130, v131 offset0:36 offset1:44
    v_pk_fma_f32 v[56:57], v[48:49], v[152:153], v[152:153] op_sel:[0,0,1] op_sel_hi:[1,0,1]
    v_pk_fma_f32 v[58:59], v[50:51], v[152:153], v[152:153] op_sel:[0,0,1] op_sel_hi:[1,0,1]
    v_pk_fma_f32 v[60:61], v[52:53], v[152:153], v[152:153] op_sel:[0,0,1] op_sel_hi:[1,0,1]
    v_pk_fma_f32 v[62:63], v[54:55], v[152:153], v[152:153] op_sel:[0,0,1] op_sel_hi:[1,0,1]
    s_waitcnt vmcnt(1)
    v_lshlrev_b32 v72, 16, v136
    v_and_b32 v73, s69, v136
    v_lshlrev_b32 v74, 16, v137
    v_and_b32 v75, s69, v137
    v_lshlrev_b32 v76, 16, v138
    v_and_b32 v77, s69, v138
    v_lshlrev_b32 v78, 16, v139
    v_and_b32 v79, s69, v139
    v_pk_fma_f32 v[80:81], v[72:73], v[156:157], v[156:157] op_sel:[0,0,1] op_sel_hi:[1,0,1]
    v_pk_fma_f32 v[82:83], v[74:75], v[156:157], v[156:157] op_sel:[0,0,1] op_sel_hi:[1,0,1]
    v_pk_fma_f32 v[84:85], v[76:77], v[156:157], v[156:157] op_sel:[0,0,1] op_sel_hi:[1,0,1]
    v_pk_fma_f32 v[86:87], v[78:79], v[156:157], v[156:157] op_sel:[0,0,1] op_sel_hi:[1,0,1]
    s_waitcnt lgkmcnt(0)
    s_barrier
    ds_read2st64_b32 v[40:41], v209 offset0:0 offset1:1
    ds_read2st64_b32 v[42:43], v209 offset0:2 offset1:3
    ds_read2st64_b32 v[44:45], v209 offset0:4 offset1:5
    ds_read2st64_b32 v[46:47], v209 offset0:6 offset1:7
    ds_read2st64_b32 v[64:65], v209 offset0:32 offset1:33
    ds_read2st64_b32 v[66:67], v209 offset0:34 offset1:35
    ds_read2st64_b32 v[68:69], v209 offset0:36 offset1:37
    ds_read2st64_b32 v[70:71], v209 offset0:38 offset1:39
    s_waitcnt lgkmcnt(7)
    v_pk_fma_f32 v[48:49], v[56:57], v[40:41], v[48:49]
    s_waitcnt lgkmcnt(6)
    v_pk_fma_f32 v[50:51], v[58:59], v[42:43], v[50:51]
    s_waitcnt lgkmcnt(5)
    v_pk_fma_f32 v[52:53], v[60:61], v[44:45], v[52:53]
    s_waitcnt lgkmcnt(4)
    v_pk_fma_f32 v[54:55], v[62:63], v[46:47], v[54:55]
    v_cvt_pk_bf16_f32 v196, v48, v49
    v_cvt_pk_bf16_f32 v197, v50, v51
    v_cvt_pk_bf16_f32 v198, v52, v53
    v_cvt_pk_bf16_f32 v199, v54, v55
    buffer_store_dwordx4 v[196:199], v215, s[52:55], s83 offen sc1
    s_waitcnt lgkmcnt(3)
    v_pk_fma_f32 v[72:73], v[80:81], v[64:65], v[72:73]
    s_waitcnt lgkmcnt(2)
    v_pk_fma_f32 v[74:75], v[82:83], v[66:67], v[74:75]
    s_waitcnt lgkmcnt(1)
    v_pk_fma_f32 v[76:77], v[84:85], v[68:69], v[76:77]
    s_waitcnt lgkmcnt(0)
    v_pk_fma_f32 v[78:79], v[86:87], v[70:71], v[78:79]
    v_cvt_pk_bf16_f32 v200, v72, v73
    v_cvt_pk_bf16_f32 v201, v74, v75
    v_cvt_pk_bf16_f32 v202, v76, v77
    v_cvt_pk_bf16_f32 v203, v78, v79
    buffer_store_dwordx4 v[200:203], v216, s[52:55], s83 offen sc1
    s_waitcnt vmcnt(2)
    v_cmp_eq_u32 s[90:91], s6, v3
    s_nop 0
    s_cmp_eq_u64 s[90:91], -1
    s_cbranch_scc0 L_pollf48
L_polld46:
    s_add_u32 m0, s77, 0
    s_add_u32 s74, s75, 0
    buffer_load_dwordx4 v1, s[52:55], s74 offen sc1 lds
    buffer_load_dwordx4 v1, s[52:55], s74 offen offset:1024 sc1 lds
    buffer_load_dwordx4 v1, s[52:55], s74 offen offset:2048 sc1 lds
    buffer_load_dwordx4 v1, s[52:55], s74 offen offset:3072 sc1 lds
    s_mul_i32 s61, s60, 20
    v_add_u32 v14, 65536, v1
    v_add_u32 v15, 81920, v1
    s_and_b32 s80, s3, 1
    s_and_b32 s68, s4, 7
    v_lshrrev_b32 v8, 4, v0
    v_and_b32 v9, 15, v0
    v_lshlrev_b32 v9, 4, v9
    v_lshl_add_u32 v9, v8, 15, v9
    s_lshl_b32 s73, s80, 8
    v_add_u32 v21, s73, v9
    v_xor_b32 v16, 256, v21
    s_lshr_b32 s64, s4, 3
    s_and_b32 s65, s3, 6
    s_lshl_b32 s65, s65, 1
    s_add_u32 s67, s64, s65
    s_lshl_b32 s64, s67, 2
    s_add_u32 s65, s64, s5
    s_lshl_b32 s64, s65, 9
    s_add_u32 s64, s64, 0x390000
    s_mul_i32 s79, s68, 327680
    s_add_u32 s79, s79, s64
    s_lshl_b32 s73, s5, 10
    s_add_u32 s73, s73, 155648
    v_lshl_add_u32 v20, v8, 4, s73
    s_lshl_b32 s81, s65, 1
    s_add_u32 s81, s81, s80
    s_mul_i32 s81, s81, 57344
    s_add_u32 s81, s81, 0x610000
    s_mul_i32 s76, s68, 7168
    s_add_u32 s76, s76, s81
    s_add_u32 s69, s76, 3072
    s_mov_b32 s1, s57
    s_lshl_b32 s0, s68, 2
    s_add_u32 s0, s0, s57
    s_add_u32 s59, s0, 64
    v_lshrrev_b32 v5, 6, v225
    v_bfe_u32 v9, v0, 2, 2
    v_and_b32 v13, 15, v0
    v_lshl_add_u32 v12, v9, 4, v13
    v_lshlrev_b32_e64 v12, 2, v12
    v_lshl_add_u32 v13, v13, 2, 64
    v_add_u32 v13, 128, v13
    v_mov_b32 v11, 0x3f800054
    s_mov_b32 s86, 0x3acccccd
    s_mov_b32 s88, 0xaaaaaaaa
    s_mov_b32 s89, 0xaaaaaaaa
    s_mov_b32 s82, 0xcccccccc
    s_mov_b32 s83, 0xcccccccc
    s_mov_b32 s84, 0
    s_mov_b32 s85, 0xffff0000
    v_mov_b32 v22, 0xc0135761
    v_mov_b32 v23, 0xbdd2d3e8
    s_waitcnt vmcnt(4)
    s_barrier
    s_cmp_lg_u32 s5, 0
    s_cbranch_scc1 L_post49
    buffer_store_dword v226, v227, s[52:55], s99 offen
L_post49:
    v_min_u32 v17, 55, v0
    v_lshlrev_b32 v18, 3, v17
    v_lshlrev_b32 v17, 2, v17
    s_mul_i32 s72, s5, 5
    s_add_u32 s72, s72, s61
    s_mul_i32 s72, s72, 448
    s_add_u32 s72, s72, 0x1170000
    s_mul_i32 s70, s60, 216
    buffer_load_dwordx2 v[176:177], v18, s[52:55], s72 offen offset:0 sc1
    buffer_load_dwordx2 v[178:179], v18, s[52:55], s72 offen offset:448 sc1
    buffer_load_dwordx2 v[180:181], v18, s[52:55], s72 offen offset:896 sc1
    buffer_load_dwordx2 v[182:183], v18, s[52:55], s72 offen offset:1344 sc1
    buffer_load_dwordx2 v[184:185], v18, s[52:55], s72 offen offset:1792 sc1
    buffer_load_dword v187, v17, s[36:39], s70 offen
    v_lshrrev_b32 v10, 4, v0
    v_lshlrev_b32 v4, 4, v10
    s_mul_i32 s72, s68, 160
    v_lshlrev_b32_e64 v8, 3, v10
    buffer_load_dwordx4 v[122:125], v4, s[44:47], s72 offen
    buffer_load_dwordx4 v[126:129], v4, s[44:47], s72 offen offset:64
    buffer_load_dwordx2 v[130:131], v8, s[44:47], s72 offen offset:128
    v_and_b32 v6, 0x1f0, v21
    v_lshrrev_b32 v4, 5, v0
    v_lshl_add_u32 v6, v4, 15, v6
    v_and_b32 v4, 1, v10
    v_lshl_add_u32 v6, v4, 3, v6
    s_add_u32 s70, s79, 131072
    s_add_u32 s71, s79, 262144
    s_add_u32 m0, s77, 16384
    s_add_u32 s74, s75, 16384
    buffer_load_dwordx4 v1, s[52:55], s74 offen sc1 lds
    buffer_load_dwordx4 v1, s[52:55], s74 offen offset:1024 sc1 lds
    buffer_load_dwordx4 v1, s[52:55], s74 offen offset:2048 sc1 lds
    buffer_load_dwordx4 v1, s[52:55], s74 offen offset:3072 sc1 lds
    s_add_u32 m0, s77, 32768
    s_add_u32 s74, s75, 32768
    buffer_load_dwordx4 v1, s[52:55], s74 offen sc1 lds
    buffer_load_dwordx4 v1, s[52:55], s74 offen offset:1024 sc1 lds
    buffer_load_dwordx4 v1, s[52:55], s74 offen offset:2048 sc1 lds
    buffer_load_dwordx4 v1, s[52:55], s74 offen offset:3072 sc1 lds
    s_add_u32 m0, s77, 49152
    s_add_u32 s74, s75, 49152
    buffer_load_dwordx4 v1, s[52:55], s74 offen sc1 lds
    buffer_load_dwordx4 v1, s[52:55], s74 offen offset:1024 sc1 lds
    buffer_load_dwordx4 v1, s[52:55], s74 offen offset:2048 sc1 lds
    buffer_load_dwordx4 v1, s[52:55], s74 offen offset:3072 sc1 lds
    s_add_u32 m0, s77, 65536
    s_add_u32 s74, s75, 65536
    buffer_load_dwordx4 v1, s[52:55], s74 offen sc1 lds
    buffer_load_dwordx4 v1, s[52:55], s74 offen offset:1024 sc1 lds
    buffer_load_dwordx4 v1, s[52:55], s74 offen offset:2048 sc1 lds
    buffer_load_dwordx4 v1, s[52:55], s74 offen offset:3072 sc1 lds
    s_branch L_convdone
L_idle:
    v_lshlrev_b32 v7, 11, v0
    v_cmp_gt_u32 vcc, 8, v0
    s_nop 1
    v_cndmask_b32 v7, v231, v7, vcc
    s_cmp_lg_u32 s5, 0
    s_cbranch_scc1 L_post50
    buffer_store_dword v226, v227, s[52:55], s1 offen
L_post50:
    s_cmp_lg_u32 s4, 31
    s_cbranch_scc1 L_rl51
    s_cmp_lg_u32 s5, 0
    s_cbranch_scc1 L_rl51
    s_lshl_b32 s94, s3, 12
    s_add_u32 s94, s94, 0x20000
    s_sub_u32 s95, s99, 8
    s_mov_b64 s[90:91], 0
    s_mov_b32 s92, 0
    s_waitcnt vmcnt(0)
    buffer_load_dword v31, v2, s[52:55], s94 offen sc1
    buffer_load_dword v30, v2, s[52:55], s94 offen sc1
L_poll52:
    buffer_load_dword v3, v2, s[52:55], s94 offen sc1
    s_add_u32 s92, s92, 1
    s_waitcnt vmcnt(2)
    v_cmp_eq_u32 vcc, s6, v31
    s_nop 0
    s_or_b64 s[90:91], s[90:91], vcc
    s_cmp_eq_u64 s[90:91], -1
    s_cbranch_scc1 L_polld53
    buffer_load_dword v31, v2, s[52:55], s94 offen sc1
    s_waitcnt vmcnt(2)
    v_cmp_eq_u32 vcc, s6, v30
    s_nop 0
    s_or_b64 s[90:91], s[90:91], vcc
    s_cmp_eq_u64 s[90:91], -1
    s_cbranch_scc1 L_polld53
    s_cmp_lg_u32 s92, 64
    s_cbranch_scc1 L_polln54
    s_xor_b32 s93, s95, 0x8000
    buffer_store_dword v226, v227, s[52:55], s93 offen sc1
L_polln54:
    s_cmp_gt_u32 s92, 256
    s_cselect_b32 s93, 0x8000, 0
    s_xor_b32 s94, s94, s93
    buffer_load_dword v30, v2, s[52:55], s94 offen sc1
    s_waitcnt vmcnt(2)
    v_cmp_eq_u32 vcc, s6, v3
    s_nop 0
    s_or_b64 s[90:91], s[90:91], vcc
    s_cmp_eq_u64 s[90:91], -1
    s_cbranch_scc1 L_polld53
    s_cmp_lt_u32 s92, 0x200000
    s_cbranch_scc1 L_poll52
L_polld53:
    s_lshl_b32 s94, s3, 8
    s_add_u32 s94, s94, 0x14000
    buffer_store_dword v226, v7, s[52:55], s94 offen sc1
L_rl51:
    s_barrier
    buffer_load_dword v4, v2, s[36:39], 0 offen
    buffer_load_dword v5, v2, s[44:47], 0 offen
    s_add_u32 m0, s77, 0
    s_nop 0
    buffer_load_dwordx4 v240, s[40:43], s85 offen lds
    s_add_u32 m0, s77, 4096
    s_nop 0
    buffer_load_dwordx4 v241, s[40:43], s85 offen lds
    s_add_u32 m0, s77, 8192
    s_nop 0
    buffer_load_dwordx4 v242, s[40:43], s87 offen lds
    s_add_u32 m0, s77, 12288
    s_nop 0
    buffer_load_dwordx4 v243, s[40:43], s86 offen lds
    s_add_u32 m0, s77, 16384
    s_nop 0
    buffer_load_dwordx4 v244, s[40:43], s86 offen lds
    s_mov_b32 s60, s81
    s_add_u32 s78, s78, 4
    s_sub_u32 s77, s77, 40960
    s_mul_i32 s84, s3, 56
    s_add_u32 s84, s84, s78
    s_and_b32 s80, s84, 7
    s_lshr_b32 s84, s84, 3
    s_cmp_ge_u32 s84, 28
    s_cselect_b32 s85, 1, 0
    s_mul_i32 s86, s85, 28
    s_sub_u32 s86, s84, s86
    s_lshl_b32 s81, s85, 3
    s_add_u32 s81, s81, s80
    s_mul_i32 s81, s81, 28
    s_add_u32 s81, s81, s86
    s_lshr_b32 s87, s86, 1
    s_sub_u32 s88, s86, 16
    s_cmp_lt_u32 s86, 16
    s_cselect_b32 s87, s87, s88
    s_cselect_b32 s89, 2, 1
    s_sub_u32 s90, 0, s87
    s_cmp_lt_u32 s87, s80
    s_cselect_b32 s88, 1, 0
    s_cmp_eq_u32 s87, s80
    s_cselect_b32 s88, s90, s88
    s_mul_i32 s88, s88, s89
    s_add_u32 s81, s81, s88
    s_mul_i32 s81, s81, 5120
    s_add_u32 s81, s81, 0xf40000
    s_mul_i32 s85, s85, 864
    s_lshr_b32 s87, s86, 1
    s_mul_i32 s87, s87, 44
    s_lshl_b32 s88, s86, 5
    s_add_u32 s87, s87, s88
    s_add_u32 s87, s87, 48
    s_mul_i32 s88, s86, 108
    s_sub_u32 s89, s88, 1728
    s_cmp_lt_u32 s86, 16
    s_cselect_b32 s87, s87, s89
    s_lshl_b32 s88, s88, 1
    s_sub_u32 s88, s88, 5152
    s_cmp_lt_u32 s86, 24
    s_cselect_b32 s88, s87, s88
    s_cselect_b32 s87, 0, 117760
    s_add_u32 s85, s85, s88
    s_mul_i32 s85, s85, 1280
    s_lshr_b32 s88, s80, 2
    s_mul_i32 s88, s88, 640
    s_add_u32 s85, s85, s88
    s_add_u32 s86, s85, s87
    s_add_u32 s82, s81, 4096
    s_cmp_lt_u32 s5, 2
    s_cselect_b32 s87, s85, s86
    s_add_u32 m0, s77, 0
    s_nop 0
    buffer_load_dwordx4 v240, s[40:43], s85 offen lds
    s_add_u32 m0, s77, 4096
    s_nop 0
    buffer_load_dwordx4 v241, s[40:43], s85 offen lds
    s_add_u32 m0, s77, 8192
    s_nop 0
    buffer_load_dwordx4 v242, s[40:43], s87 offen lds
    s_add_u32 m0, s77, 12288
    s_nop 0
    buffer_load_dwordx4 v243, s[40:43], s86 offen lds
    s_add_u32 m0, s77, 16384
    s_nop 0
    buffer_load_dwordx4 v244, s[40:43], s86 offen lds
    s_mov_b32 s61, s81
    s_mov_b32 s81, s60
    s_add_u32 s82, s81, 4096
    s_waitcnt vmcnt(5)
    s_barrier
    s_nop 0
    ds_read_b64_tr_b16 v[172:173], v245 offset:0
    ds_read_b64_tr_b16 v[174:175], v245 offset:10240
    ds_read_b64_tr_b16 v[176:177], v245 offset:8
    ds_read_b64_tr_b16 v[178:179], v245 offset:10248
    ds_read_b64_tr_b16 v[180:181], v245 offset:64
    ds_read_b64_tr_b16 v[182:183], v245 offset:10304
    ds_read_b64_tr_b16 v[184:185], v245 offset:72
    ds_read_b64_tr_b16 v[186:187], v245 offset:10312
    ds_read_b64_tr_b16 v[188:189], v246 offset:128
    ds_read_b64_tr_b16 v[190:191], v246 offset:10368
    s_waitcnt lgkmcnt(8)
    buffer_store_dwordx4 v[172:175], v1, s[52:55], s81 offen offset:0 sc1
    s_waitcnt lgkmcnt(6)
    buffer_store_dwordx4 v[176:179], v1, s[52:55], s81 offen offset:1024 sc1
    s_waitcnt lgkmcnt(4)
    buffer_store_dwordx4 v[180:183], v1, s[52:55], s81 offen offset:2048 sc1
    s_waitcnt lgkmcnt(2)
    buffer_store_dwordx4 v[184:187], v1, s[52:55], s81 offen offset:3072 sc1
    s_waitcnt lgkmcnt(0)
    buffer_store_dwordx4 v[188:191], v1, s[52:55], s82 offen offset:0 sc1
    v_subrev_u32 v245, 40960, v245
    v_subrev_u32 v246, 40960, v246
    s_mov_b32 s81, s61
    s_add_u32 s82, s81, 4096
    s_waitcnt vmcnt(5)
    s_barrier
    ds_read_b64_tr_b16 v[172:173], v245 offset:0
    ds_read_b64_tr_b16 v[174:175], v245 offset:10240
    ds_read_b64_tr_b16 v[176:177], v245 offset:8
    ds_read_b64_tr_b16 v[178:179], v245 offset:10248
    ds_read_b64_tr_b16 v[180:181], v245 offset:64
    ds_read_b64_tr_b16 v[182:183], v245 offset:10304
    ds_read_b64_tr_b16 v[184:185], v245 offset:72
    ds_read_b64_tr_b16 v[186:187], v245 offset:10312
    ds_read_b64_tr_b16 v[188:189], v246 offset:128
    ds_read_b64_tr_b16 v[190:191], v246 offset:10368
    s_waitcnt lgkmcnt(8)
    buffer_store_dwordx4 v[172:175], v1, s[52:55], s81 offen offset:0 sc1
    s_waitcnt lgkmcnt(6)
    buffer_store_dwordx4 v[176:179], v1, s[52:55], s81 offen offset:1024 sc1
    s_waitcnt lgkmcnt(4)
    buffer_store_dwordx4 v[180:183], v1, s[52:55], s81 offen offset:2048 sc1
    s_waitcnt lgkmcnt(2)
    buffer_store_dwordx4 v[184:187], v1, s[52:55], s81 offen offset:3072 sc1
    s_waitcnt lgkmcnt(0)
    buffer_store_dwordx4 v[188:191], v1, s[52:55], s82 offen offset:0 sc1
    s_add_u32 s59, s58, 0
    buffer_store_dwordx4 v[248:251], v1, s[52:55], s59 offen offset:0 sc1
    buffer_store_dwordx4 v[248:251], v1, s[52:55], s59 offen offset:1024 sc1
    buffer_store_dwordx4 v[248:251], v212, s[52:55], s59 offen offset:2048 sc1
    s_cmp_lg_u32 s5, 0
    s_cbranch_scc1 L_polld56
    s_mov_b64 s[90:91], 0
    s_mov_b32 s92, 0
    s_waitcnt vmcnt(0)
    buffer_load_dword v31, v214, s[52:55], s67 offen sc1
    buffer_load_dword v30, v214, s[52:55], s67 offen sc1
L_poll55:
    buffer_load_dword v3, v214, s[52:55], s67 offen sc1
    s_add_u32 s92, s92, 1
    s_waitcnt vmcnt(2)
    v_cmp_eq_u32 vcc, s6, v31
    s_nop 0
    s_or_b64 s[90:91], s[90:91], vcc
    s_cmp_eq_u64 s[90:91], -1
    s_cbranch_scc1 L_polld56
    buffer_load_dword v31, v214, s[52:55], s67 offen sc1
    s_waitcnt vmcnt(2)
    v_cmp_eq_u32 vcc, s6, v30
    s_nop 0
    s_or_b64 s[90:91], s[90:91], vcc
    s_cmp_eq_u64 s[90:91], -1
    s_cbranch_scc1 L_polld56
    s_cmp_lg_u32 s92, 64
    s_cbranch_scc1 L_polln57
    s_xor_b32 s93, s0, 0x8000
    buffer_store_dword v226, v227, s[52:55], s93 offen sc1
L_polln57:
    buffer_load_dword v30, v214, s[52:55], s67 offen sc1
    s_waitcnt vmcnt(2)
    v_cmp_eq_u32 vcc, s6, v3
    s_nop 0
    s_or_b64 s[90:91], s[90:91], vcc
    s_cmp_eq_u64 s[90:91], -1
    s_cbranch_scc1 L_polld56
    s_cmp_lt_u32 s92, 0x200000
    s_cbranch_scc1 L_poll55
L_polld56:
    s_waitcnt vmcnt(0) lgkmcnt(0)
    s_barrier
    s_cmp_lg_u32 s5, 0
    s_cbranch_scc1 L_post58
    buffer_store_dword v226, v227, s[52:55], s99 offen
L_post58:
    s_add_u32 s67, s67, 0x4000
    s_cmp_lg_u32 s4, 30
    s_cbranch_scc1 L_rl59
    s_cmp_lg_u32 s5, 0
    s_cbranch_scc1 L_rl59
    s_lshl_b32 s94, s3, 12
    s_add_u32 s94, s94, 0x20004
    s_sub_u32 s95, s99, 8
    s_mov_b64 s[90:91], 0
    s_mov_b32 s92, 0
    s_waitcnt vmcnt(0)
    buffer_load_dword v31, v2, s[52:55], s94 offen sc1
    buffer_load_dword v30, v2, s[52:55], s94 offen sc1
L_poll60:
    buffer_load_dword v3, v2, s[52:55], s94 offen sc1
    s_add_u32 s92, s92, 1
    s_waitcnt vmcnt(2)
    v_cmp_eq_u32 vcc, s6, v31
    s_nop 0
    s_or_b64 s[90:91], s[90:91], vcc
    s_cmp_eq_u64 s[90:91], -1
    s_cbranch_scc1 L_polld61
    buffer_load_dword v31, v2, s[52:55], s94 offen sc1
    s_waitcnt vmcnt(2)
    v_cmp_eq_u32 vcc, s6, v30
    s_nop 0
    s_or_b64 s[90:91], s[90:91], vcc
    s_cmp_eq_u64 s[90:91], -1
    s_cbranch_scc1 L_polld61
    s_cmp_lg_u32 s92, 64
    s_cbranch_scc1 L_polln62
    s_xor_b32 s93, s95, 0x8000
    buffer_store_dword v226, v227, s[52:55], s93 offen sc1
L_polln62:
    s_cmp_gt_u32 s92, 256
    s_cselect_b32 s93, 0x8000, 0
    s_xor_b32 s94, s94, s93
    buffer_load_dword v30, v2, s[52:55], s94 offen sc1
    s_waitcnt vmcnt(2)
    v_cmp_eq_u32 vcc, s6, v3
    s_nop 0
    s_or_b64 s[90:91], s[90:91], vcc
    s_cmp_eq_u64 s[90:91], -1
    s_cbranch_scc1 L_polld61
    s_cmp_lt_u32 s92, 0x200000
    s_cbranch_scc1 L_poll60
L_polld61:
    s_lshl_b32 s94, s3, 8
    s_add_u32 s94, s94, 0x18000
    buffer_store_dword v226, v7, s[52:55], s94 offen sc1
L_rl59:
    s_barrier
    s_and_b32 s60, s3, 1
    s_lshl_b32 s60, s60, 3
    s_and_b32 s61, s4, 7
    s_add_u32 s60, s60, s61
    s_mul_i32 s61, s60, 143360
    s_add_u32 s61, s61, 0xd10000
    s_lshl_b32 s63, s5, 10
    s_add_u32 s62, s61, s63
    s_lshl_b32 s77, s5, 12
    s_add_u32 s75, s61, s77
    buffer_load_dword v3, v214, s[52:55], s67 offen sc1
    s_waitcnt vmcnt(0)
    v_cmp_eq_u32 s[90:91], s6, v3
    s_nop 0
    s_cmp_eq_u64 s[90:91], -1
    s_cbranch_scc0 L_pollf66
L_polld64:
    s_add_u32 m0, s77, 0
    s_add_u32 s74, s75, 0
    buffer_load_dwordx4 v1, s[52:55], s74 offen sc1 lds
    buffer_load_dwordx4 v1, s[52:55], s74 offen offset:1024 sc1 lds
    buffer_load_dwordx4 v1, s[52:55], s74 offen offset:2048 sc1 lds
    buffer_load_dwordx4 v1, s[52:55], s74 offen offset:3072 sc1 lds
    s_mul_i32 s61, s60, 20
    v_add_u32 v14, 65536, v1
    v_add_u32 v15, 81920, v1
    s_and_b32 s80, s3, 1
    s_and_b32 s68, s4, 7
    v_lshrrev_b32 v8, 4, v0
    v_and_b32 v9, 15, v0
    v_lshlrev_b32 v9, 4, v9
    v_lshl_add_u32 v9, v8, 15, v9
    s_lshl_b32 s73, s80, 8
    v_add_u32 v21, s73, v9
    v_xor_b32 v16, 256, v21
    s_lshr_b32 s64, s4, 3
    s_and_b32 s65, s3, 6
    s_lshl_b32 s65, s65, 1
    s_add_u32 s67, s64, s65
    s_lshl_b32 s64, s67, 2
    s_add_u32 s65, s64, s5
    s_lshl_b32 s64, s65, 9
    s_add_u32 s64, s64, 0x390000
    s_mul_i32 s79, s68, 327680
    s_add_u32 s79, s79, s64
    s_lshl_b32 s73, s5, 10
    s_add_u32 s73, s73, 155648
    v_lshl_add_u32 v20, v8, 4, s73
    s_lshl_b32 s81, s65, 1
    s_add_u32 s81, s81, s80
    s_mul_i32 s81, s81, 57344
    s_add_u32 s81, s81, 0x610000
    s_mul_i32 s76, s68, 7168
    s_add_u32 s76, s76, s81
    s_add_u32 s69, s76, 3072
    s_mov_b32 s1, s57
    s_lshl_b32 s0, s68, 2
    s_add_u32 s0, s0, s57
    s_add_u32 s59, s0, 64
    v_lshrrev_b32 v5, 6, v225
    v_bfe_u32 v9, v0, 2, 2
    v_and_b32 v13, 15, v0
    v_lshl_add_u32 v12, v9, 4, v13
    v_lshlrev_b32 v12, 2, v12
    v_lshl_add_u32 v13, v13, 2, 64
    v_add_u32 v13, 128, v13
    v_mov_b32 v11, 0x3f800054
    s_mov_b32 s86, 0x3acccccd
    s_mov_b32 s88, 0xaaaaaaaa
    s_mov_b32 s89, 0xaaaaaaaa
    s_mov_b32 s82, 0xcccccccc
    s_mov_b32 s83, 0xcccccccc
    s_mov_b32 s84, 0
    s_mov_b32 s85, 0xffff0000
    v_mov_b32 v22, 0xc0135761
    v_mov_b32 v23, 0xbdd2d3e8
    v_min_u32 v17, 55, v0
    v_lshlrev_b32 v18, 3, v17
    v_lshlrev_b32 v17, 2, v17
    s_mul_i32 s72, s5, 5
    s_add_u32 s72, s72, s61
    s_mul_i32 s72, s72, 448
    s_add_u32 s72, s72, 0x1170000
    s_mul_i32 s70, s60, 216
    buffer_load_dwordx2 v[176:177], v18, s[52:55], s72 offen offset:0 sc1
    buffer_load_dwordx2 v[178:179], v18, s[52:55], s72 offen offset:448 sc1
    buffer_load_dwordx2 v[180:181], v18, s[52:55], s72 offen offset:896 sc1
    buffer_load_dwordx2 v[182:183], v18, s[52:55], s72 offen offset:1344 sc1
    buffer_load_dwordx2 v[184:185], v18, s[52:55], s72 offen offset:1792 sc1
    buffer_load_dword v187, v17, s[36:39], s70 offen
    v_lshrrev_b32 v10, 4, v0
    v_lshlrev_b32 v4, 4, v10
    s_mul_i32 s72, s68, 160
    v_lshlrev_b32_e64 v8, 3, v10
    buffer_load_dwordx4 v[122:125], v4, s[44:47], s72 offen
    buffer_load_dwordx4 v[126:129], v4, s[44:47], s72 offen offset:64
    buffer_load_dwordx2 v[130:131], v8, s[44:47], s72 offen offset:128
    v_and_b32 v6, 0x1f0, v21
    v_lshrrev_b32 v4, 5, v0
    v_lshl_add_u32 v6, v4, 15, v6
    v_and_b32 v4, 1, v10
    v_lshl_add_u32 v6, v4, 3, v6
    s_add_u32 s70, s79, 131072
    s_add_u32 s71, s79, 262144
    s_add_u32 m0, s77, 16384
    s_add_u32 s74, s75, 16384
    buffer_load_dwordx4 v1, s[52:55], s74 offen sc1 lds
    buffer_load_dwordx4 v1, s[52:55], s74 offen offset:1024 sc1 lds
    buffer_load_dwordx4 v1, s[52:55], s74 offen offset:2048 sc1 lds
    buffer_load_dwordx4 v1, s[52:55], s74 offen offset:3072 sc1 lds
    s_add_u32 m0, s77, 32768
    s_add_u32 s74, s75, 32768
    buffer_load_dwordx4 v1, s[52:55], s74 offen sc1 lds
    buffer_load_dwordx4 v1, s[52:55], s74 offen offset:1024 sc1 lds
    s_cmp_lg_u32 s4, 31
    s_cbranch_scc1 L_rl67
    s_cmp_lg_u32 s5, 0
    s_cbranch_scc1 L_rl67
    s_lshl_b32 s94, s3, 12
    s_add_u32 s94, s94, 0x20008
    s_sub_u32 s95, s99, 8
    s_mov_b64 s[90:91], 0
    s_mov_b32 s92, 0
    s_waitcnt vmcnt(0)
    buffer_load_dword v31, v2, s[52:55], s94 offen sc1
    buffer_load_dword v30, v2, s[52:55], s94 offen sc1
L_poll68:
    buffer_load_dword v3, v2, s[52:55], s94 offen sc1
    s_add_u32 s92, s92, 1
    s_waitcnt vmcnt(2)
    v_cmp_eq_u32 vcc, s6, v31
    s_nop 0
    s_or_b64 s[90:91], s[90:91], vcc
    s_cmp_eq_u64 s[90:91], -1
    s_cbranch_scc1 L_polld69
    buffer_load_dword v31, v2, s[52:55], s94 offen sc1
    s_waitcnt vmcnt(2)
    v_cmp_eq_u32 vcc, s6, v30
    s_nop 0
    s_or_b64 s[90:91], s[90:91], vcc
    s_cmp_eq_u64 s[90:91], -1
    s_cbranch_scc1 L_polld69
    s_cmp_lg_u32 s92, 64
    s_cbranch_scc1 L_polln70
    s_xor_b32 s93, s95, 0x8000
    buffer_store_dword v226, v227, s[52:55], s93 offen sc1
L_polln70:
    s_cmp_gt_u32 s92, 256
    s_cselect_b32 s93, 0x8000, 0
    s_xor_b32 s94, s94, s93
    buffer_load_dword v30, v2, s[52:55], s94 offen sc1
    s_waitcnt vmcnt(2)
    v_cmp_eq_u32 vcc, s6, v3
    s_nop 0
    s_or_b64 s[90:91], s[90:91], vcc
    s_cmp_eq_u64 s[90:91], -1
    s_cbranch_scc1 L_polld69
    s_cmp_lt_u32 s92, 0x200000
    s_cbranch_scc1 L_poll68
L_polld69:
    s_lshl_b32 s94, s3, 8
    s_add_u32 s94, s94, 0x10000
    buffer_store_dword v226, v7, s[52:55], s94 offen sc1
L_rl67:
    s_barrier
    buffer_load_dwordx4 v1, s[52:55], s74 offen offset:2048 sc1 lds
    buffer_load_dwordx4 v1, s[52:55], s74 offen offset:3072 sc1 lds
    s_add_u32 m0, s77, 49152
    s_add_u32 s74, s75, 49152
    buffer_load_dwordx4 v1, s[52:55], s74 offen sc1 lds
    buffer_load_dwordx4 v1, s[52:55], s74 offen offset:1024 sc1 lds
    buffer_load_dwordx4 v1, s[52:55], s74 offen offset:2048 sc1 lds
    buffer_load_dwordx4 v1, s[52:55], s74 offen offset:3072 sc1 lds
    s_add_u32 m0, s77, 65536
    s_add_u32 s74, s75, 65536
    buffer_load_dwordx4 v1, s[52:55], s74 offen sc1 lds
    buffer_load_dwordx4 v1, s[52:55], s74 offen offset:1024 sc1 lds
    buffer_load_dwordx4 v1, s[52:55], s74 offen offset:2048 sc1 lds
    buffer_load_dwordx4 v1, s[52:55], s74 offen offset:3072 sc1 lds
L_convdone:
L_pad_cd_0:
    s_cbranch_execz L_pad_cd_1
    s_lshl_b32 s94, s3, 11
    s_add_u32 s94, s94, 0x10000
    buffer_load_dword v3, v214, s[52:55], s94 offen sc1
    s_add_u32 m0, s77, 81920
    s_add_u32 s74, s75, 81920
    buffer_load_dwordx4 v1, s[52:55], s74 offen sc1 lds
    buffer_load_dwordx4 v1, s[52:55], s74 offen offset:1024 sc1 lds
    buffer_load_dwordx4 v1, s[52:55], s74 offen offset:2048 sc1 lds
    buffer_load_dwordx4 v1, s[52:55], s74 offen offset:3072 sc1 lds
    s_lshl_b32 s73, s5, 9
    s_add_u32 s73, s73, 159744
    v_lshl_add_u32 v17, v0, 3, s73
    s_lshl_b32 s73, s5, 10
    s_add_u32 s73, s73, 155648
    v_lshl_add_u32 v19, v0, 3, s73
    v_lshlrev_b32 v18, 3, v0
    v_add_u32 v18, 159744, v18
    s_waitcnt vmcnt(28)
    v_add_f32 v176, v176, v178
    v_add_f32 v177, v177, v179
    s_waitcnt vmcnt(27)
    v_add_f32 v176, v176, v180
    v_add_f32 v177, v177, v181
    s_waitcnt vmcnt(26)
    v_add_f32 v176, v176, v182
    v_add_f32 v177, v177, v183
    s_waitcnt vmcnt(25)
    v_add_f32 v176, v176, v184
    v_add_f32 v177, v177, v185
    s_waitcnt vmcnt(24)
    v_lshlrev_b32 v186, 16, v187
    v_and_b32 v187, s85, v187
    ds_write_b64 v17, v[176:177]
    ds_write_b64 v19, v[186:187] offset:512
    s_lshl_b32 s61, s65, 1
    s_add_u32 s61, s61, s80
    s_mul_i32 s66, s61, 20480
    s_add_u32 s66, s66, s72
    v_lshrrev_b32 v9, 2, v0
    v_and_b32_e64 v10, 3, v0
    v_mul_u32_u24 v8, 1280, v9
    v_lshl_add_u32 v220, v10, 4, v8
    v_lshl_add_u32 v221, v10, 3, v8
    v_and_b32 v4, 1, v10
    v_and_b32 v8, 2, v10
    v_lshl_add_u32 v4, v8, 2, v4
    v_xor_b32_e64 v4, v4, v9
    v_lshl_add_u32 v4, v10, 4, v4
    s_mul_i32 s73, s5, 3072
    s_add_u32 s73, s73, 143360
    v_lshl_add_u32 v222, v4, 4, s73
    v_bfe_u32 v4, v0, 4, 1
    v_bfe_u32 v8, v0, 5, 1
    v_lshl_add_u32 v4, v8, 3, v4
    v_xor_b32 v4, v4, v0
    v_lshl_add_u32 v223, v4, 4, s73
    v_lshrrev_b32 v252, 1, v1
    s_lshl_b32 s57, s2, 2
    s_add_u32 s57, s57, s5
    s_mul_i32 s57, s57, 2560
    s_add_u32 s57, s57, 0x1198000
    v_mov_b32_e64 v253, v227
    v_writelane_b32 v253, 64, 1
    s_xor_b32 s56, s0, 0x8000
    v_add_u32 v254, 3072, v1
    s_cmp_ge_u32 s68, 1
    s_cselect_b32 s12, 0, 1
    s_mul_i32 s12, s12, 7168
    s_add_u32 s12, s12, s81
    s_cmp_ge_u32 s68, 2
    s_cselect_b32 s13, 1, 2
    s_mul_i32 s13, s13, 7168
    s_add_u32 s13, s13, s81
    s_cmp_ge_u32 s68, 3
    s_cselect_b32 s14, 2, 3
    s_mul_i32 s14, s14, 7168
    s_add_u32 s14, s14, s81
    s_cmp_ge_u32 s68, 4
    s_cselect_b32 s15, 3, 4
    s_mul_i32 s15, s15, 7168
    s_add_u32 s15, s15, s81
    s_cmp_ge_u32 s68, 5
    s_cselect_b32 s16, 4, 5
    s_mul_i32 s16, s16, 7168
    s_add_u32 s16, s16, s81
    s_cmp_ge_u32 s68, 6
    s_cselect_b32 s17, 5, 6
    s_mul_i32 s17, s17, 7168
    s_add_u32 s17, s17, s81
    s_cmp_ge_u32 s68, 7
    s_cselect_b32 s18, 6, 7
    s_mul_i32 s18, s18, 7168
    s_add_u32 s18, s18, s81
    s_sub_u32 s95, s99, 8
    s_cmp_lg_u32 s5, 0
    s_cbranch_scc1 L_polld72
    s_waitcnt vmcnt(4)
    v_cmp_eq_u32 s[90:91], s6, v3
    s_nop 0
    s_cmp_eq_u64 s[90:91], -1
    s_cbranch_scc0 L_pollf74
L_polld72:
    s_waitcnt vmcnt(5)
    s_waitcnt lgkmcnt(0)
    s_barrier
    s_nop 0
    buffer_load_dwordx4 a[0:3], v16, s[52:55], s64 offen sc1
    buffer_load_dwordx4 a[4:7], v21, s[52:55], s64 offen sc1
    s_add_u32 s64, s64, 131072
    buffer_load_dwordx4 a[8:11], v16, s[52:55], s64 offen sc1
    buffer_load_dwordx4 a[12:15], v21, s[52:55], s64 offen sc1
    s_add_u32 s64, s64, 131072
    buffer_load_dwordx4 a[16:19], v16, s[52:55], s64 offen sc1
    buffer_load_dwordx4 a[20:23], v21, s[52:55], s64 offen sc1
    s_add_u32 s64, s64, 131072
    buffer_load_dwordx4 a[24:27], v16, s[52:55], s64 offen sc1
    buffer_load_dwordx4 a[28:31], v21, s[52:55], s64 offen sc1
    s_add_u32 s64, s64, 131072
    buffer_load_dwordx4 a[32:35], v16, s[52:55], s64 offen sc1
    buffer_load_dwordx4 a[36:39], v21, s[52:55], s64 offen sc1
    s_add_u32 s64, s64, 131072
    ds_read_b64 v[176:177], v18 offset:0
    ds_read_b64 v[178:179], v18 offset:512
    ds_read_b64 v[180:181], v18 offset:1024
    ds_read_b64 v[182:183], v18 offset:1536
    ds_read_b128 v[64:67], v1 offset:0
    ds_read_b128 v[68:71], v1 offset:1024
    ds_read_b128 v[72:75], v1 offset:2048
    ds_read_b128 v[76:79], v1 offset:3072
    ds_read_b128 v[80:83], v1 offset:4096
    ds_read_b128 v[84:87], v1 offset:5120
    ds_read_b128 v[88:91], v1 offset:6144
    ds_read_b128 v[92:95], v1 offset:7168
    s_waitcnt vmcnt(9)
    v_mfma_f32_16x16x32_bf16 v[56:59], a[0:3], a[0:3], 0
    buffer_load_dwordx4 a[40:43], v16, s[52:55], s64 offen sc1
    s_waitcnt vmcnt(9)
    v_mfma_f32_16x16x32_bf16 v[60:63], a[4:7], a[4:7], 0
    s_waitcnt lgkmcnt(4)
    v_mfma_f32_16x16x32_bf16 v[24:27], v[64:67], a[0:3], 0
    ds_read_b128 v[96:99], v1 offset:8192
    v_mfma_f32_16x16x32_bf16 v[40:43], v[64:67], a[4:7], 0
    v_mfma_f32_16x16x32_bf16 v[28:31], v[68:71], a[0:3], 0
    ds_read_b128 v[100:103], v1 offset:9216
    v_mfma_f32_16x16x32_bf16 v[44:47], v[68:71], a[4:7], 0
    buffer_load_dwordx4 a[44:47], v21, s[52:55], s64 offen sc1
    s_add_u32 s64, s64, 131072
    v_mfma_f32_16x16x32_bf16 v[32:35], v[72:75], a[0:3], 0
    ds_read_b128 v[104:107], v1 offset:10240
    v_mfma_f32_16x16x32_bf16 v[48:51], v[72:75], a[4:7], 0
    v_mfma_f32_16x16x32_bf16 v[36:39], v[76:79], a[0:3], 0
    ds_read_b128 v[108:111], v1 offset:11264
    v_mfma_f32_16x16x32_bf16 v[52:55], v[76:79], a[4:7], 0
    s_waitcnt vmcnt(9)
    v_mfma_f32_16x16x32_bf16 v[56:59], a[8:11], a[8:11], v[56:59]
    buffer_load_dwordx4 a[48:51], v16, s[52:55], s64 offen sc1
    s_waitcnt vmcnt(9)
    v_mfma_f32_16x16x32_bf16 v[60:63], a[12:15], a[12:15], v[60:63]
    s_waitcnt lgkmcnt(4)
    v_mfma_f32_16x16x32_bf16 v[24:27], v[80:83], a[8:11], v[24:27]
    ds_read_b128 v[64:67], v1 offset:12288
    v_mfma_f32_16x16x32_bf16 v[40:43], v[80:83], a[12:15], v[40:43]
    v_mfma_f32_16x16x32_bf16 v[28:31], v[84:87], a[8:11], v[28:31]
    ds_read_b128 v[68:71], v1 offset:13312
    v_mfma_f32_16x16x32_bf16 v[44:47], v[84:87], a[12:15], v[44:47]
    buffer_load_dwordx4 a[52:55], v21, s[52:55], s64 offen sc1
    s_add_u32 s64, s64, 131072
    v_mfma_f32_16x16x32_bf16 v[32:35], v[88:91], a[8:11], v[32:35]
    ds_read_b128 v[72:75], v1 offset:14336
    v_mfma_f32_16x16x32_bf16 v[48:51], v[88:91], a[12:15], v[48:51]
    v_mfma_f32_16x16x32_bf16 v[36:39], v[92:95], a[8:11], v[36:39]
    ds_read_b128 v[76:79], v1 offset:15360
    v_mfma_f32_16x16x32_bf16 v[52:55], v[92:95], a[12:15], v[52:55]
    v_add_f32 v176, v176, v178
    s_waitcnt vmcnt(9)
    v_mfma_f32_16x16x32_bf16 v[56:59], a[16:19], a[16:19], v[56:59]
    buffer_load_dwordx4 a[56:59], v16, s[52:55], s64 offen sc1
    s_waitcnt vmcnt(9)
    v_mfma_f32_16x16x32_bf16 v[60:63], a[20:23], a[20:23], v[60:63]
    s_waitcnt lgkmcnt(4)
    v_mfma_f32_16x16x32_bf16 v[24:27], v[96:99], a[16:19], v[24:27]
    ds_read_b128 v[80:83], v1 offset:16384
    v_mfma_f32_16x16x32_bf16 v[40:43], v[96:99], a[20:23], v[40:43]
    v_mfma_f32_16x16x32_bf16 v[28:31], v[100:103], a[16:19], v[28:31]
    ds_read_b128 v[84:87], v1 offset:17408
    v_mfma_f32_16x16x32_bf16 v[44:47], v[100:103], a[20:23], v[44:47]
    buffer_load_dwordx4 a[60:63], v21, s[52:55], s64 offen sc1
    s_add_u32 s64, s64, 131072
    v_mfma_f32_16x16x32_bf16 v[32:35], v[104:107], a[16:19], v[32:35]
    ds_read_b128 v[88:91], v1 offset:18432
    v_mfma_f32_16x16x32_bf16 v[48:51], v[104:107], a[20:23], v[48:51]
    v_mfma_f32_16x16x32_bf16 v[36:39], v[108:111], a[16:19], v[36:39]
    ds_read_b128 v[92:95], v1 offset:19456
    v_mfma_f32_16x16x32_bf16 v[52:55], v[108:111], a[20:23], v[52:55]
    v_add_f32 v177, v177, v179
    s_waitcnt vmcnt(9)
    v_mfma_f32_16x16x32_bf16 v[56:59], a[24:27], a[24:27], v[56:59]
    buffer_load_dwordx4 a[64:67], v16, s[52:55], s64 offen sc1
    s_waitcnt vmcnt(9)
    v_mfma_f32_16x16x32_bf16 v[60:63], a[28:31], a[28:31], v[60:63]
    s_waitcnt lgkmcnt(4)
    v_mfma_f32_16x16x32_bf16 v[24:27], v[64:67], a[24:27], v[24:27]
    ds_read_b128 v[96:99], v1 offset:20480
    v_mfma_f32_16x16x32_bf16 v[40:43], v[64:67], a[28:31], v[40:43]
    v_mfma_f32_16x16x32_bf16 v[28:31], v[68:71], a[24:27], v[28:31]
    ds_read_b128 v[100:103], v1 offset:21504
    v_mfma_f32_16x16x32_bf16 v[44:47], v[68:71], a[28:31], v[44:47]
    buffer_load_dwordx4 a[68:71], v21, s[52:55], s64 offen sc1
    s_add_u32 s64, s64, 131072
    v_mfma_f32_16x16x32_bf16 v[32:35], v[72:75], a[24:27], v[32:35]
    ds_read_b128 v[104:107], v1 offset:22528
    v_mfma_f32_16x16x32_bf16 v[48:51], v[72:75], a[28:31], v[48:51]
    v_mfma_f32_16x16x32_bf16 v[36:39], v[76:79], a[24:27], v[36:39]
    ds_read_b128 v[108:111], v1 offset:23552
    v_mfma_f32_16x16x32_bf16 v[52:55], v[76:79], a[28:31], v[52:55]
    v_add_f32 v180, v180, v182
    s_waitcnt vmcnt(9)
    v_mfma_f32_16x16x32_bf16 v[56:59], a[32:35], a[32:35], v[56:59]
    buffer_load_dwordx4 a[72:75], v16, s[52:55], s64 offen sc1
    s_waitcnt vmcnt(9)
    v_mfma_f32_16x16x32_bf16 v[60:63], a[36:39], a[36:39], v[60:63]
    s_waitcnt lgkmcnt(4)
    v_mfma_f32_16x16x32_bf16 v[24:27], v[80:83], a[32:35], v[24:27]
    ds_read_b128 v[64:67], v1 offset:24576
    v_mfma_f32_16x16x32_bf16 v[40:43], v[80:83], a[36:39], v[40:43]
    buffer_load_dwordx4 v[112:115], v21, s[52:55], s79 offen sc1
    v_mfma_f32_16x16x32_bf16 v[28:31], v[84:87], a[32:35], v[28:31]
    ds_read_b128 v[68:71], v1 offset:25600
    v_mfma_f32_16x16x32_bf16 v[44:47], v[84:87], a[36:39], v[44:47]
    buffer_load_dwordx4 a[76:79], v21, s[52:55], s64 offen sc1
    s_add_u32 s64, s64, 131072
    v_mfma_f32_16x16x32_bf16 v[32:35], v[88:91], a[32:35], v[32:35]
    ds_read_b128 v[72:75], v1 offset:26624
    v_mfma_f32_16x16x32_bf16 v[48:51], v[88:91], a[36:39], v[48:51]
    v_mfma_f32_16x16x32_bf16 v[36:39], v[92:95], a[32:35], v[36:39]
    ds_read_b128 v[76:79], v1 offset:27648
    v_mfma_f32_16x16x32_bf16 v[52:55], v[92:95], a[36:39], v[52:55]
    v_add_f32 v181, v181, v183
    s_waitcnt vmcnt(10)
    v_mfma_f32_16x16x32_bf16 v[56:59], a[40:43], a[40:43], v[56:59]
    buffer_load_dwordx4 a[80:83], v16, s[52:55], s64 offen sc1
    s_waitcnt vmcnt(10)
    v_mfma_f32_16x16x32_bf16 v[60:63], a[44:47], a[44:47], v[60:63]
    s_waitcnt lgkmcnt(4)
    v_mfma_f32_16x16x32_bf16 v[24:27], v[96:99], a[40:43], v[24:27]
    ds_read_b128 v[80:83], v1 offset:28672
    v_mfma_f32_16x16x32_bf16 v[40:43], v[96:99], a[44:47], v[40:43]
    buffer_load_dwordx4 v[116:119], v21, s[52:55], s70 offen sc1
    v_mfma_f32_16x16x32_bf16 v[28:31], v[100:103], a[40:43], v[28:31]
    ds_read_b128 v[84:87], v1 offset:29696
    v_mfma_f32_16x16x32_bf16 v[44:47], v[100:103], a[44:47], v[44:47]
    buffer_load_dwordx4 a[84:87], v21, s[52:55], s64 offen sc1
    s_add_u32 s64, s64, 131072
    v_mfma_f32_16x16x32_bf16 v[32:35], v[104:107], a[40:43], v[32:35]
    ds_read_b128 v[88:91], v1 offset:30720
    v_mfma_f32_16x16x32_bf16 v[48:51], v[104:107], a[44:47], v[48:51]
    v_mfma_f32_16x16x32_bf16 v[36:39], v[108:111], a[40:43], v[36:39]
    ds_read_b128 v[92:95], v1 offset:31744
    v_mfma_f32_16x16x32_bf16 v[52:55], v[108:111], a[44:47], v[52:55]
    v_add_f32 v176, v176, v180
    s_waitcnt vmcnt(11)
    v_mfma_f32_16x16x32_bf16 v[56:59], a[48:51], a[48:51], v[56:59]
    buffer_load_dwordx4 a[88:91], v16, s[52:55], s64 offen sc1
L_pad_m0_0:
    s_cbranch_execz L_pad_m0_1
    s_waitcnt vmcnt(11)
    v_mfma_f32_16x16x32_bf16 v[60:63], a[52:55], a[52:55], v[60:63]
    s_waitcnt lgkmcnt(4)
    v_mfma_f32_16x16x32_bf16 v[24:27], v[64:67], a[48:51], v[24:27]
    ds_read_b128 v[96:99], v1 offset:32768
    v_mfma_f32_16x16x32_bf16 v[40:43], v[64:67], a[52:55], v[40:43]
    buffer_load_dwordx2 v[120:121], v6, s[52:55], s71 offen sc1
    v_mfma_f32_16x16x32_bf16 v[28:31], v[68:71], a[48:51], v[28:31]
    ds_read_b128 v[100:103], v1 offset:33792
    v_mfma_f32_16x16x32_bf16 v[44:47], v[68:71], a[52:55], v[44:47]
    buffer_load_dwordx4 a[92:95], v21, s[52:55], s64 offen sc1
    s_add_u32 s64, s64, 131072
    v_mfma_f32_16x16x32_bf16 v[32:35], v[72:75], a[48:51], v[32:35]
    ds_read_b128 v[104:107], v1 offset:34816
    v_mfma_f32_16x16x32_bf16 v[48:51], v[72:75], a[52:55], v[48:51]
    v_mfma_f32_16x16x32_bf16 v[36:39], v[76:79], a[48:51], v[36:39]
    ds_read_b128 v[108:111], v1 offset:35840
    v_mfma_f32_16x16x32_bf16 v[52:55], v[76:79], a[52:55], v[52:55]
    v_add_f32 v177, v177, v181
    s_waitcnt vmcnt(12)
    v_mfma_f32_16x16x32_bf16 v[56:59], a[56:59], a[56:59], v[56:59]
    buffer_load_dwordx4 a[96:99], v16, s[52:55], s64 offen sc1
    s_waitcnt vmcnt(12)
    v_mfma_f32_16x16x32_bf16 v[60:63], a[60:63], a[60:63], v[60:63]
    s_waitcnt lgkmcnt(4)
    v_mfma_f32_16x16x32_bf16 v[24:27], v[80:83], a[56:59], v[24:27]
    ds_read_b128 v[64:67], v1 offset:36864
    v_mfma_f32_16x16x32_bf16 v[40:43], v[80:83], a[60:63], v[40:43]
    v_mfma_f32_16x16x32_bf16 v[28:31], v[84:87], a[56:59], v[28:31]
    ds_read_b128 v[68:71], v1 offset:37888
    v_mfma_f32_16x16x32_bf16 v[44:47], v[84:87], a[60:63], v[44:47]
    buffer_load_dwordx4 a[100:103], v21, s[52:55], s64 offen sc1
    s_add_u32 s64, s64, 131072
    v_mfma_f32_16x16x32_bf16 v[32:35], v[88:91], a[56:59], v[32:35]
    ds_read_b128 v[72:75], v1 offset:38912
    v_mfma_f32_16x16x32_bf16 v[48:51], v[88:91], a[60:63], v[48:51]
    v_mfma_f32_16x16x32_bf16 v[36:39], v[92:95], a[56:59], v[36:39]
    ds_read_b128 v[76:79], v1 offset:39936
    v_mfma_f32_16x16x32_bf16 v[52:55], v[92:95], a[60:63], v[52:55]
    ds_write_b64 v19, v[176:177]
    s_waitcnt vmcnt(12)
    v_mfma_f32_16x16x32_bf16 v[56:59], a[64:67], a[64:67], v[56:59]
    buffer_load_dwordx4 a[104:107], v16, s[52:55], s64 offen sc1
    s_waitcnt vmcnt(12)
    v_mfma_f32_16x16x32_bf16 v[60:63], a[68:71], a[68:71], v[60:63]
    s_waitcnt lgkmcnt(5)
    v_mfma_f32_16x16x32_bf16 v[24:27], v[96:99], a[64:67], v[24:27]
    ds_read_b128 v[80:83], v1 offset:40960
    v_mfma_f32_16x16x32_bf16 v[40:43], v[96:99], a[68:71], v[40:43]
    v_mfma_f32_16x16x32_bf16 v[28:31], v[100:103], a[64:67], v[28:31]
    ds_read_b128 v[84:87], v1 offset:41984
    v_mfma_f32_16x16x32_bf16 v[44:47], v[100:103], a[68:71], v[44:47]
    buffer_load_dwordx4 a[108:111], v21, s[52:55], s64 offen sc1
    s_add_u32 s64, s64, 131072
    v_mfma_f32_16x16x32_bf16 v[32:35], v[104:107], a[64:67], v[32:35]
    ds_read_b128 v[88:91], v1 offset:43008
    v_mfma_f32_16x16x32_bf16 v[48:51], v[104:107], a[68:71], v[48:51]
    v_mfma_f32_16x16x32_bf16 v[36:39], v[108:111], a[64:67], v[36:39]
    ds_read_b128 v[92:95], v1 offset:44032
    v_mfma_f32_16x16x32_bf16 v[52:55], v[108:111], a[68:71], v[52:55]
    s_waitcnt vmcnt(12)
    v_mfma_f32_16x16x32_bf16 v[56:59], a[72:75], a[72:75], v[56:59]
    buffer_load_dwordx4 a[112:115], v16, s[52:55], s64 offen sc1
    s_waitcnt vmcnt(11)
    v_mfma_f32_16x16x32_bf16 v[60:63], a[76:79], a[76:79], v[60:63]
    s_waitcnt lgkmcnt(5)
    v_mfma_f32_16x16x32_bf16 v[24:27], v[64:67], a[72:75], v[24:27]
    ds_read_b128 v[96:99], v1 offset:45056
    v_mfma_f32_16x16x32_bf16 v[40:43], v[64:67], a[76:79], v[40:43]
    v_mfma_f32_16x16x32_bf16 v[28:31], v[68:71], a[72:75], v[28:31]
    ds_read_b128 v[100:103], v1 offset:46080
    v_mfma_f32_16x16x32_bf16 v[44:47], v[68:71], a[76:79], v[44:47]
    buffer_load_dwordx4 a[116:119], v21, s[52:55], s64 offen sc1
    s_add_u32 s64, s64, 131072
    v_mfma_f32_16x16x32_bf16 v[32:35], v[72:75], a[72:75], v[32:35]
    ds_read_b128 v[104:107], v1 offset:47104
    v_mfma_f32_16x16x32_bf16 v[48:51], v[72:75], a[76:79], v[48:51]
    v_mfma_f32_16x16x32_bf16 v[36:39], v[76:79], a[72:75], v[36:39]
    ds_read_b128 v[108:111], v1 offset:48128
    v_mfma_f32_16x16x32_bf16 v[52:55], v[76:79], a[76:79], v[52:55]
    ds_read_b128 v[144:147], v20 offset:192
    s_waitcnt vmcnt(11)
    v_mfma_f32_16x16x32_bf16 v[56:59], a[80:83], a[80:83], v[56:59]
    buffer_load_dwordx4 a[120:123], v16, s[52:55], s64 offen sc1
    s_waitcnt vmcnt(10)
    v_mfma_f32_16x16x32_bf16 v[60:63], a[84:87], a[84:87], v[60:63]
    s_waitcnt lgkmcnt(5)
    v_mfma_f32_16x16x32_bf16 v[24:27], v[80:83], a[80:83], v[24:27]
    ds_read_b128 v[64:67], v1 offset:49152
    v_mfma_f32_16x16x32_bf16 v[40:43], v[80:83], a[84:87], v[40:43]
    v_mfma_f32_16x16x32_bf16 v[28:31], v[84:87], a[80:83], v[28:31]
    ds_read_b128 v[68:71], v1 offset:50176
    v_mfma_f32_16x16x32_bf16 v[44:47], v[84:87], a[84:87], v[44:47]
    buffer_load_dwordx4 a[124:127], v21, s[52:55], s64 offen sc1
    s_add_u32 s64, s64, 131072
    v_mfma_f32_16x16x32_bf16 v[32:35], v[88:91], a[80:83], v[32:35]
    ds_read_b128 v[72:75], v1 offset:51200
    v_mfma_f32_16x16x32_bf16 v[48:51], v[88:91], a[84:87], v[48:51]
    v_mfma_f32_16x16x32_bf16 v[36:39], v[92:95], a[80:83], v[36:39]
    ds_read_b128 v[76:79], v1 offset:52224
    v_mfma_f32_16x16x32_bf16 v[52:55], v[92:95], a[84:87], v[52:55]
    ds_read_b128 v[148:151], v20 offset:704
    s_waitcnt vmcnt(10)
    v_mfma_f32_16x16x32_bf16 v[56:59], a[88:91], a[88:91], v[56:59]
    buffer_load_dwordx4 a[128:131], v16, s[52:55], s64 offen sc1
    s_waitcnt vmcnt(9)
    v_mfma_f32_16x16x32_bf16 v[60:63], a[92:95], a[92:95], v[60:63]
    v_lshlrev_b32 v8, 16, v112
    v_lshlrev_b32 v9, 16, v122
    s_waitcnt lgkmcnt(6)
    v_mfma_f32_16x16x32_bf16 v[24:27], v[96:99], a[88:91], v[24:27]
    ds_read_b128 v[80:83], v1 offset:53248
    v_and_b32 v112, s85, v112
    v_mfma_f32_16x16x32_bf16 v[40:43], v[96:99], a[92:95], v[40:43]
    v_and_b32 v122, s85, v122
    v_add_f32 v232, v8, v9
    v_mfma_f32_16x16x32_bf16 v[28:31], v[100:103], a[88:91], v[28:31]
    ds_read_b128 v[84:87], v1 offset:54272
    v_add_f32 v233, v112, v122
    v_mfma_f32_16x16x32_bf16 v[44:47], v[100:103], a[92:95], v[44:47]
    buffer_load_dwordx4 a[132:135], v21, s[52:55], s64 offen sc1
    s_add_u32 s64, s64, 131072
    v_mfma_f32_16x16x32_bf16 v[32:35], v[104:107], a[88:91], v[32:35]
    ds_read_b128 v[88:91], v1 offset:55296
    v_lshlrev_b32 v8, 16, v113
    v_mfma_f32_16x16x32_bf16 v[48:51], v[104:107], a[92:95], v[48:51]
    v_lshlrev_b32 v9, 16, v123
    v_and_b32 v113, s85, v113
    v_mfma_f32_16x16x32_bf16 v[36:39], v[108:111], a[88:91], v[36:39]
    ds_read_b128 v[92:95], v1 offset:56320
    v_and_b32 v123, s85, v123
    v_mfma_f32_16x16x32_bf16 v[52:55], v[108:111], a[92:95], v[52:55]
    ds_read_b128 v[152:155], v20 offset:256
    s_waitcnt vmcnt(9)
    v_mfma_f32_16x16x32_bf16 v[56:59], a[96:99], a[96:99], v[56:59]
    buffer_load_dwordx4 a[136:139], v16, s[52:55], s64 offen sc1
    s_waitcnt vmcnt(9)
    v_mfma_f32_16x16x32_bf16 v[60:63], a[100:103], a[100:103], v[60:63]
    v_add_f32 v234, v8, v9
    v_add_f32 v235, v113, v123
    s_waitcnt lgkmcnt(6)
    v_mfma_f32_16x16x32_bf16 v[24:27], v[64:67], a[96:99], v[24:27]
    ds_read_b128 v[96:99], v1 offset:57344
    v_lshlrev_b32 v8, 16, v114
    v_mfma_f32_16x16x32_bf16 v[40:43], v[64:67], a[100:103], v[40:43]
    v_lshlrev_b32 v9, 16, v124
    v_and_b32 v114, s85, v114
    v_mfma_f32_16x16x32_bf16 v[28:31], v[68:71], a[96:99], v[28:31]
    ds_read_b128 v[100:103], v1 offset:58368
    v_and_b32 v124, s85, v124
    v_mfma_f32_16x16x32_bf16 v[44:47], v[68:71], a[100:103], v[44:47]
    buffer_load_dwordx4 a[140:143], v21, s[52:55], s64 offen sc1
    s_add_u32 s64, s64, 131072
    v_mfma_f32_16x16x32_bf16 v[32:35], v[72:75], a[96:99], v[32:35]
    ds_read_b128 v[104:107], v1 offset:59392
    v_add_f32 v236, v8, v9
    v_mfma_f32_16x16x32_bf16 v[48:51], v[72:75], a[100:103], v[48:51]
    v_add_f32 v237, v114, v124
    v_lshlrev_b32 v8, 16, v115
    v_mfma_f32_16x16x32_bf16 v[36:39], v[76:79], a[96:99], v[36:39]
    ds_read_b128 v[108:111], v1 offset:60416
    v_lshlrev_b32 v9, 16, v125
    v_mfma_f32_16x16x32_bf16 v[52:55], v[76:79], a[100:103], v[52:55]
    ds_read_b128 v[156:159], v20 offset:768
    s_waitcnt vmcnt(9)
    v_mfma_f32_16x16x32_bf16 v[56:59], a[104:107], a[104:107], v[56:59]
    buffer_load_dwordx4 a[144:147], v16, s[52:55], s64 offen sc1
    s_waitcnt vmcnt(9)
    v_mfma_f32_16x16x32_bf16 v[60:63], a[108:111], a[108:111], v[60:63]
    v_and_b32 v115, s85, v115
    v_and_b32 v125, s85, v125
    s_waitcnt lgkmcnt(6)
    v_mfma_f32_16x16x32_bf16 v[24:27], v[80:83], a[104:107], v[24:27]
    ds_read_b128 v[64:67], v1 offset:61440
    v_add_f32 v238, v8, v9
    v_mfma_f32_16x16x32_bf16 v[40:43], v[80:83], a[108:111], v[40:43]
    v_add_f32 v239, v115, v125
    v_lshlrev_b32 v8, 16, v116
    v_mfma_f32_16x16x32_bf16 v[28:31], v[84:87], a[104:107], v[28:31]
    ds_read_b128 v[68:71], v1 offset:62464
    v_lshlrev_b32 v9, 16, v126
    v_mfma_f32_16x16x32_bf16 v[44:47], v[84:87], a[108:111], v[44:47]
    buffer_load_dwordx4 a[148:151], v21, s[52:55], s64 offen sc1
    s_add_u32 s64, s64, 131072
    v_mfma_f32_16x16x32_bf16 v[32:35], v[88:91], a[104:107], v[32:35]
    ds_read_b128 v[72:75], v1 offset:63488
    v_and_b32 v116, s85, v116
    v_mfma_f32_16x16x32_bf16 v[48:51], v[88:91], a[108:111], v[48:51]
    v_and_b32 v126, s85, v126
    v_add_f32 v240, v8, v9
    v_mfma_f32_16x16x32_bf16 v[36:39], v[92:95], a[104:107], v[36:39]
    ds_read_b128 v[76:79], v1 offset:64512
    v_add_f32 v241, v116, v126
    v_mfma_f32_16x16x32_bf16 v[52:55], v[92:95], a[108:111], v[52:55]
    ds_read_b128 v[160:163], v20 offset:320
    s_waitcnt vmcnt(9)
    v_mfma_f32_16x16x32_bf16 v[56:59], a[112:115], a[112:115], v[56:59]
    buffer_load_dwordx4 a[152:155], v16, s[52:55], s64 offen sc1
    s_waitcnt vmcnt(9)
    v_mfma_f32_16x16x32_bf16 v[60:63], a[116:119], a[116:119], v[60:63]
    v_lshlrev_b32 v8, 16, v117
    v_lshlrev_b32 v9, 16, v127
    s_waitcnt lgkmcnt(6)
    v_mfma_f32_16x16x32_bf16 v[24:27], v[96:99], a[112:115], v[24:27]
    ds_read_b128 v[80:83], v14 offset:0
    v_and_b32 v117, s85, v117
    v_mfma_f32_16x16x32_bf16 v[40:43], v[96:99], a[116:119], v[40:43]
    v_and_b32 v127, s85, v127
    v_add_f32 v242, v8, v9
    v_mfma_f32_16x16x32_bf16 v[28:31], v[100:103], a[112:115], v[28:31]
    ds_read_b128 v[84:87], v14 offset:1024
    v_add_f32 v243, v117, v127
    v_mfma_f32_16x16x32_bf16 v[44:47], v[100:103], a[116:119], v[44:47]
    buffer_load_dwordx4 a[156:159], v21, s[52:55], s64 offen sc1
    s_add_u32 s64, s64, 131072
    v_mfma_f32_16x16x32_bf16 v[32:35], v[104:107], a[112:115], v[32:35]
    ds_read_b128 v[88:91], v14 offset:2048
    v_lshlrev_b32 v8, 16, v118
    v_mfma_f32_16x16x32_bf16 v[48:51], v[104:107], a[116:119], v[48:51]
    v_lshlrev_b32 v9, 16, v128
    v_and_b32 v118, s85, v118
    v_mfma_f32_16x16x32_bf16 v[36:39], v[108:111], a[112:115], v[36:39]
    ds_read_b128 v[92:95], v14 offset:3072
    v_and_b32 v128, s85, v128
    v_mfma_f32_16x16x32_bf16 v[52:55], v[108:111], a[116:119], v[52:55]
    ds_read_b128 v[164:167], v20 offset:832
    s_waitcnt vmcnt(9)
    v_mfma_f32_16x16x32_bf16 v[56:59], a[120:123], a[120:123], v[56:59]
    s_add_u32 m0, s77, 98304
    s_add_u32 s74, s75, 98304
    buffer_load_dwordx4 v1, s[52:55], s74 offen sc1 lds
    s_waitcnt vmcnt(9)
    v_mfma_f32_16x16x32_bf16 v[60:63], a[124:127], a[124:127], v[60:63]
    v_add_f32 v244, v8, v9
    v_add_f32 v245, v118, v128
    s_waitcnt lgkmcnt(6)
    v_mfma_f32_16x16x32_bf16 v[24:27], v[64:67], a[120:123], v[24:27]
    ds_read_b128 v[96:99], v14 offset:4096
    v_lshlrev_b32 v8, 16, v119
    v_mfma_f32_16x16x32_bf16 v[40:43], v[64:67], a[124:127], v[40:43]
    v_lshlrev_b32 v9, 16, v129
    v_and_b32 v119, s85, v119
    v_mfma_f32_16x16x32_bf16 v[28:31], v[68:71], a[120:123], v[28:31]
    ds_read_b128 v[100:103], v14 offset:5120
    v_and_b32 v129, s85, v129
    v_mfma_f32_16x16x32_bf16 v[44:47], v[68:71], a[124:127], v[44:47]
    buffer_load_dwordx4 v1, s[52:55], s74 offen offset:1024 sc1 lds
    v_mfma_f32_16x16x32_bf16 v[32:35], v[72:75], a[120:123], v[32:35]
    ds_read_b128 v[104:107], v14 offset:6144
    v_add_f32 v246, v8, v9
    v_mfma_f32_16x16x32_bf16 v[48:51], v[72:75], a[124:127], v[48:51]
    v_add_f32 v247, v119, v129
    v_lshlrev_b32 v8, 16, v120
    v_mfma_f32_16x16x32_bf16 v[36:39], v[76:79], a[120:123], v[36:39]
    ds_read_b128 v[108:111], v14 offset:7168
    v_lshlrev_b32 v9, 16, v130
    v_mfma_f32_16x16x32_bf16 v[52:55], v[76:79], a[124:127], v[52:55]
    ds_read_b128 v[168:171], v20 offset:384
    s_waitcnt vmcnt(9)
    v_mfma_f32_16x16x32_bf16 v[56:59], a[128:131], a[128:131], v[56:59]
    buffer_load_dwordx4 v1, s[52:55], s74 offen offset:2048 sc1 lds
    s_waitcnt vmcnt(9)
    v_mfma_f32_16x16x32_bf16 v[60:63], a[132:135], a[132:135], v[60:63]
    v_and_b32 v120, s85, v120
    v_and_b32 v130, s85, v130
    s_waitcnt lgkmcnt(6)
    v_mfma_f32_16x16x32_bf16 v[24:27], v[80:83], a[128:131], v[24:27]
    ds_read_b128 v[64:67], v14 offset:8192
    v_add_f32 v248, v8, v9
    v_mfma_f32_16x16x32_bf16 v[40:43], v[80:83], a[132:135], v[40:43]
    v_add_f32 v249, v120, v130
    v_lshlrev_b32 v8, 16, v121
    v_mfma_f32_16x16x32_bf16 v[28:31], v[84:87], a[128:131], v[28:31]
    ds_read_b128 v[68:71], v14 offset:9216
    v_lshlrev_b32 v9, 16, v131
    v_mfma_f32_16x16x32_bf16 v[44:47], v[84:87], a[132:135], v[44:47]
    buffer_load_dwordx4 v1, s[52:55], s74 offen offset:3072 sc1 lds
    v_mfma_f32_16x16x32_bf16 v[32:35], v[88:91], a[128:131], v[32:35]
    ds_read_b128 v[72:75], v14 offset:10240
    v_and_b32 v121, s85, v121
    v_mfma_f32_16x16x32_bf16 v[48:51], v[88:91], a[132:135], v[48:51]
    v_and_b32 v131, s85, v131
    v_add_f32 v250, v8, v9
    v_mfma_f32_16x16x32_bf16 v[36:39], v[92:95], a[128:131], v[36:39]
    ds_read_b128 v[76:79], v14 offset:11264
    v_add_f32 v251, v121, v131
    v_mfma_f32_16x16x32_bf16 v[52:55], v[92:95], a[132:135], v[52:55]
    ds_read_b128 v[172:175], v20 offset:896
    s_waitcnt vmcnt(9)
    v_mfma_f32_16x16x32_bf16 v[56:59], a[136:139], a[136:139], v[56:59]
    ds_read_b128 v[92:95], v14 offset:15360
    s_waitcnt vmcnt(8)
    v_mfma_f32_16x16x32_bf16 v[60:63], a[140:143], a[140:143], v[60:63]
    ds_read_b128 v[80:83], v14 offset:12288
    s_add_u32 m0, s77, 114688
    s_add_u32 s74, s75, 114688
    buffer_load_dwordx4 v1, s[52:55], s74 offen sc1 lds
    s_waitcnt lgkmcnt(8)
    v_mfma_f32_16x16x32_bf16 v[36:39], v[108:111], a[136:139], v[36:39]
    v_mfma_f32_16x16x32_bf16 v[52:55], v[108:111], a[140:143], v[52:55]
    s_waitcnt vmcnt(8)
    v_mfma_f32_16x16x32_bf16 v[56:59], a[144:147], a[144:147], v[56:59]
    ds_read_b128 v[84:87], v14 offset:13312
    s_waitcnt vmcnt(7)
    v_mfma_f32_16x16x32_bf16 v[60:63], a[148:151], a[148:151], v[60:63]
    ds_read_b128 v[88:91], v14 offset:14336
    buffer_load_dwordx4 v1, s[52:55], s74 offen offset:1024 sc1 lds
    s_waitcnt lgkmcnt(5)
    v_mfma_f32_16x16x32_bf16 v[36:39], v[76:79], a[144:147], v[36:39]
    v_mfma_f32_16x16x32_bf16 v[52:55], v[76:79], a[148:151], v[52:55]
    s_waitcnt vmcnt(7)
    v_mfma_f32_16x16x32_bf16 v[56:59], a[152:155], a[152:155], v[56:59]
    s_waitcnt vmcnt(6)
    v_mfma_f32_16x16x32_bf16 v[60:63], a[156:159], a[156:159], v[60:63]
    buffer_load_dwordx4 v1, s[52:55], s74 offen offset:2048 sc1 lds
    s_waitcnt lgkmcnt(3)
    v_mfma_f32_16x16x32_bf16 v[36:39], v[92:95], a[152:155], v[36:39]
    v_mfma_f32_16x16x32_bf16 v[52:55], v[92:95], a[156:159], v[52:55]
    v_mfma_f32_16x16x32_bf16 v[24:27], v[96:99], a[136:139], v[24:27]
    s_waitcnt lgkmcnt(0)
    s_barrier
    v_mfma_f32_16x16x32_bf16 v[40:43], v[96:99], a[140:143], v[40:43]
    buffer_load_dwordx4 v1, s[52:55], s74 offen offset:3072 sc1 lds
    v_mfma_f32_16x16x32_bf16 v[28:31], v[100:103], a[136:139], v[28:31]
    v_mfma_f32_16x16x32_bf16 v[44:47], v[100:103], a[140:143], v[44:47]
    v_cndmask_b32 v180, v56, v57, s[88:89]
    v_cndmask_b32 v181, v58, v59, s[88:89]
    v_mfma_f32_16x16x32_bf16 v[32:35], v[104:107], a[136:139], v[32:35]
    v_cndmask_b32 v180, v180, v181, s[82:83]
    ds_bpermute_b32 v176, v12, v180
    v_mfma_f32_16x16x32_bf16 v[48:51], v[104:107], a[140:143], v[48:51]
    v_cndmask_b32 v182, v60, v61, s[88:89]
    v_cndmask_b32 v183, v62, v63, s[88:89]
    v_mfma_f32_16x16x32_bf16 v[24:27], v[64:67], a[144:147], v[24:27]
    v_cndmask_b32 v182, v182, v183, s[82:83]
    ds_bpermute_b32 v177, v12, v182
    v_mfma_f32_16x16x32_bf16 v[40:43], v[64:67], a[148:151], v[40:43]
    ds_bpermute_b32 v178, v13, v36
    ds_bpermute_b32 v179, v13, v52
    v_mfma_f32_16x16x32_bf16 v[28:31], v[68:71], a[144:147], v[28:31]
    v_mfma_f32_16x16x32_bf16 v[44:47], v[68:71], a[148:151], v[44:47]
    v_mfma_f32_16x16x32_bf16 v[32:35], v[72:75], a[144:147], v[32:35]
    v_mfma_f32_16x16x32_bf16 v[48:51], v[72:75], a[148:151], v[48:51]
    s_add_u32 m0, s63, 131072
    s_add_u32 s74, s62, 131072
    buffer_load_dwordx4 v1, s[52:55], s74 offen sc1 lds
    v_mfma_f32_16x16x32_bf16 v[24:27], v[80:83], a[152:155], v[24:27]
    v_mfma_f32_16x16x32_bf16 v[40:43], v[80:83], a[156:159], v[40:43]
    v_mfma_f32_16x16x32_bf16 v[28:31], v[84:87], a[152:155], v[28:31]
    v_mfma_f32_16x16x32_bf16 v[44:47], v[84:87], a[156:159], v[44:47]
    v_mfma_f32_16x16x32_bf16 v[32:35], v[88:91], a[152:155], v[32:35]
    s_add_u32 m0, s63, 135168
    s_add_u32 s74, s62, 135168
    buffer_load_dwordx4 v1, s[52:55], s74 offen sc1 lds
    v_mfma_f32_16x16x32_bf16 v[48:51], v[88:91], a[156:159], v[48:51]
    s_add_u32 m0, s63, 139264
    s_add_u32 s74, s62, 139264
    buffer_load_dwordx4 v1, s[52:55], s74 offen sc1 lds
    s_waitcnt lgkmcnt(0)
    v_pk_mul_f32 v[178:179], v[178:179], s[86:87] op_sel_hi:[1,0]
    v_pk_mul_f32 v[176:177], v[176:177], s[86:87] op_sel_hi:[1,0]
    v_pk_fma_f32 v[176:177], v[178:179], v[178:179], v[176:177] neg_lo:[1,0,0] neg_hi:[1,0,0]
    v_max_f32 v176, 0, v176
    v_max_f32 v177, 0, v177
    v_fmaak_f32 v176, v176, v11, 0x2edbe6ff
    v_fmaak_f32 v177, v177, v11, 0x2edbe6ff
    v_rsq_f32 v184, v176
    v_rsq_f32_e64 v185, v177
    s_nop 0
    v_pk_mul_f32 v[186:187], v[178:179], v[184:185] neg_lo:[1,0] neg_hi:[1,0]
    v_pk_fma_f32 v[188:189], v[144:145], v[186:187], v[148:149] op_sel:[0,0,0] op_sel_hi:[1,0,1]
    v_pk_fma_f32 v[190:191], v[146:147], v[186:187], v[150:151] op_sel:[0,0,0] op_sel_hi:[1,0,1]
    v_pk_fma_f32 v[192:193], v[144:145], v[186:187], v[148:149] op_sel:[0,1,0] op_sel_hi:[1,1,1]
    v_pk_fma_f32 v[194:195], v[146:147], v[186:187], v[150:151] op_sel:[0,1,0] op_sel_hi:[1,1,1]
    v_pk_fma_f32 v[188:189], v[24:25], v[184:185], v[188:189] op_sel:[0,0,0] op_sel_hi:[1,0,1]
    v_pk_fma_f32 v[190:191], v[26:27], v[184:185], v[190:191] op_sel:[0,0,0] op_sel_hi:[1,0,1]
    v_pk_fma_f32 v[192:193], v[40:41], v[184:185], v[192:193] op_sel:[0,1,0] op_sel_hi:[1,1,1]
    v_pk_fma_f32 v[194:195], v[42:43], v[184:185], v[194:195] op_sel:[0,1,0] op_sel_hi:[1,1,1]
    s_add_u32 m0, s77, 0
    s_nop 0
    s_add_u32 s74, s75, 2293760
    buffer_load_dwordx4 v1, s[52:55], s74 offen sc1 lds
    v_pk_mul_f32 v[196:197], v[188:189], v[188:189]
    v_pk_mul_f32 v[198:199], v[190:191], v[190:191]
    v_pk_mul_f32 v[200:201], v[192:193], v[192:193]
    v_pk_mul_f32 v[202:203], v[194:195], v[194:195]
    v_pk_fma_f32 v[196:197], v[196:197], v[22:23], v[22:23] op_sel:[0,1,0] op_sel_hi:[1,1,0]
    v_pk_fma_f32 v[198:199], v[198:199], v[22:23], v[22:23] op_sel:[0,1,0] op_sel_hi:[1,1,0]
    v_pk_fma_f32 v[200:201], v[200:201], v[22:23], v[22:23] op_sel:[0,1,0] op_sel_hi:[1,1,0]
    v_pk_fma_f32 v[202:203], v[202:203], v[22:23], v[22:23] op_sel:[0,1,0] op_sel_hi:[1,1,0]
    v_pk_mul_f32 v[196:197], v[196:197], v[188:189]
    v_pk_mul_f32 v[198:199], v[198:199], v[190:191]
    v_pk_mul_f32 v[200:201], v[200:201], v[192:193]
    v_pk_mul_f32 v[202:203], v[202:203], v[194:195]
    v_exp_f32 v196, v196
    v_exp_f32 v197, v197
    v_exp_f32 v198, v198
    v_exp_f32 v199, v199
    v_exp_f32 v200, v200
    v_exp_f32 v201, v201
    v_exp_f32 v202, v202
    v_exp_f32 v203, v203
    buffer_load_dwordx4 v1, s[52:55], s74 offen offset:1024 sc1 lds
    v_pk_add_f32 v[196:197], v[196:197], 1.0 op_sel_hi:[1,0]
    v_pk_add_f32 v[198:199], v[198:199], 1.0 op_sel_hi:[1,0]
    v_pk_add_f32 v[200:201], v[200:201], 1.0 op_sel_hi:[1,0]
    v_pk_add_f32 v[202:203], v[202:203], 1.0 op_sel_hi:[1,0]
    v_rcp_f32 v196, v196
    v_rcp_f32 v197, v197
    v_rcp_f32 v198, v198
    v_rcp_f32 v199, v199
    v_rcp_f32 v200, v200
    v_rcp_f32 v201, v201
    v_rcp_f32 v202, v202
    v_rcp_f32 v203, v203
    buffer_load_dwordx4 v1, s[52:55], s74 offen offset:2048 sc1 lds
    v_pk_mul_f32 v[196:197], v[196:197], v[188:189]
    v_pk_mul_f32 v[198:199], v[198:199], v[190:191]
    v_pk_mul_f32 v[200:201], v[200:201], v[192:193]
    v_pk_mul_f32 v[202:203], v[202:203], v[194:195]
    v_cvt_pk_bf16_f32 v204, v196, v197
    v_cvt_pk_bf16_f32 v205, v198, v199
    v_cvt_pk_bf16_f32 v208, v200, v201
    v_cvt_pk_bf16_f32 v209, v202, v203
    v_pk_fma_f32 v[188:189], v[152:153], v[186:187], v[156:157] op_sel:[0,0,0] op_sel_hi:[1,0,1]
    v_pk_fma_f32 v[190:191], v[154:155], v[186:187], v[158:159] op_sel:[0,0,0] op_sel_hi:[1,0,1]
    v_pk_fma_f32 v[192:193], v[152:153], v[186:187], v[156:157] op_sel:[0,1,0] op_sel_hi:[1,1,1]
    v_pk_fma_f32 v[194:195], v[154:155], v[186:187], v[158:159] op_sel:[0,1,0] op_sel_hi:[1,1,1]
    v_pk_fma_f32 v[188:189], v[28:29], v[184:185], v[188:189] op_sel:[0,0,0] op_sel_hi:[1,0,1]
    v_pk_fma_f32 v[190:191], v[30:31], v[184:185], v[190:191] op_sel:[0,0,0] op_sel_hi:[1,0,1]
    v_pk_fma_f32 v[192:193], v[44:45], v[184:185], v[192:193] op_sel:[0,1,0] op_sel_hi:[1,1,1]
    v_pk_fma_f32 v[194:195], v[46:47], v[184:185], v[194:195] op_sel:[0,1,0] op_sel_hi:[1,1,1]
    buffer_load_dwordx4 v1, s[52:55], s74 offen offset:3072 sc1 lds
    v_pk_mul_f32 v[196:197], v[188:189], v[188:189]
    v_pk_mul_f32 v[198:199], v[190:191], v[190:191]
    v_pk_mul_f32 v[200:201], v[192:193], v[192:193]
    v_pk_mul_f32 v[202:203], v[194:195], v[194:195]
    v_pk_fma_f32 v[196:197], v[196:197], v[22:23], v[22:23] op_sel:[0,1,0] op_sel_hi:[1,1,0]
    v_pk_fma_f32 v[198:199], v[198:199], v[22:23], v[22:23] op_sel:[0,1,0] op_sel_hi:[1,1,0]
    v_pk_fma_f32 v[200:201], v[200:201], v[22:23], v[22:23] op_sel:[0,1,0] op_sel_hi:[1,1,0]
    v_pk_fma_f32 v[202:203], v[202:203], v[22:23], v[22:23] op_sel:[0,1,0] op_sel_hi:[1,1,0]
    v_pk_mul_f32 v[196:197], v[196:197], v[188:189]
    v_pk_mul_f32 v[198:199], v[198:199], v[190:191]
    v_pk_mul_f32 v[200:201], v[200:201], v[192:193]
    v_pk_mul_f32 v[202:203], v[202:203], v[194:195]
    v_exp_f32 v196, v196
    v_exp_f32 v197, v197
    v_exp_f32 v198, v198
    v_exp_f32 v199, v199
    v_exp_f32 v200, v200
    v_exp_f32 v201, v201
    v_exp_f32 v202, v202
    v_exp_f32 v203, v203
    s_add_u32 m0, s77, 16384
    s_add_u32 s74, s75, 2310144
    buffer_load_dwordx4 v1, s[52:55], s74 offen sc1 lds
    v_pk_add_f32 v[196:197], v[196:197], 1.0 op_sel_hi:[1,0]
    v_pk_add_f32 v[198:199], v[198:199], 1.0 op_sel_hi:[1,0]
    v_pk_add_f32 v[200:201], v[200:201], 1.0 op_sel_hi:[1,0]
    v_pk_add_f32 v[202:203], v[202:203], 1.0 op_sel_hi:[1,0]
    v_rcp_f32 v196, v196
    v_rcp_f32 v197, v197
    v_rcp_f32 v198, v198
    v_rcp_f32 v199, v199
    v_rcp_f32 v200, v200
    v_rcp_f32 v201, v201
    v_rcp_f32 v202, v202
    v_rcp_f32 v203, v203
    buffer_load_dwordx4 v1, s[52:55], s74 offen offset:1024 sc1 lds
    v_pk_mul_f32 v[196:197], v[196:197], v[188:189]
    v_pk_mul_f32 v[198:199], v[198:199], v[190:191]
    v_pk_mul_f32 v[200:201], v[200:201], v[192:193]
    v_pk_mul_f32 v[202:203], v[202:203], v[194:195]
    v_cvt_pk_bf16_f32 v206, v196, v197
    v_cvt_pk_bf16_f32 v207, v198, v199
    v_cvt_pk_bf16_f32 v210, v200, v201
    v_cvt_pk_bf16_f32 v211, v202, v203
    buffer_store_dwordx4 v[204:207], v1, s[52:55], s69 offen offset:0 sc1
    buffer_store_dwordx4 v[208:211], v1, s[52:55], s69 offen offset:1024 sc1
    v_pk_fma_f32 v[188:189], v[160:161], v[186:187], v[164:165] op_sel:[0,0,0] op_sel_hi:[1,0,1]
    v_pk_fma_f32 v[190:191], v[162:163], v[186:187], v[166:167] op_sel:[0,0,0] op_sel_hi:[1,0,1]
    v_pk_fma_f32 v[192:193], v[160:161], v[186:187], v[164:165] op_sel:[0,1,0] op_sel_hi:[1,1,1]
    v_pk_fma_f32 v[194:195], v[162:163], v[186:187], v[166:167] op_sel:[0,1,0] op_sel_hi:[1,1,1]
    v_pk_fma_f32 v[188:189], v[32:33], v[184:185], v[188:189] op_sel:[0,0,0] op_sel_hi:[1,0,1]
    v_pk_fma_f32 v[190:191], v[34:35], v[184:185], v[190:191] op_sel:[0,0,0] op_sel_hi:[1,0,1]
    v_pk_fma_f32 v[192:193], v[48:49], v[184:185], v[192:193] op_sel:[0,1,0] op_sel_hi:[1,1,1]
    v_pk_fma_f32 v[194:195], v[50:51], v[184:185], v[194:195] op_sel:[0,1,0] op_sel_hi:[1,1,1]
    buffer_load_dwordx4 v1, s[52:55], s74 offen offset:2048 sc1 lds
    v_pk_mul_f32 v[196:197], v[188:189], v[188:189]
    v_pk_mul_f32 v[198:199], v[190:191], v[190:191]
    v_pk_mul_f32 v[200:201], v[192:193], v[192:193]
    v_pk_mul_f32 v[202:203], v[194:195], v[194:195]
    v_pk_fma_f32 v[196:197], v[196:197], v[22:23], v[22:23] op_sel:[0,1,0] op_sel_hi:[1,1,0]
    v_pk_fma_f32 v[198:199], v[198:199], v[22:23], v[22:23] op_sel:[0,1,0] op_sel_hi:[1,1,0]
    v_pk_fma_f32 v[200:201], v[200:201], v[22:23], v[22:23] op_sel:[0,1,0] op_sel_hi:[1,1,0]
    v_pk_fma_f32 v[202:203], v[202:203], v[22:23], v[22:23] op_sel:[0,1,0] op_sel_hi:[1,1,0]
    v_pk_mul_f32 v[196:197], v[196:197], v[188:189]
    v_pk_mul_f32 v[198:199], v[198:199], v[190:191]
    v_pk_mul_f32 v[200:201], v[200:201], v[192:193]
    v_pk_mul_f32 v[202:203], v[202:203], v[194:195]
    v_exp_f32 v196, v196
    v_exp_f32 v197, v197
    v_exp_f32 v198, v198
    v_exp_f32 v199, v199
    v_exp_f32 v200, v200
    v_exp_f32 v201, v201
    v_exp_f32 v202, v202
    v_exp_f32 v203, v203
    buffer_load_dwordx4 v1, s[52:55], s74 offen offset:3072 sc1 lds
    v_pk_add_f32 v[196:197], v[196:197], 1.0 op_sel_hi:[1,0]
    v_pk_add_f32 v[198:199], v[198:199], 1.0 op_sel_hi:[1,0]
    v_pk_add_f32 v[200:201], v[200:201], 1.0 op_sel_hi:[1,0]
    v_pk_add_f32 v[202:203], v[202:203], 1.0 op_sel_hi:[1,0]
    v_rcp_f32 v196, v196
    v_rcp_f32 v197, v197
    v_rcp_f32 v198, v198
    v_rcp_f32 v199, v199
    v_rcp_f32 v200, v200
    v_rcp_f32 v201, v201
    v_rcp_f32 v202, v202
    v_rcp_f32 v203, v203
    s_add_u32 m0, s77, 32768
    s_add_u32 s74, s75, 2326528
    buffer_load_dwordx4 v1, s[52:55], s74 offen sc1 lds
    v_pk_mul_f32 v[196:197], v[196:197], v[188:189]
    v_pk_mul_f32 v[198:199], v[198:199], v[190:191]
    v_pk_mul_f32 v[200:201], v[200:201], v[192:193]
    v_pk_mul_f32 v[202:203], v[202:203], v[194:195]
    v_cvt_pk_bf16_f32 v212, v196, v197
    v_cvt_pk_bf16_f32 v213, v198, v199
    v_cvt_pk_bf16_f32 v216, v200, v201
    v_cvt_pk_bf16_f32 v217, v202, v203
    v_pk_fma_f32 v[188:189], v[168:169], v[186:187], v[172:173] op_sel:[0,0,0] op_sel_hi:[1,0,1]
    v_pk_fma_f32 v[190:191], v[170:171], v[186:187], v[174:175] op_sel:[0,0,0] op_sel_hi:[1,0,1]
    v_pk_fma_f32 v[192:193], v[168:169], v[186:187], v[172:173] op_sel:[0,1,0] op_sel_hi:[1,1,1]
    v_pk_fma_f32 v[194:195], v[170:171], v[186:187], v[174:175] op_sel:[0,1,0] op_sel_hi:[1,1,1]
    v_pk_fma_f32 v[188:189], v[36:37], v[184:185], v[188:189] op_sel:[0,0,0] op_sel_hi:[1,0,1]
    v_pk_fma_f32 v[190:191], v[38:39], v[184:185], v[190:191] op_sel:[0,0,0] op_sel_hi:[1,0,1]
    v_pk_fma_f32 v[192:193], v[52:53], v[184:185], v[192:193] op_sel:[0,1,0] op_sel_hi:[1,1,1]
    v_pk_fma_f32 v[194:195], v[54:55], v[184:185], v[194:195] op_sel:[0,1,0] op_sel_hi:[1,1,1]
    buffer_load_dwordx4 v1, s[52:55], s74 offen offset:1024 sc1 lds
    v_pk_mul_f32 v[196:197], v[188:189], v[188:189]
    v_pk_mul_f32 v[198:199], v[190:191], v[190:191]
    v_pk_mul_f32 v[200:201], v[192:193], v[192:193]
    v_pk_mul_f32 v[202:203], v[194:195], v[194:195]
    v_pk_fma_f32 v[196:197], v[196:197], v[22:23], v[22:23] op_sel:[0,1,0] op_sel_hi:[1,1,0]
    v_pk_fma_f32 v[198:199], v[198:199], v[22:23], v[22:23] op_sel:[0,1,0] op_sel_hi:[1,1,0]
    v_pk_fma_f32 v[200:201], v[200:201], v[22:23], v[22:23] op_sel:[0,1,0] op_sel_hi:[1,1,0]
    v_pk_fma_f32 v[202:203], v[202:203], v[22:23], v[22:23] op_sel:[0,1,0] op_sel_hi:[1,1,0]
    v_pk_mul_f32 v[196:197], v[196:197], v[188:189]
    v_pk_mul_f32 v[198:199], v[198:199], v[190:191]
    v_pk_mul_f32 v[200:201], v[200:201], v[192:193]
    v_pk_mul_f32 v[202:203], v[202:203], v[194:195]
    s_waitcnt vmcnt(12)
    s_barrier
    v_exp_f32 v196, v196
    v_exp_f32 v197, v197
    v_exp_f32 v198, v198
    v_exp_f32 v199, v199
    v_exp_f32 v200, v200
    v_exp_f32 v201, v201
    v_exp_f32 v202, v202
    v_exp_f32 v203, v203
    v_pk_add_f32 v[196:197], v[196:197], 1.0 op_sel_hi:[1,0]
    v_pk_add_f32 v[198:199], v[198:199], 1.0 op_sel_hi:[1,0]
    v_pk_add_f32 v[200:201], v[200:201], 1.0 op_sel_hi:[1,0]
    v_pk_add_f32 v[202:203], v[202:203], 1.0 op_sel_hi:[1,0]
    v_rcp_f32 v196, v196
    v_rcp_f32 v197, v197
    v_rcp_f32 v198, v198
    v_rcp_f32 v199, v199
    v_rcp_f32 v200, v200
    v_rcp_f32 v201, v201
    v_rcp_f32 v202, v202
    v_rcp_f32 v203, v203
    ds_read_b128 v[64:67], v15 offset:0
    ds_read_b128 v[68:71], v15 offset:1024
    ds_read_b128 v[72:75], v15 offset:2048
    ds_read_b128 v[76:79], v15 offset:3072
    ds_read_b128 v[80:83], v15 offset:4096
    ds_read_b128 v[84:87], v15 offset:5120
    ds_read_b128 v[88:91], v15 offset:6144
    ds_read_b128 v[92:95], v15 offset:7168
    ds_read_b128 v[96:99], v15 offset:8192
    v_pk_mul_f32 v[196:197], v[196:197], v[188:189]
    v_pk_mul_f32 v[198:199], v[198:199], v[190:191]
    v_pk_mul_f32 v[200:201], v[200:201], v[192:193]
    v_pk_mul_f32 v[202:203], v[202:203], v[194:195]
    v_cvt_pk_bf16_f32 v214, v196, v197
    v_cvt_pk_bf16_f32 v215, v198, v199
    v_cvt_pk_bf16_f32 v218, v200, v201
    v_cvt_pk_bf16_f32 v219, v202, v203
    v_cndmask_b32 v214, v214, 0, s[84:85]
    v_cndmask_b32 v215, v215, 0, s[84:85]
    v_cndmask_b32 v218, v218, 0, s[84:85]
    v_cndmask_b32 v219, v219, 0, s[84:85]
    buffer_store_dwordx4 v[212:215], v1, s[52:55], s69 offen offset:2048 sc1
    buffer_store_dwordx4 v[216:219], v1, s[52:55], s69 offen offset:3072 sc1
    s_waitcnt lgkmcnt(6)
    v_mfma_f32_16x16x32_bf16 v[24:27], v[64:67], a[0:3], 0
    ds_read_b128 v[100:103], v15 offset:9216
L_pad_m1_0:
    s_cbranch_execz L_pad_m1_1
    v_mfma_f32_16x16x32_bf16 v[36:39], v[64:67], a[4:7], 0
    ds_read_b128 v[144:147], v20 offset:0
    v_mfma_f32_16x16x32_bf16 v[28:31], v[68:71], a[0:3], 0
    ds_read_b128 v[104:107], v15 offset:10240
    v_mfma_f32_16x16x32_bf16 v[40:43], v[68:71], a[4:7], 0
    buffer_load_dwordx4 v1, s[52:55], s74 offen offset:2048 sc1 lds
    v_mfma_f32_16x16x32_bf16 v[32:35], v[72:75], a[0:3], 0
    ds_read_b128 v[108:111], v15 offset:11264
    v_mfma_f32_16x16x32_bf16 v[44:47], v[72:75], a[4:7], 0
    s_waitcnt lgkmcnt(7)
    v_mfma_f32_16x16x32_bf16 v[24:27], v[76:79], a[8:11], v[24:27]
    ds_read_b128 v[64:67], v15 offset:12288
    v_mfma_f32_16x16x32_bf16 v[36:39], v[76:79], a[12:15], v[36:39]
    ds_read_b128 v[148:151], v20 offset:512
    v_mfma_f32_16x16x32_bf16 v[28:31], v[80:83], a[8:11], v[28:31]
    ds_read_b128 v[68:71], v15 offset:13312
    v_mfma_f32_16x16x32_bf16 v[40:43], v[80:83], a[12:15], v[40:43]
    buffer_load_dwordx4 v1, s[52:55], s74 offen offset:3072 sc1 lds
    v_mfma_f32_16x16x32_bf16 v[32:35], v[84:87], a[8:11], v[32:35]
    ds_read_b128 v[72:75], v15 offset:14336
    v_mfma_f32_16x16x32_bf16 v[44:47], v[84:87], a[12:15], v[44:47]
    s_add_u32 m0, s77, 49152
    s_add_u32 s74, s75, 2342912
    buffer_load_dwordx4 v1, s[52:55], s74 offen sc1 lds
    s_waitcnt lgkmcnt(8)
    v_mfma_f32_16x16x32_bf16 v[24:27], v[88:91], a[16:19], v[24:27]
    ds_read_b128 v[76:79], v15 offset:15360
    v_mfma_f32_16x16x32_bf16 v[36:39], v[88:91], a[20:23], v[36:39]
    ds_read_b128 v[152:155], v20 offset:64
    v_mfma_f32_16x16x32_bf16 v[28:31], v[92:95], a[16:19], v[28:31]
    ds_read_b128 v[80:83], v15 offset:16384
    v_mfma_f32_16x16x32_bf16 v[40:43], v[92:95], a[20:23], v[40:43]
    buffer_load_dwordx4 v1, s[52:55], s74 offen offset:1024 sc1 lds
    v_mfma_f32_16x16x32_bf16 v[32:35], v[96:99], a[16:19], v[32:35]
    ds_read_b128 v[84:87], v15 offset:17408
    v_mfma_f32_16x16x32_bf16 v[44:47], v[96:99], a[20:23], v[44:47]
    s_waitcnt lgkmcnt(8)
    v_mfma_f32_16x16x32_bf16 v[24:27], v[100:103], a[24:27], v[24:27]
    ds_read_b128 v[88:91], v15 offset:18432
    v_mfma_f32_16x16x32_bf16 v[36:39], v[100:103], a[28:31], v[36:39]
    ds_read_b128 v[156:159], v20 offset:576
    v_mfma_f32_16x16x32_bf16 v[28:31], v[104:107], a[24:27], v[28:31]
    ds_read_b128 v[92:95], v15 offset:19456
    v_mfma_f32_16x16x32_bf16 v[40:43], v[104:107], a[28:31], v[40:43]
    buffer_load_dwordx4 v1, s[52:55], s74 offen offset:2048 sc1 lds
    v_mfma_f32_16x16x32_bf16 v[32:35], v[108:111], a[24:27], v[32:35]
    ds_read_b128 v[96:99], v15 offset:20480
    v_mfma_f32_16x16x32_bf16 v[44:47], v[108:111], a[28:31], v[44:47]
    buffer_load_dwordx4 v1, s[52:55], s74 offen offset:3072 sc1 lds
    s_waitcnt lgkmcnt(8)
    v_mfma_f32_16x16x32_bf16 v[24:27], v[64:67], a[32:35], v[24:27]
    ds_read_b128 v[100:103], v15 offset:21504
    v_mfma_f32_16x16x32_bf16 v[36:39], v[64:67], a[36:39], v[36:39]
    ds_read_b128 v[160:163], v20 offset:128
    v_mfma_f32_16x16x32_bf16 v[28:31], v[68:71], a[32:35], v[28:31]
    ds_read_b128 v[104:107], v15 offset:22528
    v_mfma_f32_16x16x32_bf16 v[40:43], v[68:71], a[36:39], v[40:43]
    s_add_u32 m0, s77, 65536
    s_add_u32 s74, s75, 2359296
    buffer_load_dwordx4 v1, s[52:55], s74 offen sc1 lds
    v_mfma_f32_16x16x32_bf16 v[32:35], v[72:75], a[32:35], v[32:35]
    ds_read_b128 v[108:111], v15 offset:23552
    v_mfma_f32_16x16x32_bf16 v[44:47], v[72:75], a[36:39], v[44:47]
    s_waitcnt lgkmcnt(8)
    v_mfma_f32_16x16x32_bf16 v[24:27], v[76:79], a[40:43], v[24:27]
    ds_read_b128 v[64:67], v15 offset:24576
    v_mfma_f32_16x16x32_bf16 v[36:39], v[76:79], a[44:47], v[36:39]
    ds_read_b128 v[164:167], v20 offset:640
    v_mfma_f32_16x16x32_bf16 v[28:31], v[80:83], a[40:43], v[28:31]
    ds_read_b128 v[68:71], v15 offset:25600
    v_mfma_f32_16x16x32_bf16 v[40:43], v[80:83], a[44:47], v[40:43]
    buffer_load_dwordx4 v1, s[52:55], s74 offen offset:1024 sc1 lds
    v_mfma_f32_16x16x32_bf16 v[32:35], v[84:87], a[40:43], v[32:35]
    ds_read_b128 v[72:75], v15 offset:26624
    v_mfma_f32_16x16x32_bf16 v[44:47], v[84:87], a[44:47], v[44:47]
    buffer_load_dwordx4 v1, s[52:55], s74 offen offset:2048 sc1 lds
    s_waitcnt lgkmcnt(8)
    v_mfma_f32_16x16x32_bf16 v[24:27], v[88:91], a[48:51], v[24:27]
    ds_read_b128 v[76:79], v15 offset:27648
    v_mfma_f32_16x16x32_bf16 v[36:39], v[88:91], a[52:55], v[36:39]
    v_mfma_f32_16x16x32_bf16 v[28:31], v[92:95], a[48:51], v[28:31]
    ds_read_b128 v[80:83], v15 offset:28672
    v_mfma_f32_16x16x32_bf16 v[40:43], v[92:95], a[52:55], v[40:43]
    buffer_load_dwordx4 v1, s[52:55], s74 offen offset:3072 sc1 lds
    v_mfma_f32_16x16x32_bf16 v[32:35], v[96:99], a[48:51], v[32:35]
    ds_read_b128 v[84:87], v15 offset:29696
    v_mfma_f32_16x16x32_bf16 v[44:47], v[96:99], a[52:55], v[44:47]
    s_waitcnt lgkmcnt(7)
    v_mfma_f32_16x16x32_bf16 v[24:27], v[100:103], a[56:59], v[24:27]
    ds_read_b128 v[88:91], v15 offset:30720
    v_mfma_f32_16x16x32_bf16 v[36:39], v[100:103], a[60:63], v[36:39]
    v_mfma_f32_16x16x32_bf16 v[28:31], v[104:107], a[56:59], v[28:31]
    ds_read_b128 v[92:95], v15 offset:31744
    v_mfma_f32_16x16x32_bf16 v[40:43], v[104:107], a[60:63], v[40:43]
    v_mfma_f32_16x16x32_bf16 v[32:35], v[108:111], a[56:59], v[32:35]
    ds_read_b128 v[96:99], v15 offset:32768
    v_mfma_f32_16x16x32_bf16 v[44:47], v[108:111], a[60:63], v[44:47]
    s_waitcnt lgkmcnt(6)
    v_mfma_f32_16x16x32_bf16 v[24:27], v[64:67], a[64:67], v[24:27]
    ds_read_b128 v[100:103], v15 offset:33792
    s_barrier
    v_mfma_f32_16x16x32_bf16 v[36:39], v[64:67], a[68:71], v[36:39]
    v_mfma_f32_16x16x32_bf16 v[28:31], v[68:71], a[64:67], v[28:31]
    ds_read_b128 v[104:107], v15 offset:34816
    v_mfma_f32_16x16x32_bf16 v[40:43], v[68:71], a[68:71], v[40:43]
    s_add_u32 m0, s63, 81920
    s_add_u32 s74, s62, 2375680
    buffer_load_dwordx4 v1, s[52:55], s74 offen sc1 lds
    v_mfma_f32_16x16x32_bf16 v[32:35], v[72:75], a[64:67], v[32:35]
    ds_read_b128 v[108:111], v15 offset:35840
    v_mfma_f32_16x16x32_bf16 v[44:47], v[72:75], a[68:71], v[44:47]
    s_waitcnt lgkmcnt(6)
    v_mfma_f32_16x16x32_bf16 v[24:27], v[76:79], a[72:75], v[24:27]
    ds_read_b128 v[64:67], v15 offset:36864
    v_mfma_f32_16x16x32_bf16 v[36:39], v[76:79], a[76:79], v[36:39]
    s_waitcnt vmcnt(11)
    buffer_store_dword v226, v227, s[52:55], s0 offen
    v_mfma_f32_16x16x32_bf16 v[28:31], v[80:83], a[72:75], v[28:31]
    ds_read_b128 v[68:71], v15 offset:37888
    v_mfma_f32_16x16x32_bf16 v[40:43], v[80:83], a[76:79], v[40:43]
    s_add_u32 m0, s63, 86016
    s_add_u32 s74, s62, 2379776
    buffer_load_dwordx4 v1, s[52:55], s74 offen sc1 lds
    v_mfma_f32_16x16x32_bf16 v[32:35], v[84:87], a[72:75], v[32:35]
    ds_read_b128 v[72:75], v15 offset:38912
    v_mfma_f32_16x16x32_bf16 v[44:47], v[84:87], a[76:79], v[44:47]
    s_waitcnt lgkmcnt(6)
    v_mfma_f32_16x16x32_bf16 v[24:27], v[88:91], a[80:83], v[24:27]
    ds_read_b128 v[76:79], v15 offset:39936
    v_mfma_f32_16x16x32_bf16 v[36:39], v[88:91], a[84:87], v[36:39]
    v_mfma_f32_16x16x32_bf16 v[28:31], v[92:95], a[80:83], v[28:31]
    ds_read_b128 v[80:83], v15 offset:40960
    v_mfma_f32_16x16x32_bf16 v[40:43], v[92:95], a[84:87], v[40:43]
    s_add_u32 m0, s63, 90112
    s_add_u32 s74, s62, 2383872
    buffer_load_dwordx4 v1, s[52:55], s74 offen sc1 lds
    v_mfma_f32_16x16x32_bf16 v[32:35], v[96:99], a[80:83], v[32:35]
    ds_read_b128 v[84:87], v15 offset:41984
    v_mfma_f32_16x16x32_bf16 v[44:47], v[96:99], a[84:87], v[44:47]
    s_waitcnt lgkmcnt(6)
    v_mfma_f32_16x16x32_bf16 v[24:27], v[100:103], a[88:91], v[24:27]
    ds_read_b128 v[88:91], v15 offset:43008
    v_mfma_f32_16x16x32_bf16 v[36:39], v[100:103], a[92:95], v[36:39]
    v_mfma_f32_16x16x32_bf16 v[28:31], v[104:107], a[88:91], v[28:31]
    ds_read_b128 v[92:95], v15 offset:44032
    v_mfma_f32_16x16x32_bf16 v[40:43], v[104:107], a[92:95], v[40:43]
    s_add_u32 m0, s63, 94208
    s_add_u32 s74, s62, 2387968
    buffer_load_dwordx4 v1, s[52:55], s74 offen sc1 lds
    v_mfma_f32_16x16x32_bf16 v[32:35], v[108:111], a[88:91], v[32:35]
    ds_read_b128 v[96:99], v15 offset:45056
    v_mfma_f32_16x16x32_bf16 v[44:47], v[108:111], a[92:95], v[44:47]
    s_waitcnt lgkmcnt(6)
    v_mfma_f32_16x16x32_bf16 v[24:27], v[64:67], a[96:99], v[24:27]
    ds_read_b128 v[100:103], v15 offset:46080
    v_mfma_f32_16x16x32_bf16 v[36:39], v[64:67], a[100:103], v[36:39]
    v_mfma_f32_16x16x32_bf16 v[28:31], v[68:71], a[96:99], v[28:31]
    ds_read_b128 v[104:107], v15 offset:47104
    v_mfma_f32_16x16x32_bf16 v[40:43], v[68:71], a[100:103], v[40:43]
    s_add_u32 m0, s63, 98304
    s_add_u32 s74, s62, 2392064
    buffer_load_dwordx4 v1, s[52:55], s74 offen sc1 lds
    v_mfma_f32_16x16x32_bf16 v[32:35], v[72:75], a[96:99], v[32:35]
    ds_read_b128 v[108:111], v15 offset:48128
    v_mfma_f32_16x16x32_bf16 v[44:47], v[72:75], a[100:103], v[44:47]
    s_waitcnt lgkmcnt(6)
    v_mfma_f32_16x16x32_bf16 v[24:27], v[76:79], a[104:107], v[24:27]
    ds_read_b128 v[64:67], v15 offset:49152
    v_mfma_f32_16x16x32_bf16 v[36:39], v[76:79], a[108:111], v[36:39]
    v_mfma_f32_16x16x32_bf16 v[28:31], v[80:83], a[104:107], v[28:31]
    ds_read_b128 v[68:71], v15 offset:50176
    v_mfma_f32_16x16x32_bf16 v[40:43], v[80:83], a[108:111], v[40:43]
    s_add_u32 m0, s63, 102400
    s_add_u32 s74, s62, 2396160
    buffer_load_dwordx4 v1, s[52:55], s74 offen sc1 lds
    v_mfma_f32_16x16x32_bf16 v[32:35], v[84:87], a[104:107], v[32:35]
    ds_read_b128 v[72:75], v15 offset:51200
    v_mfma_f32_16x16x32_bf16 v[44:47], v[84:87], a[108:111], v[44:47]
    s_waitcnt lgkmcnt(6)
    v_mfma_f32_16x16x32_bf16 v[24:27], v[88:91], a[112:115], v[24:27]
    ds_read_b128 v[76:79], v15 offset:52224
    v_mfma_f32_16x16x32_bf16 v[36:39], v[88:91], a[116:119], v[36:39]
    v_mfma_f32_16x16x32_bf16 v[28:31], v[92:95], a[112:115], v[28:31]
    ds_read_b128 v[80:83], v15 offset:53248
    v_mfma_f32_16x16x32_bf16 v[40:43], v[92:95], a[116:119], v[40:43]
    v_mfma_f32_16x16x32_bf16 v[32:35], v[96:99], a[112:115], v[32:35]
    ds_read_b128 v[84:87], v15 offset:54272
    v_mfma_f32_16x16x32_bf16 v[44:47], v[96:99], a[116:119], v[44:47]
    s_waitcnt lgkmcnt(6)
    v_mfma_f32_16x16x32_bf16 v[24:27], v[100:103], a[120:123], v[24:27]
    ds_read_b128 v[88:91], v15 offset:55296
    s_barrier
    v_mfma_f32_16x16x32_bf16 v[36:39], v[100:103], a[124:127], v[36:39]
    v_mfma_f32_16x16x32_bf16 v[28:31], v[104:107], a[120:123], v[28:31]
    ds_read_b128 v[92:95], v15 offset:56320
    v_mfma_f32_16x16x32_bf16 v[40:43], v[104:107], a[124:127], v[40:43]
    s_add_u32 m0, s63, 106496
    s_add_u32 s74, s62, 2400256
    buffer_load_dwordx4 v1, s[52:55], s74 offen sc1 lds
    v_mfma_f32_16x16x32_bf16 v[32:35], v[108:111], a[120:123], v[32:35]
    ds_read_b128 v[96:99], v15 offset:57344
    v_mfma_f32_16x16x32_bf16 v[44:47], v[108:111], a[124:127], v[44:47]
    s_waitcnt lgkmcnt(6)
    v_mfma_f32_16x16x32_bf16 v[24:27], v[64:67], a[128:131], v[24:27]
    ds_read_b128 v[100:103], v15 offset:58368
    v_mfma_f32_16x16x32_bf16 v[36:39], v[64:67], a[132:135], v[36:39]
    buffer_load_dword v2, v5, s[52:55], s1 offen sc1
    v_mfma_f32_16x16x32_bf16 v[28:31], v[68:71], a[128:131], v[28:31]
    ds_read_b128 v[104:107], v15 offset:59392
    v_mfma_f32_16x16x32_bf16 v[40:43], v[68:71], a[132:135], v[40:43]
    s_add_u32 m0, s63, 110592
    s_add_u32 s74, s62, 2404352
    buffer_load_dwordx4 v1, s[52:55], s74 offen sc1 lds
    v_mfma_f32_16x16x32_bf16 v[32:35], v[72:75], a[128:131], v[32:35]
    ds_read_b128 v[108:111], v15 offset:60416
    v_mfma_f32_16x16x32_bf16 v[44:47], v[72:75], a[132:135], v[44:47]
    s_waitcnt lgkmcnt(6)
    v_mfma_f32_16x16x32_bf16 v[24:27], v[76:79], a[136:139], v[24:27]
    v_mfma_f32_16x16x32_bf16 v[36:39], v[76:79], a[140:143], v[36:39]
    v_mfma_f32_16x16x32_bf16 v[28:31], v[80:83], a[136:139], v[28:31]
    v_mfma_f32_16x16x32_bf16 v[40:43], v[80:83], a[140:143], v[40:43]
    s_add_u32 m0, s63, 114688
    s_add_u32 s74, s62, 2408448
    buffer_load_dwordx4 v1, s[52:55], s74 offen sc1 lds
    v_mfma_f32_16x16x32_bf16 v[32:35], v[84:87], a[136:139], v[32:35]
    v_mfma_f32_16x16x32_bf16 v[44:47], v[84:87], a[140:143], v[44:47]
    s_waitcnt lgkmcnt(3)
    v_mfma_f32_16x16x32_bf16 v[24:27], v[88:91], a[144:147], v[24:27]
    v_mfma_f32_16x16x32_bf16 v[36:39], v[88:91], a[148:151], v[36:39]
    v_mfma_f32_16x16x32_bf16 v[28:31], v[92:95], a[144:147], v[28:31]
    v_mfma_f32_16x16x32_bf16 v[40:43], v[92:95], a[148:151], v[40:43]
    s_add_u32 m0, s63, 118784
    s_add_u32 s74, s62, 2412544
    buffer_load_dwordx4 v1, s[52:55], s74 offen sc1 lds
    v_mfma_f32_16x16x32_bf16 v[32:35], v[96:99], a[144:147], v[32:35]
    v_mfma_f32_16x16x32_bf16 v[44:47], v[96:99], a[148:151], v[44:47]
    s_waitcnt lgkmcnt(0)
    v_mfma_f32_16x16x32_bf16 v[24:27], v[100:103], a[152:155], v[24:27]
    s_waitcnt vmcnt(12)
    s_barrier
    v_mfma_f32_16x16x32_bf16 v[36:39], v[100:103], a[156:159], v[36:39]
    v_mfma_f32_16x16x32_bf16 v[28:31], v[104:107], a[152:155], v[28:31]
    v_mfma_f32_16x16x32_bf16 v[40:43], v[104:107], a[156:159], v[40:43]
    s_add_u32 m0, s63, 122880
    s_add_u32 s74, s62, 2416640
    buffer_load_dwordx4 v1, s[52:55], s74 offen sc1 lds
    v_mfma_f32_16x16x32_bf16 v[32:35], v[108:111], a[152:155], v[32:35]
    v_mfma_f32_16x16x32_bf16 v[44:47], v[108:111], a[156:159], v[44:47]
    v_pk_fma_f32 v[188:189], v[144:145], v[186:187], v[148:149] op_sel:[0,0,0] op_sel_hi:[1,0,1]
    v_pk_fma_f32 v[190:191], v[146:147], v[186:187], v[150:151] op_sel:[0,0,0] op_sel_hi:[1,0,1]
    v_pk_fma_f32 v[192:193], v[144:145], v[186:187], v[148:149] op_sel:[0,1,0] op_sel_hi:[1,1,1]
    v_pk_fma_f32 v[194:195], v[146:147], v[186:187], v[150:151] op_sel:[0,1,0] op_sel_hi:[1,1,1]
    v_pk_fma_f32 v[188:189], v[24:25], v[184:185], v[188:189] op_sel:[0,0,0] op_sel_hi:[1,0,1]
    v_pk_fma_f32 v[190:191], v[26:27], v[184:185], v[190:191] op_sel:[0,0,0] op_sel_hi:[1,0,1]
    v_pk_fma_f32 v[192:193], v[36:37], v[184:185], v[192:193] op_sel:[0,1,0] op_sel_hi:[1,1,1]
    v_pk_fma_f32 v[194:195], v[38:39], v[184:185], v[194:195] op_sel:[0,1,0] op_sel_hi:[1,1,1]
    s_add_u32 m0, s63, 126976
    s_add_u32 s74, s62, 2420736
    buffer_load_dwordx4 v1, s[52:55], s74 offen sc1 lds
    v_pk_mul_f32 v[196:197], v[188:189], v[188:189]
    v_pk_mul_f32 v[198:199], v[190:191], v[190:191]
    v_pk_mul_f32 v[200:201], v[192:193], v[192:193]
    v_pk_mul_f32 v[202:203], v[194:195], v[194:195]
    v_pk_fma_f32 v[196:197], v[196:197], v[22:23], v[22:23] op_sel:[0,1,0] op_sel_hi:[1,1,0]
    v_pk_fma_f32 v[198:199], v[198:199], v[22:23], v[22:23] op_sel:[0,1,0] op_sel_hi:[1,1,0]
    v_pk_fma_f32 v[200:201], v[200:201], v[22:23], v[22:23] op_sel:[0,1,0] op_sel_hi:[1,1,0]
    v_pk_fma_f32 v[202:203], v[202:203], v[22:23], v[22:23] op_sel:[0,1,0] op_sel_hi:[1,1,0]
    v_pk_mul_f32 v[196:197], v[196:197], v[188:189]
    v_pk_mul_f32 v[198:199], v[198:199], v[190:191]
    v_pk_mul_f32 v[200:201], v[200:201], v[192:193]
    v_pk_mul_f32 v[202:203], v[202:203], v[194:195]
    s_waitcnt vmcnt(5)
    v_cmp_eq_u32 s[90:91], s6, v2
    s_nop 0
    s_cmp_eq_u64 s[90:91], -1
    s_cbranch_scc0 L_pollf78
L_polld76:
    s_or_b32 s1, s1, 64
    buffer_load_dwordx4 a[0:3], v254, s[52:55], s12 offen offset:0 sc1
    buffer_load_dwordx4 a[4:7], v254, s[52:55], s12 offen offset:1024 sc1
    buffer_load_dwordx4 a[8:11], v254, s[52:55], s12 offen offset:2048 sc1
    buffer_load_dwordx4 a[12:15], v254, s[52:55], s12 offen offset:3072 sc1
    v_exp_f32 v196, v196
    v_exp_f32 v197, v197
    v_exp_f32 v198, v198
    v_exp_f32 v199, v199
    v_exp_f32 v200, v200
    v_exp_f32 v201, v201
    v_exp_f32 v202, v202
    v_exp_f32_e64 v203, v203
    buffer_load_dwordx4 a[16:19], v254, s[52:55], s13 offen offset:0 sc1
    v_pk_add_f32 v[196:197], v[196:197], 1.0 op_sel_hi:[1,0]
    v_pk_add_f32 v[198:199], v[198:199], 1.0 op_sel_hi:[1,0]
    v_pk_add_f32 v[200:201], v[200:201], 1.0 op_sel_hi:[1,0]
    v_pk_add_f32 v[202:203], v[202:203], 1.0 op_sel_hi:[1,0]
    v_rcp_f32 v196, v196
    v_rcp_f32 v197, v197
    v_rcp_f32 v198, v198
    v_rcp_f32 v199, v199
    v_rcp_f32 v200, v200
    v_rcp_f32 v201, v201
    v_rcp_f32 v202, v202
    v_rcp_f32 v203, v203
    buffer_load_dwordx4 a[20:23], v254, s[52:55], s13 offen offset:1024 sc1
    v_pk_mul_f32 v[196:197], v[196:197], v[188:189]
    v_pk_mul_f32 v[198:199], v[198:199], v[190:191]
    v_pk_mul_f32 v[200:201], v[200:201], v[192:193]
    v_pk_mul_f32 v[202:203], v[202:203], v[194:195]
    v_cvt_pk_bf16_f32 v168, v196, v197
    v_cvt_pk_bf16_f32 v169, v198, v199
    v_cvt_pk_bf16_f32 v172, v200, v201
    v_cvt_pk_bf16_f32 v173, v202, v203
    v_pk_fma_f32 v[188:189], v[152:153], v[186:187], v[156:157] op_sel:[0,0,0] op_sel_hi:[1,0,1]
    v_pk_fma_f32 v[190:191], v[154:155], v[186:187], v[158:159] op_sel:[0,0,0] op_sel_hi:[1,0,1]
    v_pk_fma_f32 v[192:193], v[152:153], v[186:187], v[156:157] op_sel:[0,1,0] op_sel_hi:[1,1,1]
    v_pk_fma_f32 v[194:195], v[154:155], v[186:187], v[158:159] op_sel:[0,1,0] op_sel_hi:[1,1,1]
    v_pk_fma_f32 v[188:189], v[28:29], v[184:185], v[188:189] op_sel:[0,0,0] op_sel_hi:[1,0,1]
    v_pk_fma_f32 v[190:191], v[30:31], v[184:185], v[190:191] op_sel:[0,0,0] op_sel_hi:[1,0,1]
    v_pk_fma_f32 v[192:193], v[40:41], v[184:185], v[192:193] op_sel:[0,1,0] op_sel_hi:[1,1,1]
    v_pk_fma_f32 v[194:195], v[42:43], v[184:185], v[194:195] op_sel:[0,1,0] op_sel_hi:[1,1,1]
    s_add_u32 m0, s63, 131072
    s_add_u32 s74, s62, 2424832
    buffer_load_dwordx4 v1, s[52:55], s74 offen sc1 lds
    v_pk_mul_f32 v[196:197], v[188:189], v[188:189]
    v_pk_mul_f32 v[198:199], v[190:191], v[190:191]
    v_pk_mul_f32 v[200:201], v[192:193], v[192:193]
    v_pk_mul_f32 v[202:203], v[194:195], v[194:195]
    v_pk_fma_f32 v[196:197], v[196:197], v[22:23], v[22:23] op_sel:[0,1,0] op_sel_hi:[1,1,0]
    v_pk_fma_f32 v[198:199], v[198:199], v[22:23], v[22:23] op_sel:[0,1,0] op_sel_hi:[1,1,0]
    v_pk_fma_f32 v[200:201], v[200:201], v[22:23], v[22:23] op_sel:[0,1,0] op_sel_hi:[1,1,0]
    v_pk_fma_f32 v[202:203], v[202:203], v[22:23], v[22:23] op_sel:[0,1,0] op_sel_hi:[1,1,0]
    v_pk_mul_f32 v[196:197], v[196:197], v[188:189]
    v_pk_mul_f32 v[198:199], v[198:199], v[190:191]
    v_pk_mul_f32 v[200:201], v[200:201], v[192:193]
    v_pk_mul_f32 v[202:203], v[202:203], v[194:195]
    s_add_u32 m0, s63, 135168
    s_add_u32 s74, s62, 2428928
    buffer_load_dwordx4 v1, s[52:55], s74 offen sc1 lds
    v_exp_f32 v196, v196
    v_exp_f32 v197, v197
    v_exp_f32 v198, v198
    v_exp_f32 v199, v199
    v_exp_f32 v200, v200
    v_exp_f32 v201, v201
    v_exp_f32 v202, v202
    v_exp_f32 v203, v203
    s_add_u32 m0, s63, 139264
    s_add_u32 s74, s62, 2433024
    buffer_load_dwordx4 v1, s[52:55], s74 offen sc1 lds
    v_pk_add_f32 v[196:197], v[196:197], 1.0 op_sel_hi:[1,0]
    v_pk_add_f32 v[198:199], v[198:199], 1.0 op_sel_hi:[1,0]
    v_pk_add_f32 v[200:201], v[200:201], 1.0 op_sel_hi:[1,0]
    v_pk_add_f32 v[202:203], v[202:203], 1.0 op_sel_hi:[1,0]
    v_rcp_f32 v196, v196
    v_rcp_f32 v197, v197
    v_rcp_f32 v198, v198
    v_rcp_f32 v199, v199
    v_rcp_f32 v200, v200
    v_rcp_f32 v201, v201
    v_rcp_f32 v202, v202
    v_rcp_f32 v203, v203
    buffer_load_dwordx4 a[24:27], v254, s[52:55], s13 offen offset:2048 sc1
    v_pk_mul_f32 v[196:197], v[196:197], v[188:189]
    v_pk_mul_f32 v[198:199], v[198:199], v[190:191]
    v_pk_mul_f32 v[200:201], v[200:201], v[192:193]
    v_pk_mul_f32 v[202:203], v[202:203], v[194:195]
    v_cvt_pk_bf16_f32 v170, v196, v197
    v_cvt_pk_bf16_f32 v171, v198, v199
    v_cvt_pk_bf16_f32 v174, v200, v201
    v_cvt_pk_bf16_f32 v175, v202, v203
    buffer_store_dwordx4 v[168:171], v1, s[52:55], s76 offen offset:0 sc1
    buffer_store_dwordx4 v[172:175], v1, s[52:55], s76 offen offset:1024 sc1
    v_pk_fma_f32 v[188:189], v[160:161], v[186:187], v[164:165] op_sel:[0,0,0] op_sel_hi:[1,0,1]
    v_pk_fma_f32 v[190:191], v[162:163], v[186:187], v[166:167] op_sel:[0,0,0] op_sel_hi:[1,0,1]
    v_pk_fma_f32 v[192:193], v[160:161], v[186:187], v[164:165] op_sel:[0,1,0] op_sel_hi:[1,1,1]
    v_pk_fma_f32 v[194:195], v[162:163], v[186:187], v[166:167] op_sel:[0,1,0] op_sel_hi:[1,1,1]
    v_pk_fma_f32 v[188:189], v[32:33], v[184:185], v[188:189] op_sel:[0,0,0] op_sel_hi:[1,0,1]
    v_pk_fma_f32 v[190:191], v[34:35], v[184:185], v[190:191] op_sel:[0,0,0] op_sel_hi:[1,0,1]
    v_pk_fma_f32 v[192:193], v[44:45], v[184:185], v[192:193] op_sel:[0,1,0] op_sel_hi:[1,1,1]
    v_pk_fma_f32 v[194:195], v[46:47], v[184:185], v[194:195] op_sel:[0,1,0] op_sel_hi:[1,1,1]
    buffer_load_dwordx4 a[28:31], v254, s[52:55], s13 offen offset:3072 sc1
    v_pk_mul_f32 v[196:197], v[188:189], v[188:189]
    v_pk_mul_f32 v[198:199], v[190:191], v[190:191]
    v_pk_mul_f32 v[200:201], v[192:193], v[192:193]
    v_pk_mul_f32 v[202:203], v[194:195], v[194:195]
    v_pk_fma_f32 v[196:197], v[196:197], v[22:23], v[22:23] op_sel:[0,1,0] op_sel_hi:[1,1,0]
    v_pk_fma_f32 v[198:199], v[198:199], v[22:23], v[22:23] op_sel:[0,1,0] op_sel_hi:[1,1,0]
    v_pk_fma_f32 v[200:201], v[200:201], v[22:23], v[22:23] op_sel:[0,1,0] op_sel_hi:[1,1,0]
    v_pk_fma_f32 v[202:203], v[202:203], v[22:23], v[22:23] op_sel:[0,1,0] op_sel_hi:[1,1,0]
    v_pk_mul_f32 v[196:197], v[196:197], v[188:189]
    v_pk_mul_f32 v[198:199], v[198:199], v[190:191]
    v_pk_mul_f32 v[200:201], v[200:201], v[192:193]
    v_pk_mul_f32 v[202:203], v[202:203], v[194:195]
    buffer_load_dwordx4 a[32:35], v254, s[52:55], s14 offen offset:0 sc1
    v_exp_f32 v196, v196
    v_exp_f32 v197, v197
    v_exp_f32 v198, v198
    v_exp_f32 v199, v199
    v_exp_f32 v200, v200
    v_exp_f32 v201, v201
    v_exp_f32 v202, v202
    v_exp_f32 v203, v203
    buffer_load_dwordx4 a[36:39], v254, s[52:55], s14 offen offset:1024 sc1
    v_pk_add_f32 v[196:197], v[196:197], 1.0 op_sel_hi:[1,0]
    v_pk_add_f32 v[198:199], v[198:199], 1.0 op_sel_hi:[1,0]
    v_pk_add_f32 v[200:201], v[200:201], 1.0 op_sel_hi:[1,0]
    v_pk_add_f32 v[202:203], v[202:203], 1.0 op_sel_hi:[1,0]
    v_rcp_f32 v196, v196
    v_rcp_f32 v197, v197
    v_rcp_f32 v198, v198
    v_rcp_f32 v199, v199
    v_rcp_f32 v200, v200
    v_rcp_f32 v201, v201
    v_rcp_f32 v202, v202
    v_rcp_f32 v203, v203
    buffer_load_dwordx4 a[40:43], v254, s[52:55], s14 offen offset:2048 sc1
    ds_read_b128 a[160:163], v1 offset:0
    ds_read_b128 a[164:167], v1 offset:1024
    ds_read_b128 a[168:171], v1 offset:2048
    ds_read_b128 a[172:175], v1 offset:3072
    ds_read_b128 a[176:179], v1 offset:4096
    ds_read_b128 a[180:183], v1 offset:5120
    ds_read_b128 a[184:187], v1 offset:6144
    v_pk_mul_f32 v[196:197], v[196:197], v[188:189]
    v_pk_mul_f32 v[198:199], v[198:199], v[190:191]
    v_pk_mul_f32 v[200:201], v[200:201], v[192:193]
    v_pk_mul_f32 v[202:203], v[202:203], v[194:195]
    v_cvt_pk_bf16_f32 v176, v196, v197
    v_cvt_pk_bf16_f32 v177, v198, v199
    v_cvt_pk_bf16_f32 v178, v200, v201
    v_cvt_pk_bf16_f32 v179, v202, v203
    buffer_store_dwordx4 v[176:179], v1, s[52:55], s76 offen offset:2048 sc1
    s_waitcnt lgkmcnt(6)
    v_mfma_f32_16x16x32_bf16 v[24:27], a[160:163], v[204:207], 0
    ds_read_b128 a[188:191], v1 offset:7168
    v_mfma_f32_16x16x32_bf16 v[44:47], a[160:163], v[208:211], v[232:235]
    ds_read_b128 a[192:195], v1 offset:8192
    s_waitcnt lgkmcnt(7)
    v_mfma_f32_16x16x32_bf16 v[28:31], a[164:167], v[204:207], 0
    v_mfma_f32_16x16x32_bf16 v[48:51], a[164:167], v[208:211], v[236:239]
    ds_read_b128 a[196:199], v1 offset:9216
    s_waitcnt lgkmcnt(7)
    v_mfma_f32_16x16x32_bf16 v[32:35], a[168:171], v[204:207], 0
    ds_read_b128 a[200:203], v1 offset:10240
    v_mfma_f32_16x16x32_bf16 v[52:55], a[168:171], v[208:211], v[240:243]
    s_waitcnt lgkmcnt(7)
    v_mfma_f32_16x16x32_bf16 v[36:39], a[172:175], v[204:207], 0
    ds_read_b128 a[204:207], v1 offset:11264
    v_mfma_f32_16x16x32_bf16 v[56:59], a[172:175], v[208:211], v[244:247]
    buffer_load_dwordx4 a[44:47], v254, s[52:55], s14 offen offset:3072 sc1
    ds_read_b128 a[208:211], v1 offset:12288
    s_waitcnt lgkmcnt(8)
    v_mfma_f32_16x16x32_bf16 v[40:43], a[176:179], v[204:207], 0
    v_mfma_f32_16x16x32_bf16 v[60:63], a[176:179], v[208:211], v[248:251]
    ds_read_b128 a[212:215], v1 offset:13312
    s_waitcnt lgkmcnt(6)
    v_mfma_f32_16x16x32_bf16 v[24:27], a[180:183], v[212:215], v[24:27]
    ds_read_b128 a[216:219], v1 offset:14336
    v_mfma_f32_16x16x32_bf16 v[44:47], a[180:183], v[216:219], v[44:47]
    v_mfma_f32_16x16x32_bf16 v[28:31], a[184:187], v[212:215], v[28:31]
    ds_read_b128 a[220:223], v1 offset:15360
    v_mfma_f32_16x16x32_bf16 v[48:51], a[184:187], v[216:219], v[48:51]
    buffer_load_dwordx4 a[48:51], v254, s[52:55], s15 offen offset:0 sc1
    ds_read_b128 a[224:227], v1 offset:16384
    v_mfma_f32_16x16x32_bf16 v[32:35], a[188:191], v[212:215], v[32:35]
    v_mfma_f32_16x16x32_bf16 v[52:55], a[188:191], v[216:219], v[52:55]
    ds_read_b128 a[228:231], v1 offset:17408
    s_waitcnt lgkmcnt(6)
    v_mfma_f32_16x16x32_bf16 v[36:39], a[192:195], v[212:215], v[36:39]
    ds_read_b128 a[232:235], v1 offset:18432
    v_mfma_f32_16x16x32_bf16 v[56:59], a[192:195], v[216:219], v[56:59]
    v_mfma_f32_16x16x32_bf16 v[40:43], a[196:199], v[212:215], v[40:43]
    ds_read_b128 a[236:239], v1 offset:19456
    v_mfma_f32_16x16x32_bf16 v[60:63], a[196:199], v[216:219], v[60:63]
    buffer_load_dwordx4 a[52:55], v254, s[52:55], s15 offen offset:1024 sc1
    ds_read_b128 a[240:243], v1 offset:20480
    s_waitcnt vmcnt(19)
    v_mfma_f32_16x16x32_bf16 v[24:27], a[200:203], a[0:3], v[24:27]
    s_waitcnt vmcnt(18)
    v_mfma_f32_16x16x32_bf16 v[44:47], a[200:203], a[4:7], v[44:47]
    ds_read_b128 a[244:247], v1 offset:21504
    v_mfma_f32_16x16x32_bf16 v[28:31], a[204:207], a[0:3], v[28:31]
    ds_read_b128 a[248:251], v1 offset:22528
    v_mfma_f32_16x16x32_bf16 v[48:51], a[204:207], a[4:7], v[48:51]
    s_waitcnt lgkmcnt(6)
    v_mfma_f32_16x16x32_bf16 v[32:35], a[208:211], a[0:3], v[32:35]
    ds_read_b128 a[252:255], v1 offset:23552
    v_mfma_f32_16x16x32_bf16 v[52:55], a[208:211], a[4:7], v[52:55]
    buffer_load_dwordx4 a[56:59], v254, s[52:55], s15 offen offset:2048 sc1
    ds_read_b128 v[200:203], v1 offset:24576
    v_mfma_f32_16x16x32_bf16 v[36:39], a[212:215], a[0:3], v[36:39]
    v_mfma_f32_16x16x32_bf16 v[56:59], a[212:215], a[4:7], v[56:59]
    ds_read_b128 v[196:199], v1 offset:25600
    v_mfma_f32_16x16x32_bf16 v[40:43], a[216:219], a[0:3], v[40:43]
    ds_read_b128 v[192:195], v1 offset:26624
    v_mfma_f32_16x16x32_bf16 v[60:63], a[216:219], a[4:7], v[60:63]
    s_waitcnt vmcnt(18)
    v_mfma_f32_16x16x32_bf16 v[24:27], a[220:223], a[8:11], v[24:27]
    ds_read_b128 v[188:191], v1 offset:27648
    s_waitcnt vmcnt(17)
    v_mfma_f32_16x16x32_bf16 v[44:47], a[220:223], a[12:15], v[44:47]
    buffer_load_dwordx4 a[60:63], v254, s[52:55], s15 offen offset:3072 sc1
    ds_read_b128 v[184:187], v1 offset:28672
    v_mfma_f32_16x16x32_bf16 v[28:31], a[224:227], a[8:11], v[28:31]
    v_mfma_f32_16x16x32_bf16 v[48:51], a[224:227], a[12:15], v[48:51]
    ds_read_b128 v[180:183], v1 offset:29696
    s_waitcnt lgkmcnt(6)
    v_mfma_f32_16x16x32_bf16 v[32:35], a[228:231], a[8:11], v[32:35]
    v_mfma_f32_16x16x32_bf16 v[52:55], a[228:231], a[12:15], v[52:55]
    v_mfma_f32_16x16x32_bf16 v[36:39], a[232:235], a[8:11], v[36:39]
    ds_read_b128 v[176:179], v1 offset:30720
    v_mfma_f32_16x16x32_bf16 v[56:59], a[232:235], a[12:15], v[56:59]
    buffer_load_dwordx4 a[64:67], v254, s[52:55], s16 offen offset:0 sc1
    ds_read_b128 v[164:167], v1 offset:31744
    v_mfma_f32_16x16x32_bf16 v[40:43], a[236:239], a[8:11], v[40:43]
    v_mfma_f32_16x16x32_bf16 v[60:63], a[236:239], a[12:15], v[60:63]
    ds_read_b128 v[108:111], v1 offset:32768
    s_waitcnt vmcnt(18)
    v_mfma_f32_16x16x32_bf16 v[24:27], a[240:243], a[16:19], v[24:27]
    s_waitcnt vmcnt(17)
    v_mfma_f32_16x16x32_bf16 v[44:47], a[240:243], a[20:23], v[44:47]
    v_mfma_f32_16x16x32_bf16 v[28:31], a[244:247], a[16:19], v[28:31]
    ds_read_b128 v[104:107], v1 offset:33792
    v_mfma_f32_16x16x32_bf16 v[48:51], a[244:247], a[20:23], v[48:51]
    buffer_load_dwordx4 a[68:71], v254, s[52:55], s16 offen offset:1024 sc1
    ds_read_b128 v[100:103], v1 offset:34816
    v_mfma_f32_16x16x32_bf16 v[32:35], a[248:251], a[16:19], v[32:35]
    v_mfma_f32_16x16x32_bf16 v[52:55], a[248:251], a[20:23], v[52:55]
    ds_read_b128 v[96:99], v1 offset:35840
    v_mfma_f32_16x16x32_bf16 v[36:39], a[252:255], a[16:19], v[36:39]
    v_mfma_f32_16x16x32_bf16 v[56:59], a[252:255], a[20:23], v[56:59]
    s_waitcnt lgkmcnt(4)
    v_mfma_f32_16x16x32_bf16 v[40:43], v[200:203], a[16:19], v[40:43]
    ds_read_b128 v[92:95], v1 offset:36864
    v_mfma_f32_16x16x32_bf16 v[60:63], v[200:203], a[20:23], v[60:63]
    buffer_load_dwordx4 a[72:75], v254, s[52:55], s16 offen offset:2048 sc1
    ds_read_b128 v[88:91], v1 offset:37888
    s_waitcnt vmcnt(15)
    v_mfma_f32_16x16x32_bf16 v[24:27], v[196:199], a[24:27], v[24:27]
    s_waitcnt vmcnt(12)
    v_mfma_f32_16x16x32_bf16 v[44:47], v[196:199], a[28:31], v[44:47]
    ds_read_b128 v[84:87], v1 offset:38912
    v_mfma_f32_16x16x32_bf16 v[28:31], v[192:195], a[24:27], v[28:31]
    v_mfma_f32_16x16x32_bf16 v[48:51], v[192:195], a[28:31], v[48:51]
    v_mfma_f32_16x16x32_bf16 v[32:35], v[188:191], a[24:27], v[32:35]
    ds_read_b128 v[80:83], v1 offset:39936
    v_mfma_f32_16x16x32_bf16 v[52:55], v[188:191], a[28:31], v[52:55]
    buffer_load_dwordx4 a[76:79], v254, s[52:55], s16 offen offset:3072 sc1
    ds_read_b128 v[76:79], v1 offset:40960
    v_mfma_f32_16x16x32_bf16 v[36:39], v[184:187], a[24:27], v[36:39]
    v_mfma_f32_16x16x32_bf16 v[56:59], v[184:187], a[28:31], v[56:59]
    ds_read_b128 v[72:75], v1 offset:41984
    v_mfma_f32_16x16x32_bf16 v[40:43], v[180:183], a[24:27], v[40:43]
    v_mfma_f32_16x16x32_bf16 v[60:63], v[180:183], a[28:31], v[60:63]
    s_waitcnt vmcnt(9)
    buffer_store_dword v226, v227, s[52:55], s59 offen
    v_mfma_f32_16x16x32_bf16 v[24:27], v[176:179], a[32:35], v[24:27]
    ds_read_b128 v[68:71], v1 offset:43008
    v_mfma_f32_16x16x32_bf16 v[44:47], v[176:179], a[36:39], v[44:47]
    s_barrier
L_pad_m1_1:
    s_cbranch_execz L_pad_m1_2
    buffer_load_dwordx4 a[80:83], v254, s[52:55], s17 offen offset:0 sc1
    ds_read_b128 v[64:67], v1 offset:44032
    v_mfma_f32_16x16x32_bf16 v[28:31], v[164:167], a[32:35], v[28:31]
    v_mfma_f32_16x16x32_bf16 v[48:51], v[164:167], a[36:39], v[48:51]
    ds_read_b128 a[160:163], v1 offset:45056
    s_waitcnt lgkmcnt(5)
    v_mfma_f32_16x16x32_bf16 v[32:35], v[108:111], a[32:35], v[32:35]
    ds_read_b128 a[164:167], v1 offset:46080
    v_mfma_f32_16x16x32_bf16 v[52:55], v[108:111], a[36:39], v[52:55]
    v_mfma_f32_16x16x32_bf16 v[36:39], v[104:107], a[32:35], v[36:39]
    ds_read_b128 a[168:171], v1 offset:47104
    v_mfma_f32_16x16x32_bf16 v[56:59], v[104:107], a[36:39], v[56:59]
    buffer_load_dwordx4 a[84:87], v254, s[52:55], s17 offen offset:1024 sc1
    ds_read_b128 a[172:175], v1 offset:48128
    v_mfma_f32_16x16x32_bf16 v[40:43], v[100:103], a[32:35], v[40:43]
    v_mfma_f32_16x16x32_bf16 v[60:63], v[100:103], a[36:39], v[60:63]
    ds_read_b128 v[204:207], v1 offset:49152
    v_mfma_f32_16x16x32_bf16 v[24:27], v[96:99], a[40:43], v[24:27]
    ds_read_b128 a[176:179], v1 offset:50176
    s_waitcnt vmcnt(11)
    v_mfma_f32_16x16x32_bf16 v[44:47], v[96:99], a[44:47], v[44:47]
    v_mfma_f32_16x16x32_bf16 v[28:31], v[92:95], a[40:43], v[28:31]
    ds_read_b128 v[208:211], v1 offset:51200
    v_mfma_f32_16x16x32_bf16 v[48:51], v[92:95], a[44:47], v[48:51]
    buffer_load_dwordx4 a[88:91], v254, s[52:55], s17 offen offset:2048 sc1
    ds_read_b128 a[180:183], v1 offset:52224
    v_mfma_f32_16x16x32_bf16 v[32:35], v[88:91], a[40:43], v[32:35]
    v_mfma_f32_16x16x32_bf16 v[52:55], v[88:91], a[44:47], v[52:55]
    ds_read_b128 a[184:187], v1 offset:53248
    v_mfma_f32_16x16x32_bf16 v[36:39], v[84:87], a[40:43], v[36:39]
    ds_read_b128 a[188:191], v1 offset:54272
    v_mfma_f32_16x16x32_bf16 v[56:59], v[84:87], a[44:47], v[56:59]
    v_mfma_f32_16x16x32_bf16 v[40:43], v[80:83], a[40:43], v[40:43]
    ds_read_b128 a[192:195], v1 offset:55296
    v_mfma_f32_16x16x32_bf16 v[60:63], v[80:83], a[44:47], v[60:63]
    buffer_load_dwordx4 a[92:95], v254, s[52:55], s17 offen offset:3072 sc1
    ds_read_b128 v[212:215], v1 offset:56320
    s_waitcnt vmcnt(12) lgkmcnt(6)
    v_mfma_f32_16x16x32_bf16 v[24:27], v[76:79], a[48:51], v[24:27]
    s_waitcnt vmcnt(11)
    v_mfma_f32_16x16x32_bf16 v[44:47], v[76:79], a[52:55], v[44:47]
    ds_read_b128 a[196:199], v1 offset:57344
    v_mfma_f32_16x16x32_bf16 v[28:31], v[72:75], a[48:51], v[28:31]
    ds_read_b128 v[216:219], v1 offset:58368
    v_mfma_f32_16x16x32_bf16 v[48:51], v[72:75], a[52:55], v[48:51]
    v_mfma_f32_16x16x32_bf16 v[32:35], v[68:71], a[48:51], v[32:35]
    ds_read_b128 a[200:203], v1 offset:59392
    v_mfma_f32_16x16x32_bf16 v[52:55], v[68:71], a[52:55], v[52:55]
    buffer_load_dwordx4 a[96:99], v254, s[52:55], s18 offen offset:0 sc1
    ds_read_b128 a[204:207], v1 offset:60416
    v_mfma_f32_16x16x32_bf16 v[36:39], v[64:67], a[48:51], v[36:39]
    v_mfma_f32_16x16x32_bf16 v[56:59], v[64:67], a[52:55], v[56:59]
    ds_read_b128 a[208:211], v1 offset:61440
    v_mfma_f32_16x16x32_bf16 v[40:43], a[160:163], a[48:51], v[40:43]
    ds_read_b128 a[212:215], v1 offset:62464
    v_mfma_f32_16x16x32_bf16 v[60:63], a[160:163], a[52:55], v[60:63]
    s_waitcnt vmcnt(11)
    v_mfma_f32_16x16x32_bf16 v[24:27], a[164:167], a[56:59], v[24:27]
    ds_read_b128 a[216:219], v1 offset:63488
    s_waitcnt vmcnt(10)
    v_mfma_f32_16x16x32_bf16 v[44:47], a[164:167], a[60:63], v[44:47]
    buffer_load_dwordx4 a[100:103], v254, s[52:55], s18 offen offset:1024 sc1
    ds_read_b128 a[220:223], v1 offset:64512
    v_mfma_f32_16x16x32_bf16 v[28:31], a[168:171], a[56:59], v[28:31]
    v_mfma_f32_16x16x32_bf16 v[48:51], a[168:171], a[60:63], v[48:51]
    ds_read_b128 a[224:227], v14 offset:0
    v_mfma_f32_16x16x32_bf16 v[32:35], a[172:175], a[56:59], v[32:35]
    ds_read_b128 a[228:231], v14 offset:1024
    v_mfma_f32_16x16x32_bf16 v[52:55], a[172:175], a[60:63], v[52:55]
    v_mfma_f32_16x16x32_bf16 v[36:39], v[204:207], a[56:59], v[36:39]
    ds_read_b128 a[232:235], v14 offset:2048
    v_mfma_f32_16x16x32_bf16 v[56:59], v[204:207], a[60:63], v[56:59]
    buffer_load_dwordx4 a[104:107], v254, s[52:55], s18 offen offset:2048 sc1
    ds_read_b128 a[8:11], v14 offset:3072
    v_mfma_f32_16x16x32_bf16 v[40:43], a[176:179], a[56:59], v[40:43]
    v_mfma_f32_16x16x32_bf16 v[60:63], a[176:179], a[60:63], v[60:63]
    ds_read_b128 a[236:239], v14 offset:4096
    s_waitcnt vmcnt(11) lgkmcnt(6)
    v_mfma_f32_16x16x32_bf16 v[24:27], v[208:211], a[64:67], v[24:27]
    ds_read_b128 a[12:15], v14 offset:5120
    s_waitcnt vmcnt(10)
    v_mfma_f32_16x16x32_bf16 v[44:47], v[208:211], a[68:71], v[44:47]
    v_mfma_f32_16x16x32_bf16 v[28:31], a[180:183], a[64:67], v[28:31]
    ds_read_b128 a[240:243], v14 offset:6144
    v_mfma_f32_16x16x32_bf16 v[48:51], a[180:183], a[68:71], v[48:51]
    buffer_load_dwordx4 a[108:111], v254, s[52:55], s18 offen offset:3072 sc1
    ds_read_b128 a[244:247], v14 offset:7168
    v_mfma_f32_16x16x32_bf16 v[32:35], a[184:187], a[64:67], v[32:35]
    v_mfma_f32_16x16x32_bf16 v[52:55], a[184:187], a[68:71], v[52:55]
    ds_read_b128 a[248:251], v14 offset:8192
    v_mfma_f32_16x16x32_bf16 v[36:39], a[188:191], a[64:67], v[36:39]
    ds_read_b128 a[252:255], v14 offset:9216
    v_mfma_f32_16x16x32_bf16 v[56:59], a[188:191], a[68:71], v[56:59]
    v_mfma_f32_16x16x32_bf16 v[40:43], a[192:195], a[64:67], v[40:43]
    ds_read_b128 a[16:19], v14 offset:10240
    v_mfma_f32_16x16x32_bf16 v[60:63], a[192:195], a[68:71], v[60:63]
    buffer_load_dword v2, v5, s[52:55], s1 offen sc1
    ds_read_b128 v[200:203], v14 offset:11264
    s_waitcnt vmcnt(11)
    v_mfma_f32_16x16x32_bf16 v[24:27], v[212:215], a[72:75], v[24:27]
    s_waitcnt vmcnt(10)
    v_mfma_f32_16x16x32_bf16 v[44:47], v[212:215], a[76:79], v[44:47]
    ds_read_b128 a[20:23], v14 offset:12288
    v_mfma_f32_16x16x32_bf16 v[28:31], a[196:199], a[72:75], v[28:31]
    ds_read_b128 v[196:199], v14 offset:13312
    v_mfma_f32_16x16x32_bf16 v[48:51], a[196:199], a[76:79], v[48:51]
    v_mfma_f32_16x16x32_bf16 v[32:35], v[216:219], a[72:75], v[32:35]
    ds_read_b128 v[192:195], v14 offset:14336
    v_mfma_f32_16x16x32_bf16 v[52:55], v[216:219], a[76:79], v[52:55]
    ds_read_b128 v[188:191], v14 offset:15360
    v_mfma_f32_16x16x32_bf16 v[36:39], a[200:203], a[72:75], v[36:39]
    v_mfma_f32_16x16x32_bf16 v[56:59], a[200:203], a[76:79], v[56:59]
    ds_read_b128 v[184:187], v15 offset:0
    v_mfma_f32_16x16x32_bf16 v[40:43], a[204:207], a[72:75], v[40:43]
    ds_read_b128 a[24:27], v15 offset:1024
    v_mfma_f32_16x16x32_bf16 v[60:63], a[204:207], a[76:79], v[60:63]
    s_waitcnt vmcnt(8)
    v_mfma_f32_16x16x32_bf16 v[24:27], a[208:211], a[80:83], v[24:27]
    ds_read_b128 v[180:183], v15 offset:2048
    s_waitcnt vmcnt(7)
    v_mfma_f32_16x16x32_bf16 v[44:47], a[208:211], a[84:87], v[44:47]
    ds_read_b128 a[28:31], v15 offset:3072
    v_mfma_f32_16x16x32_bf16 v[28:31], a[212:215], a[80:83], v[28:31]
    v_mfma_f32_16x16x32_bf16 v[48:51], a[212:215], a[84:87], v[48:51]
    ds_read_b128 v[176:179], v15 offset:4096
    v_mfma_f32_16x16x32_bf16 v[32:35], a[216:219], a[80:83], v[32:35]
    ds_read_b128 v[164:167], v15 offset:5120
    v_mfma_f32_16x16x32_bf16 v[52:55], a[216:219], a[84:87], v[52:55]
    s_waitcnt lgkmcnt(6)
    v_mfma_f32_16x16x32_bf16 v[36:39], a[220:223], a[80:83], v[36:39]
    ds_read_b128 v[108:111], v15 offset:6144
    v_mfma_f32_16x16x32_bf16 v[56:59], a[220:223], a[84:87], v[56:59]
    ds_read_b128 v[104:107], v15 offset:7168
    v_mfma_f32_16x16x32_bf16 v[40:43], a[224:227], a[80:83], v[40:43]
    v_mfma_f32_16x16x32_bf16 v[60:63], a[224:227], a[84:87], v[60:63]
    ds_read_b128 a[32:35], v15 offset:8192
    s_waitcnt vmcnt(6)
    v_mfma_f32_16x16x32_bf16 v[24:27], a[228:231], a[88:91], v[24:27]
    ds_read_b128 v[100:103], v15 offset:9216
    s_waitcnt vmcnt(5)
    v_mfma_f32_16x16x32_bf16 v[44:47], a[228:231], a[92:95], v[44:47]
    s_waitcnt vmcnt(0)
    v_cmp_eq_u32 s[90:91], s6, v2
    s_nop 0
    s_cmp_eq_u64 s[90:91], -1
    s_cbranch_scc0 L_pollf82
L_polld80:
    buffer_load_dwordx4 a[112:115], v1, s[52:55], s12 offen offset:0 sc1
    v_mfma_f32_16x16x32_bf16 v[28:31], a[232:235], a[88:91], v[28:31]
    ds_read_b128 a[36:39], v15 offset:10240
    v_mfma_f32_16x16x32_bf16 v[48:51], a[232:235], a[92:95], v[48:51]
    buffer_load_dwordx4 a[116:119], v1, s[52:55], s13 offen offset:0 sc1
    ds_read_b128 v[96:99], v15 offset:11264
    v_mfma_f32_16x16x32_bf16 v[32:35], a[8:11], a[88:91], v[32:35]
    v_mfma_f32_16x16x32_bf16 v[52:55], a[8:11], a[92:95], v[52:55]
    buffer_load_dwordx4 a[120:123], v1, s[52:55], s14 offen offset:0 sc1
    ds_read_b128 v[92:95], v15 offset:12288
    v_mfma_f32_16x16x32_bf16 v[36:39], a[236:239], a[88:91], v[36:39]
    ds_read_b128 v[88:91], v15 offset:13312
    v_mfma_f32_16x16x32_bf16 v[56:59], a[236:239], a[92:95], v[56:59]
    buffer_load_dwordx4 a[124:127], v1, s[52:55], s15 offen offset:0 sc1
    v_mfma_f32_16x16x32_bf16 v[40:43], a[12:15], a[88:91], v[40:43]
    ds_read_b128 v[84:87], v15 offset:14336
    v_mfma_f32_16x16x32_bf16 v[60:63], a[12:15], a[92:95], v[60:63]
    buffer_load_dwordx4 a[128:131], v1, s[52:55], s16 offen offset:0 sc1
    ds_read_b128 a[40:43], v15 offset:15360
    v_mfma_f32_16x16x32_bf16 v[24:27], a[240:243], a[96:99], v[24:27]
    v_mfma_f32_16x16x32_bf16 v[44:47], a[240:243], a[100:103], v[44:47]
    buffer_load_dwordx4 a[132:135], v1, s[52:55], s17 offen offset:0 sc1
    ds_read_b128 v[80:83], v15 offset:16384
    v_mfma_f32_16x16x32_bf16 v[28:31], a[244:247], a[96:99], v[28:31]
    ds_read_b128 a[44:47], v15 offset:17408
    v_mfma_f32_16x16x32_bf16 v[48:51], a[244:247], a[100:103], v[48:51]
    buffer_load_dwordx4 a[136:139], v1, s[52:55], s18 offen offset:0 sc1
    v_mfma_f32_16x16x32_bf16 v[32:35], a[248:251], a[96:99], v[32:35]
    ds_read_b128 v[76:79], v15 offset:18432
    v_mfma_f32_16x16x32_bf16 v[52:55], a[248:251], a[100:103], v[52:55]
    s_add_u32 s78, s81, 2048
    buffer_load_dwordx4 v[112:115], v1, s[52:55], s78 offen offset:0 sc1
    ds_read_b128 v[72:75], v15 offset:19456
    v_mfma_f32_16x16x32_bf16 v[36:39], a[252:255], a[96:99], v[36:39]
    v_mfma_f32_16x16x32_bf16 v[56:59], a[252:255], a[100:103], v[56:59]
    s_add_u32 s78, s81, 9216
    buffer_load_dwordx4 v[116:119], v1, s[52:55], s78 offen offset:0 sc1
    ds_read_b128 v[68:71], v15 offset:20480
    v_mfma_f32_16x16x32_bf16 v[40:43], a[16:19], a[96:99], v[40:43]
    ds_read_b128 v[64:67], v15 offset:21504
    v_mfma_f32_16x16x32_bf16 v[60:63], a[16:19], a[100:103], v[60:63]
    s_add_u32 s78, s81, 16384
    buffer_load_dwordx4 v[120:123], v1, s[52:55], s78 offen offset:0 sc1
    v_mfma_f32_16x16x32_bf16 v[24:27], v[200:203], a[104:107], v[24:27]
    ds_read_b128 a[48:51], v15 offset:22528
    v_mfma_f32_16x16x32_bf16 v[44:47], v[200:203], a[108:111], v[44:47]
    s_add_u32 s78, s81, 23552
    buffer_load_dwordx4 v[124:127], v1, s[52:55], s78 offen offset:0 sc1
    ds_read_b128 a[160:163], v15 offset:23552
    v_mfma_f32_16x16x32_bf16 v[28:31], a[20:23], a[104:107], v[28:31]
    v_mfma_f32_16x16x32_bf16 v[48:51], a[20:23], a[108:111], v[48:51]
    ds_read_b128 a[52:55], v15 offset:24576
    v_mfma_f32_16x16x32_bf16 v[32:35], v[196:199], a[104:107], v[32:35]
    ds_read_b128 a[164:167], v15 offset:25600
    v_mfma_f32_16x16x32_bf16 v[52:55], v[196:199], a[108:111], v[52:55]
    v_mfma_f32_16x16x32_bf16 v[36:39], v[192:195], a[104:107], v[36:39]
    ds_read_b128 a[168:171], v15 offset:26624
    v_mfma_f32_16x16x32_bf16 v[56:59], v[192:195], a[108:111], v[56:59]
    s_add_u32 s78, s81, 30720
    buffer_load_dwordx4 v[128:131], v1, s[52:55], s78 offen offset:0 sc1
    ds_read_b128 a[172:175], v15 offset:27648
    v_mfma_f32_16x16x32_bf16 v[40:43], v[188:191], a[104:107], v[40:43]
    v_mfma_f32_16x16x32_bf16 v[60:63], v[188:191], a[108:111], v[60:63]
    ds_read_b128 v[204:207], v15 offset:28672
    s_waitcnt lgkmcnt(6)
    v_mfma_f32_16x16x32_bf16 v[24:27], v[184:187], v[168:171], v[24:27]
    ds_read_b128 a[56:59], v15 offset:29696
    v_mfma_f32_16x16x32_bf16 v[28:31], a[24:27], v[168:171], v[28:31]
    v_mfma_f32_16x16x32_bf16 v[32:35], v[180:183], v[168:171], v[32:35]
    ds_read_b128 a[176:179], v15 offset:30720
    v_mfma_f32_16x16x32_bf16 v[36:39], a[28:31], v[168:171], v[36:39]
    s_add_u32 s78, s81, 37888
    buffer_load_dwordx4 v[132:135], v1, s[52:55], s78 offen offset:0 sc1
    ds_read_b128 a[60:63], v15 offset:31744
    v_mfma_f32_16x16x32_bf16 v[40:43], v[176:179], v[168:171], v[40:43]
    s_waitcnt vmcnt(12)
    v_mfma_f32_16x16x32_bf16 v[24:27], v[164:167], a[112:115], v[24:27]
    ds_read_b128 v[208:211], v15 offset:32768
    v_mfma_f32_16x16x32_bf16 v[28:31], v[108:111], a[112:115], v[28:31]
    ds_read_b128 a[180:183], v15 offset:33792
    v_mfma_f32_16x16x32_bf16 v[32:35], v[104:107], a[112:115], v[32:35]
    v_mfma_f32_16x16x32_bf16 v[36:39], a[32:35], a[112:115], v[36:39]
    ds_read_b128 a[184:187], v15 offset:34816
    v_mfma_f32_16x16x32_bf16 v[40:43], v[100:103], a[112:115], v[40:43]
    s_add_u32 s78, s81, 45056
    buffer_load_dwordx4 v[136:139], v1, s[52:55], s78 offen offset:0 sc1
    ds_read_b128 a[188:191], v15 offset:35840
    s_waitcnt vmcnt(12)
    v_mfma_f32_16x16x32_bf16 v[24:27], a[36:39], a[116:119], v[24:27]
    v_mfma_f32_16x16x32_bf16 v[28:31], v[96:99], a[116:119], v[28:31]
    ds_read_b128 a[64:67], v15 offset:36864
    v_mfma_f32_16x16x32_bf16 v[32:35], v[92:95], a[116:119], v[32:35]
    ds_read_b128 a[192:195], v15 offset:37888
    v_mfma_f32_16x16x32_bf16 v[36:39], v[88:91], a[116:119], v[36:39]
    v_mfma_f32_16x16x32_bf16 v[40:43], v[84:87], a[116:119], v[40:43]
    ds_read_b128 a[68:71], v15 offset:38912
    s_waitcnt vmcnt(11)
    v_mfma_f32_16x16x32_bf16 v[24:27], a[40:43], a[120:123], v[24:27]
    s_add_u32 s78, s81, 52224
    buffer_load_dwordx4 v[140:143], v1, s[52:55], s78 offen offset:0 sc1
    ds_read_b128 v[212:215], v15 offset:39936
    v_mfma_f32_16x16x32_bf16 v[28:31], v[80:83], a[120:123], v[28:31]
    v_mfma_f32_16x16x32_bf16 v[32:35], a[44:47], a[120:123], v[32:35]
    ds_read_b128 a[196:199], v15 offset:40960
    v_mfma_f32_16x16x32_bf16 v[36:39], v[76:79], a[120:123], v[36:39]
    ds_read_b128 v[216:219], v15 offset:41984
    v_mfma_f32_16x16x32_bf16 v[40:43], v[72:75], a[120:123], v[40:43]
    s_waitcnt vmcnt(11)
    v_mfma_f32_16x16x32_bf16 v[24:27], v[68:71], a[124:127], v[24:27]
    ds_read_b128 a[200:203], v15 offset:43008
    v_mfma_f32_16x16x32_bf16 v[28:31], v[64:67], a[124:127], v[28:31]
    buffer_load_dwordx4 a[140:143], v1, s[52:55], s12 offen offset:1024 sc1
    ds_read_b128 a[72:75], v15 offset:44032
    v_mfma_f32_16x16x32_bf16 v[32:35], a[48:51], a[124:127], v[32:35]
    s_waitcnt lgkmcnt(6)
    v_mfma_f32_16x16x32_bf16 v[36:39], a[160:163], a[124:127], v[36:39]
    ds_read_b128 a[204:207], v15 offset:45056
    v_mfma_f32_16x16x32_bf16 v[40:43], a[52:55], a[124:127], v[40:43]
    ds_read_b128 a[76:79], v15 offset:46080
    s_waitcnt vmcnt(11)
    v_mfma_f32_16x16x32_bf16 v[24:27], a[164:167], a[128:131], v[24:27]
    v_mfma_f32_16x16x32_bf16 v[28:31], a[168:171], a[128:131], v[28:31]
    ds_read_b128 a[208:211], v15 offset:47104
    v_mfma_f32_16x16x32_bf16 v[32:35], a[172:175], a[128:131], v[32:35]
    buffer_load_dwordx4 a[144:147], v1, s[52:55], s13 offen offset:1024 sc1
    ds_read_b128 a[212:215], v15 offset:48128
    v_mfma_f32_16x16x32_bf16 v[36:39], v[204:207], a[128:131], v[36:39]
    v_mfma_f32_16x16x32_bf16 v[40:43], a[56:59], a[128:131], v[40:43]
    ds_read_b128 a[216:219], v15 offset:49152
    s_waitcnt vmcnt(11)
    v_mfma_f32_16x16x32_bf16 v[24:27], a[176:179], a[132:135], v[24:27]
    ds_read_b128 a[220:223], v15 offset:50176
    v_mfma_f32_16x16x32_bf16 v[28:31], a[60:63], a[132:135], v[28:31]
    v_mfma_f32_16x16x32_bf16 v[32:35], v[208:211], a[132:135], v[32:35]
    ds_read_b128 a[80:83], v15 offset:51200
    v_mfma_f32_16x16x32_bf16 v[36:39], a[180:183], a[132:135], v[36:39]
    buffer_load_dwordx4 a[148:151], v1, s[52:55], s14 offen offset:1024 sc1
    ds_read_b128 a[224:227], v15 offset:52224
    v_mfma_f32_16x16x32_bf16 v[40:43], a[184:187], a[132:135], v[40:43]
    s_waitcnt vmcnt(11)
    v_mfma_f32_16x16x32_bf16 v[24:27], a[188:191], a[136:139], v[24:27]
    ds_read_b128 a[84:87], v15 offset:53248
    v_mfma_f32_16x16x32_bf16 v[28:31], a[64:67], a[136:139], v[28:31]
    ds_read_b128 a[228:231], v15 offset:54272
    v_mfma_f32_16x16x32_bf16 v[32:35], a[192:195], a[136:139], v[32:35]
    s_waitcnt lgkmcnt(6)
    v_mfma_f32_16x16x32_bf16 v[36:39], a[68:71], a[136:139], v[36:39]
    ds_read_b128 a[232:235], v15 offset:55296
    v_mfma_f32_16x16x32_bf16 v[40:43], v[212:215], a[136:139], v[40:43]
    buffer_load_dwordx4 a[152:155], v1, s[52:55], s15 offen offset:1024 sc1
    ds_read_b128 a[8:11], v15 offset:56320
    s_waitcnt vmcnt(10)
    v_swap_b32 v114, v116
    v_swap_b32 v115, v117
    s_nop 1
    v_mfma_f32_16x16x32_bf16 v[24:27], a[196:199], v[112:115], v[24:27]
    v_mfma_f32_16x16x32_bf16 v[28:31], v[216:219], v[112:115], v[28:31]
    ds_read_b128 a[236:239], v15 offset:57344
    v_mfma_f32_16x16x32_bf16 v[32:35], a[200:203], v[112:115], v[32:35]
    ds_read_b128 a[88:91], v15 offset:58368
    v_mfma_f32_16x16x32_bf16 v[36:39], a[72:75], v[112:115], v[36:39]
    v_mfma_f32_16x16x32_bf16 v[40:43], a[204:207], v[112:115], v[40:43]
    ds_read_b128 a[12:15], v15 offset:59392
    s_waitcnt vmcnt(8)
    v_swap_b32 v122, v124
    v_swap_b32 v123, v125
    s_nop 1
    v_mfma_f32_16x16x32_bf16 v[24:27], a[76:79], v[120:123], v[24:27]
    buffer_load_dwordx4 a[156:159], v1, s[52:55], s16 offen offset:1024 sc1
    ds_read_b128 a[92:95], v15 offset:60416
    v_mfma_f32_16x16x32_bf16 v[28:31], a[208:211], v[120:123], v[28:31]
    v_mfma_f32_16x16x32_bf16 v[32:35], a[212:215], v[120:123], v[32:35]
    s_waitcnt lgkmcnt(5)
    v_mfma_f32_16x16x32_bf16 v[36:39], a[216:219], v[120:123], v[36:39]
    v_mfma_f32_16x16x32_bf16 v[40:43], a[220:223], v[120:123], v[40:43]
    s_waitcnt vmcnt(7)
    v_swap_b32 v130, v132
    v_swap_b32 v131, v133
    s_nop 1
    v_mfma_f32_16x16x32_bf16 v[24:27], a[80:83], v[128:131], v[24:27]
    v_mfma_f32_16x16x32_bf16 v[28:31], a[224:227], v[128:131], v[28:31]
    buffer_load_dwordx4 a[0:3], v1, s[52:55], s17 offen offset:1024 sc1
    v_mfma_f32_16x16x32_bf16 v[32:35], a[84:87], v[128:131], v[32:35]
    v_mfma_f32_16x16x32_bf16 v[36:39], a[228:231], v[128:131], v[36:39]
    v_mfma_f32_16x16x32_bf16 v[40:43], a[232:235], v[128:131], v[40:43]
    s_waitcnt vmcnt(6)
    v_swap_b32 v138, v140
    v_swap_b32 v139, v141
    s_waitcnt lgkmcnt(0)
    s_nop 0
    v_mfma_f32_16x16x32_bf16 v[24:27], a[8:11], v[136:139], v[24:27]
    v_mfma_f32_16x16x32_bf16 v[28:31], a[236:239], v[136:139], v[28:31]
    v_mfma_f32_16x16x32_bf16 v[32:35], a[88:91], v[136:139], v[32:35]
    buffer_load_dwordx4 a[4:7], v1, s[52:55], s18 offen offset:1024 sc1
    v_mfma_f32_16x16x32_bf16 v[36:39], a[12:15], v[136:139], v[36:39]
    v_mfma_f32_16x16x32_bf16 v[40:43], a[92:95], v[136:139], v[40:43]
    v_mfma_f32_16x16x32_bf16 v[44:47], a[196:199], v[116:119], v[44:47]
    v_mfma_f32_16x16x32_bf16 v[48:51], v[216:219], v[116:119], v[48:51]
    buffer_store_dword v226, v253, s[52:55], s56 offen sc1
    v_mfma_f32_16x16x32_bf16 v[52:55], a[200:203], v[116:119], v[52:55]
    v_cvt_pk_bf16_f32 v232, v24, v25
    v_cvt_pk_bf16_f32 v233, v26, v27
    v_mfma_f32_16x16x32_bf16 v[56:59], a[72:75], v[116:119], v[56:59]
    v_min_u32 v232, -2, v232
    v_cvt_pk_bf16_f32 v234, v28, v29
    v_mfma_f32_16x16x32_bf16 v[60:63], a[204:207], v[116:119], v[60:63]
    v_cvt_pk_bf16_f32 v235, v30, v31
    buffer_store_dwordx4 v[232:235], v1, s[52:55], s58 offen sc1
    v_mfma_f32_16x16x32_bf16 v[44:47], a[76:79], v[124:127], v[44:47]
    v_cvt_pk_bf16_f32 v236, v32, v33
    v_cvt_pk_bf16_f32 v237, v34, v35
    v_mfma_f32_16x16x32_bf16 v[48:51], a[208:211], v[124:127], v[48:51]
    v_min_u32 v236, -2, v236
    v_cvt_pk_bf16_f32 v238, v36, v37
    v_mfma_f32_16x16x32_bf16 v[52:55], a[212:215], v[124:127], v[52:55]
    v_cvt_pk_bf16_f32 v239, v38, v39
    buffer_store_dwordx4 v[236:239], v1, s[52:55], s58 offen offset:1024 sc1
    v_mfma_f32_16x16x32_bf16 v[56:59], a[216:219], v[124:127], v[56:59]
    v_cvt_pk_bf16_f32 v240, v40, v41
    v_cvt_pk_bf16_f32 v241, v42, v43
    v_mfma_f32_16x16x32_bf16 v[60:63], a[220:223], v[124:127], v[60:63]
    v_min_u32 v240, -2, v240
    buffer_store_dwordx2 v[240:241], v252, s[52:55], s58 offen offset:2048 sc1
    v_mfma_f32_16x16x32_bf16 v[44:47], a[80:83], v[132:135], v[44:47]
    v_mfma_f32_16x16x32_bf16 v[48:51], a[224:227], v[132:135], v[48:51]
    v_mfma_f32_16x16x32_bf16 v[52:55], a[84:87], v[132:135], v[52:55]
    v_mfma_f32_16x16x32_bf16 v[56:59], a[228:231], v[132:135], v[56:59]
    v_mfma_f32_16x16x32_bf16 v[60:63], a[232:235], v[132:135], v[60:63]
    v_mfma_f32_16x16x32_bf16 v[44:47], a[8:11], v[140:143], v[44:47]
    v_mfma_f32_16x16x32_bf16 v[48:51], a[236:239], v[140:143], v[48:51]
    v_mfma_f32_16x16x32_bf16 v[52:55], a[88:91], v[140:143], v[52:55]
    v_mfma_f32_16x16x32_bf16 v[56:59], a[12:15], v[140:143], v[56:59]
    v_mfma_f32_16x16x32_bf16 v[60:63], a[92:95], v[140:143], v[60:63]
    v_mfma_f32_16x16x32_bf16 v[44:47], v[184:187], v[172:175], v[44:47]
    v_mfma_f32_16x16x32_bf16 v[48:51], a[24:27], v[172:175], v[48:51]
    v_mfma_f32_16x16x32_bf16 v[52:55], v[180:183], v[172:175], v[52:55]
    v_mfma_f32_16x16x32_bf16 v[56:59], a[28:31], v[172:175], v[56:59]
    v_mfma_f32_16x16x32_bf16 v[60:63], v[176:179], v[172:175], v[60:63]
    s_waitcnt vmcnt(10)
    v_mfma_f32_16x16x32_bf16 v[44:47], v[164:167], a[140:143], v[44:47]
    v_mfma_f32_16x16x32_bf16 v[48:51], v[108:111], a[140:143], v[48:51]
    v_mfma_f32_16x16x32_bf16 v[52:55], v[104:107], a[140:143], v[52:55]
    v_mfma_f32_16x16x32_bf16 v[56:59], a[32:35], a[140:143], v[56:59]
    v_mfma_f32_16x16x32_bf16 v[60:63], v[100:103], a[140:143], v[60:63]
    s_waitcnt vmcnt(9)
    v_mfma_f32_16x16x32_bf16 v[44:47], a[36:39], a[144:147], v[44:47]
    v_mfma_f32_16x16x32_bf16 v[48:51], v[96:99], a[144:147], v[48:51]
    v_mfma_f32_16x16x32_bf16 v[52:55], v[92:95], a[144:147], v[52:55]
    v_mfma_f32_16x16x32_bf16 v[56:59], v[88:91], a[144:147], v[56:59]
    v_mfma_f32_16x16x32_bf16 v[60:63], v[84:87], a[144:147], v[60:63]
    s_waitcnt vmcnt(8)
    v_mfma_f32_16x16x32_bf16 v[44:47], a[40:43], a[148:151], v[44:47]
    v_mfma_f32_16x16x32_bf16 v[48:51], v[80:83], a[148:151], v[48:51]
    v_mfma_f32_16x16x32_bf16 v[52:55], a[44:47], a[148:151], v[52:55]
    v_mfma_f32_16x16x32_bf16 v[56:59], v[76:79], a[148:151], v[56:59]
    v_mfma_f32_16x16x32_bf16 v[60:63], v[72:75], a[148:151], v[60:63]
    s_waitcnt vmcnt(7)
    v_mfma_f32_16x16x32_bf16 v[44:47], v[68:71], a[152:155], v[44:47]
    v_mfma_f32_16x16x32_bf16 v[48:51], v[64:67], a[152:155], v[48:51]
    v_mfma_f32_16x16x32_bf16 v[52:55], a[48:51], a[152:155], v[52:55]
    v_mfma_f32_16x16x32_bf16 v[56:59], a[160:163], a[152:155], v[56:59]
    v_mfma_f32_16x16x32_bf16 v[60:63], a[52:55], a[152:155], v[60:63]
    s_waitcnt vmcnt(6)
    v_mfma_f32_16x16x32_bf16 v[44:47], a[164:167], a[156:159], v[44:47]
    v_mfma_f32_16x16x32_bf16 v[48:51], a[168:171], a[156:159], v[48:51]
    v_mfma_f32_16x16x32_bf16 v[52:55], a[172:175], a[156:159], v[52:55]
    v_mfma_f32_16x16x32_bf16 v[56:59], v[204:207], a[156:159], v[56:59]
    v_mfma_f32_16x16x32_bf16 v[60:63], a[56:59], a[156:159], v[60:63]
    s_waitcnt vmcnt(5)
    v_mfma_f32_16x16x32_bf16 v[44:47], a[176:179], a[0:3], v[44:47]
    v_mfma_f32_16x16x32_bf16 v[48:51], a[60:63], a[0:3], v[48:51]
    v_mfma_f32_16x16x32_bf16 v[52:55], v[208:211], a[0:3], v[52:55]
    v_mfma_f32_16x16x32_bf16 v[56:59], a[180:183], a[0:3], v[56:59]
    v_mfma_f32_16x16x32_bf16 v[60:63], a[184:187], a[0:3], v[60:63]
    s_waitcnt vmcnt(4)
    v_mfma_f32_16x16x32_bf16 v[44:47], a[188:191], a[4:7], v[44:47]
    v_mfma_f32_16x16x32_bf16 v[48:51], a[64:67], a[4:7], v[48:51]
    v_mfma_f32_16x16x32_bf16 v[52:55], a[192:195], a[4:7], v[52:55]
    v_mfma_f32_16x16x32_bf16 v[56:59], a[68:71], a[4:7], v[56:59]
    v_mfma_f32_16x16x32_bf16 v[60:63], v[212:215], a[4:7], v[60:63]
    buffer_load_dwordx4 v[144:147], v1, s[52:55], s57 offen sc1
    buffer_load_dwordx4 v[148:151], v1, s[52:55], s57 offen offset:1024 sc1
    buffer_load_dwordx2 v[152:153], v252, s[52:55], s57 offen offset:2048 sc1
    s_waitcnt vmcnt(0)
    v_max3_u32 v12, v144, v148, v152
    v_cmp_eq_u32 vcc, -1, v12
    s_nop 0
    s_cmp_eq_u64 vcc, 0
    s_cbranch_scc0 L_xf86
L_xo84:
    v_lshlrev_b32 v24, 16, v144
    v_and_b32 v25, s85, v144
    v_lshlrev_b32 v26, 16, v145
    v_and_b32 v27, s85, v145
    v_lshlrev_b32 v28, 16, v146
    v_and_b32 v29, s85, v146
    v_lshlrev_b32 v30, 16, v147
    v_and_b32 v31, s85, v147
    v_lshlrev_b32 v32, 16, v148
    v_and_b32 v33, s85, v148
    v_lshlrev_b32 v34, 16, v149
    v_and_b32 v35, s85, v149
    v_lshlrev_b32 v36, 16, v150
    v_and_b32 v37, s85, v150
    v_lshlrev_b32 v38, 16, v151
    v_and_b32 v39, s85, v151
    v_lshlrev_b32 v40, 16, v152
    v_and_b32 v41, s85, v152
    v_lshlrev_b32 v42, 16, v153
    v_and_b32_e64 v43, s85, v153
    v_pk_add_f32 v[44:45], v[44:45], v[24:25]
    v_pk_add_f32 v[46:47], v[46:47], v[26:27]
    v_pk_add_f32 v[48:49], v[48:49], v[28:29]
    v_pk_add_f32 v[50:51], v[50:51], v[30:31]
    v_pk_add_f32 v[52:53], v[52:53], v[32:33]
    v_pk_add_f32 v[54:55], v[54:55], v[34:35]
    v_pk_add_f32 v[56:57], v[56:57], v[36:37]
    v_pk_add_f32 v[58:59], v[58:59], v[38:39]
    v_pk_add_f32 v[60:61], v[60:61], v[40:41]
    v_pk_add_f32 v[62:63], v[62:63], v[42:43]
    v_cvt_pk_bf16_f32 v64, v44, v45
    v_cvt_pk_bf16_f32 v65, v46, v47
    v_cvt_pk_bf16_f32 v66, v48, v49
    v_cvt_pk_bf16_f32 v67, v50, v51
    ds_write_b128 v223, v[64:67]
    v_cvt_pk_bf16_f32 v68, v52, v53
    v_cvt_pk_bf16_f32 v69, v54, v55
    v_cvt_pk_bf16_f32 v70, v56, v57
    v_cvt_pk_bf16_f32 v71, v58, v59
    ds_write_b128 v223, v[68:71] offset:1024
    v_cvt_pk_bf16_f32 v72, v60, v61
    v_cvt_pk_bf16_f32 v73, v62, v63
    ds_write_b64 v223, v[72:73] offset:2048
    ds_read_b128 v[76:79], v222
    ds_read_b128 v[80:83], v222 offset:1024
    ds_read_b64 v[84:85], v222 offset:2048
    s_waitcnt lgkmcnt(2)
    buffer_store_dwordx4 v[76:79], v220, s[48:51], s66 offen
    s_waitcnt lgkmcnt(1)
    buffer_store_dwordx4 v[80:83], v220, s[48:51], s66 offen offset:64
    s_waitcnt lgkmcnt(0)
    buffer_store_dwordx2 v[84:85], v221, s[48:51], s66 offen offset:128
    s_or_b32 s95, s2, s5
    s_cmp_lg_u32 s95, 0
    s_cbranch_scc1 L_noep
    s_add_u32 s95, s7, 1
    v_mov_b32 v226, s95
    s_mov_b32 s95, 0
    buffer_store_dword v226, v227, s[52:55], s95 offen
L_noep:
L_end:
    s_endpgm
L_stf18:
    s_mov_b32 s92, 0
L_stc16:
    buffer_load_dwordx4 v[152:155], v220, s[52:55], s79 offen sc1
    buffer_load_dwordx4 v[156:159], v221, s[52:55], s79 offen sc1
    buffer_load_dwordx4 v[160:163], v222, s[52:55], s79 offen sc1
    buffer_load_dwordx4 v[164:167], v223, s[52:55], s79 offen sc1
    buffer_load_dwordx4 v[168:171], v224, s[52:55], s79 offen sc1
    s_add_u32 s92, s92, 1
    s_waitcnt vmcnt(0)
    v_xor_b32 v30, s6, v154
    v_bitop3_b32 v30, v30, v158, s6 bitop3:0xf6
    v_bitop3_b32 v30, v30, v162, s6 bitop3:0xf6
    v_bitop3_b32 v30, v30, v166, s6 bitop3:0xf6
    v_bitop3_b32 v30, v30, v170, s6 bitop3:0xf6
    v_cmp_ne_u32 vcc, 0, v30
    s_nop 0
    s_cmp_eq_u64 vcc, 0
    s_cbranch_scc1 L_sto17
    s_cmp_lt_u32 s92, 0x100000
    s_cbranch_scc1 L_stc16
    s_branch L_sto17
L_pollf22:
    s_mov_b32 s92, 0
L_poll19:
    buffer_load_dword v3, v214, s[52:55], s67 offen sc1
    s_add_u32 s92, s92, 1
    s_cmp_lg_u32 s92, 64
    s_cbranch_scc1 L_polln21
    s_xor_b32 s93, s0, 0x8000
    buffer_store_dword v226, v227, s[52:55], s93 offen sc1
    s_xor_b32 s93, s1, 0x8000
    buffer_store_dword v226, v227, s[52:55], s93 offen sc1
L_polln21:
    s_waitcnt vmcnt(0)
    v_cmp_eq_u32 vcc, s6, v3
    s_nop 0
    s_or_b64 s[90:91], s[90:91], vcc
    s_cmp_eq_u64 s[90:91], -1
    s_cbranch_scc1 L_polld20
    s_cmp_lt_u32 s92, 0x200000
    s_cbranch_scc1 L_poll19
    s_branch L_polld20
L_stf31:
    s_mov_b32 s92, 0
L_stc29:
    buffer_load_dwordx4 v[152:155], v220, s[52:55], s79 offen sc1
    buffer_load_dwordx4 v[156:159], v221, s[52:55], s79 offen sc1
    s_add_u32 s92, s92, 1
    s_waitcnt vmcnt(0)
    v_xor_b32 v30, s6, v154
    v_bitop3_b32 v30, v30, v158, s6 bitop3:0xf6
    v_cmp_ne_u32 vcc, 0, v30
    s_nop 0
    s_cmp_eq_u64 vcc, 0
    s_cbranch_scc1 L_sto30
    s_cmp_lt_u32 s92, 0x100000
    s_cbranch_scc1 L_stc29
    s_branch L_sto30
L_pollf35:
    s_mov_b32 s92, 0
L_poll32:
    buffer_load_dword v3, v214, s[52:55], s67 offen sc1
    s_add_u32 s92, s92, 1
    s_cmp_lg_u32 s92, 64
    s_cbranch_scc1 L_polln34
    s_xor_b32 s93, s0, 0x8000
    buffer_store_dword v226, v227, s[52:55], s93 offen sc1
    s_xor_b32 s93, s1, 0x8000
    buffer_store_dword v226, v227, s[52:55], s93 offen sc1
L_polln34:
    s_waitcnt vmcnt(0)
    v_cmp_eq_u32 vcc, s6, v3
    s_nop 0
    s_or_b64 s[90:91], s[90:91], vcc
    s_cmp_eq_u64 s[90:91], -1
    s_cbranch_scc1 L_polld33
    s_cmp_lt_u32 s92, 0x200000
    s_cbranch_scc1 L_poll32
    s_branch L_polld33
L_stf44:
    s_mov_b32 s92, 0
L_stc42:
    buffer_load_dwordx4 v[152:155], v220, s[52:55], s79 offen sc1
    buffer_load_dwordx4 v[156:159], v221, s[52:55], s79 offen sc1
    s_add_u32 s92, s92, 1
    s_waitcnt vmcnt(0)
    v_xor_b32 v30, s6, v154
    v_bitop3_b32 v30, v30, v158, s6 bitop3:0xf6
    v_cmp_ne_u32 vcc, 0, v30
    s_nop 0
    s_cmp_eq_u64 vcc, 0
    s_cbranch_scc1 L_sto43
    s_cmp_lt_u32 s92, 0x100000
    s_cbranch_scc1 L_stc42
    s_branch L_sto43
L_pollf48:
    s_mov_b32 s92, 0
L_poll45:
    buffer_load_dword v3, v214, s[52:55], s67 offen sc1
    s_add_u32 s92, s92, 1
    s_cmp_lg_u32 s92, 64
    s_cbranch_scc1 L_polln47
    s_xor_b32 s93, s0, 0x8000
    buffer_store_dword v226, v227, s[52:55], s93 offen sc1
    s_xor_b32 s93, s1, 0x8000
    buffer_store_dword v226, v227, s[52:55], s93 offen sc1
L_polln47:
    s_waitcnt vmcnt(0)
    v_cmp_eq_u32 vcc, s6, v3
    s_nop 0
    s_or_b64 s[90:91], s[90:91], vcc
    s_cmp_eq_u64 s[90:91], -1
    s_cbranch_scc1 L_polld46
    s_cmp_lt_u32 s92, 0x200000
    s_cbranch_scc1 L_poll45
    s_branch L_polld46
L_pollf66:
    s_mov_b32 s92, 0
L_poll63:
    buffer_load_dword v3, v214, s[52:55], s67 offen sc1
    s_add_u32 s92, s92, 1
    s_cmp_lg_u32 s92, 64
    s_cbranch_scc1 L_polln65
    s_xor_b32 s93, s0, 0x8000
    buffer_store_dword v226, v227, s[52:55], s93 offen sc1
    s_xor_b32 s93, s1, 0x8000
    buffer_store_dword v226, v227, s[52:55], s93 offen sc1
L_polln65:
    s_waitcnt vmcnt(0)
    v_cmp_eq_u32 vcc, s6, v3
    s_nop 0
    s_or_b64 s[90:91], s[90:91], vcc
    s_cmp_eq_u64 s[90:91], -1
    s_cbranch_scc1 L_polld64
    s_cmp_lt_u32 s92, 0x200000
    s_cbranch_scc1 L_poll63
    s_branch L_polld64
L_pollf74:
L_pad_cd_1:
    s_cbranch_execz L_pad_cd_2
    s_mov_b32 s92, 0
    s_waitcnt vmcnt(0)
    buffer_load_dword v31, v214, s[52:55], s94 offen sc1
    buffer_load_dword v30, v214, s[52:55], s94 offen sc1
L_poll71:
    buffer_load_dword v3, v214, s[52:55], s94 offen sc1
    s_add_u32 s92, s92, 1
    s_waitcnt vmcnt(2)
    v_cmp_eq_u32 vcc, s6, v31
    s_nop 0
    s_or_b64 s[90:91], s[90:91], vcc
    s_cmp_eq_u64 s[90:91], -1
    s_cbranch_scc1 L_polld72
    buffer_load_dword v31, v214, s[52:55], s94 offen sc1
    s_waitcnt vmcnt(2)
    v_cmp_eq_u32 vcc, s6, v30
    s_nop 0
    s_or_b64 s[90:91], s[90:91], vcc
    s_cmp_eq_u64 s[90:91], -1
    s_cbranch_scc1 L_polld72
    s_cmp_lg_u32 s92, 64
    s_cbranch_scc1 L_polln73
    s_xor_b32 s93, s95, 0x8000
    buffer_store_dword v226, v227, s[52:55], s93 offen sc1
    s_xor_b32 s93, s99, 0x8000
    buffer_store_dword v226, v227, s[52:55], s93 offen sc1
L_polln73:
    buffer_load_dword v30, v214, s[52:55], s94 offen sc1
    s_waitcnt vmcnt(2)
    v_cmp_eq_u32 vcc, s6, v3
    s_nop 0
    s_or_b64 s[90:91], s[90:91], vcc
    s_cmp_eq_u64 s[90:91], -1
    s_cbranch_scc1 L_polld72
    s_cmp_lt_u32 s92, 0x200000
    s_cbranch_scc1 L_poll71
    s_branch L_polld72
L_pollf78:
L_pad_m2_0:
    s_cbranch_execz L_pad_m2_1
    s_mov_b32 s92, 0
L_poll75:
    buffer_load_dword v2, v5, s[52:55], s1 offen sc1
    s_add_u32 s92, s92, 1
    s_cmp_lg_u32 s92, 64
    s_cbranch_scc1 L_polln77
    s_xor_b32 s93, s0, 0x8000
    buffer_store_dword v226, v227, s[52:55], s93 offen sc1
L_polln77:
    s_cmp_gt_u32 s92, 256
    s_cselect_b32 s93, 0x8000, 0
    s_xor_b32 s1, s1, s93
    s_waitcnt vmcnt(0)
    v_cmp_eq_u32 vcc, s6, v2
    s_nop 0
    s_or_b64 s[90:91], s[90:91], vcc
    s_cmp_eq_u64 s[90:91], -1
    s_cbranch_scc1 L_polld76
    s_cmp_lt_u32 s92, 0x200000
    s_cbranch_scc1 L_poll75
    s_branch L_polld76
L_pollf82:
L_pad_m2_1:
    s_cbranch_execz L_pad_m2_2
    s_mov_b32 s92, 0
L_poll79:
    buffer_load_dword v2, v5, s[52:55], s1 offen sc1
    s_add_u32 s92, s92, 1
    s_cmp_lg_u32 s92, 64
    s_cbranch_scc1 L_polln81
    s_xor_b32 s93, s0, 0x8000
    buffer_store_dword v226, v227, s[52:55], s93 offen sc1
    s_xor_b32 s93, s59, 0x8000
    buffer_store_dword v226, v227, s[52:55], s93 offen sc1
L_polln81:
    s_cmp_gt_u32 s92, 256
    s_cselect_b32 s93, 0x8000, 0
    s_xor_b32 s1, s1, s93
    s_waitcnt vmcnt(0)
    v_cmp_eq_u32 vcc, s6, v2
    s_nop 0
    s_or_b64 s[90:91], s[90:91], vcc
    s_cmp_eq_u64 s[90:91], -1
    s_cbranch_scc1 L_polld80
    s_cmp_lt_u32 s92, 0x200000
    s_cbranch_scc1 L_poll79
    s_branch L_polld80
L_xf86:
L_pad_m2_2:
    s_cbranch_execz L_pad_m2_3
    s_mov_b32 s92, 0
L_xw83:
    buffer_load_dwordx4 v[144:147], v1, s[52:55], s57 offen sc1
    buffer_load_dwordx4 v[148:151], v1, s[52:55], s57 offen offset:1024 sc1
    buffer_load_dwordx2 v[152:153], v252, s[52:55], s57 offen offset:2048 sc1
    s_add_u32 s92, s92, 1
    s_waitcnt vmcnt(0)
    v_max3_u32 v12, v144, v148, v152
    v_cmp_eq_u32 vcc, -1, v12
    s_nop 0
    s_cmp_eq_u64 vcc, 0
    s_cbranch_scc1 L_xo84
    s_cmp_lt_u32 s92, 0x100000
    s_cbranch_scc1 L_xw83
    s_branch L_xo84
L_last:
.section .rodata,"a"
.p2align 6
.amdhsa_kernel sequential_preLN__ssm_conv_h3__mixer_channel_mlp__prompt_kernel
  .amdhsa_next_free_vgpr 512
  .amdhsa_next_free_sgpr 102
  .amdhsa_accum_offset 256
  .amdhsa_group_segment_fixed_size 0
  .amdhsa_kernarg_size 112
  .amdhsa_user_sgpr_count 2
  .amdhsa_user_sgpr_kernarg_segment_ptr 1
  .amdhsa_system_sgpr_workgroup_id_x 1
  .amdhsa_float_denorm_mode_32 3
.end_amdhsa_kernel
```
